```python
import torch

def _softmax(x, axis=-1):
    return torch.softmax(x, dim=axis)

def _gelu(x):
    return torch.nn.functional.gelu(x, approximate='tanh')

def _silu(x):
    return torch.nn.functional.silu(x)

def _sigmoid(x):
    return torch.sigmoid(x)

def _layernorm(x, axis=-1, eps=1e-05):
    m = x.mean(dim=axis, keepdim=True)
    v = x.var(dim=axis, keepdim=True, unbiased=False)
    return (x - m) / torch.sqrt(v + eps)

def _scatter_add(tgt, idx, src, axis=0):
    return tgt.clone().index_add_(axis, idx, src)

def _segment_sum(src, seg, n):
    out = torch.zeros((n,) + src.shape[1:], dtype=src.dtype)
    return out.index_add_(0, seg, src)

def _pad(x, pw):
    flat = tuple((v for pair in reversed(pw) for v in pair))
    return torch.nn.functional.pad(x, flat)
kernel_name = 'sequential_preLN__ssm_conv_s4__mixer_gmlp__prompt'

def setup_inputs():

    _w = lambda a: (lambda t: t.to(torch.bfloat16) if t.is_floating_point() else t)(torch.as_tensor(a))

    def _A_setup():
        B, L, D, N = (1, 2048, 640, 192)
        A_re = -(lambda _x: torch.exp(torch.as_tensor(_x)))((lambda *s: torch.randn(*s, dtype=torch.bfloat16) * 3.2)(D, N))
        A_im = torch.pi * (lambda *s: torch.randn(*s, dtype=torch.bfloat16) * 0.05)(D, N)
        B_re = (lambda *s: torch.randn(*s, dtype=torch.bfloat16) * 0.1)(D, N)
        B_im = (lambda *s: torch.randn(*s, dtype=torch.bfloat16) * 0.05)(D, N)
        C_re = (lambda *s: torch.randn(*s, dtype=torch.bfloat16) * 0.05)(D, N)
        C_im = (lambda *s: torch.randn(*s, dtype=torch.bfloat16) * 0.05)(D, N)
        log_dt = (lambda *s: torch.randn(*s, dtype=torch.bfloat16) * 0.05)(D) * 0.5 - 4.0
        Dskip = (lambda *s: torch.randn(*s, dtype=torch.bfloat16) * 0.05)(D)
        return {'u': _w((lambda *s: torch.randn(*s, dtype=torch.bfloat16) * 0.05)(B, L, D)), 'A_re': _w(A_re), 'A_im': _w(A_im), 'B_re': _w(B_re), 'B_im': _w(B_im), 'C_re': _w(C_re), 'C_im': _w(C_im), 'log_dt': _w(log_dt), 'Dskip': _w(Dskip)}
    _A_in = _A_setup()

    def _B_setup():
        B, S, D, F = (1, 2048, 640, 1536)
        Fh = F // 2
        return {'x': _w((lambda *s: torch.randn(*s, dtype=torch.bfloat16) * 0.05)(B, S, D)), 'w_in': _w((lambda *s: torch.randn(*s, dtype=torch.bfloat16) * 0.4)(D, 2 * Fh)), 'w_sp': _w(0.01 * (lambda *s: torch.randn(*s, dtype=torch.bfloat16) * 0.4)(S, S)), 'b_sp': _w(1.0 + 0.01 * (lambda *s: torch.randn(*s, dtype=torch.bfloat16) * 0.05)(S)), 'w_out': _w((lambda *s: torch.randn(*s, dtype=torch.bfloat16) * 0.05)(Fh, D))}
    _B_in = _B_setup()
    return {'A_u': _A_in['u'], 'A_A_re': _A_in['A_re'], 'A_A_im': _A_in['A_im'], 'A_B_re': _A_in['B_re'], 'A_B_im': _A_in['B_im'], 'A_C_re': _A_in['C_re'], 'A_C_im': _A_in['C_im'], 'A_log_dt': _A_in['log_dt'], 'A_Dskip': _A_in['Dskip'], 'B_x': _B_in['x'], 'B_w_in': _B_in['w_in'], 'B_w_sp': _B_in['w_sp'], 'B_b_sp': _B_in['b_sp'], 'B_w_out': _B_in['w_out']}

def reference(A_u, A_A_re, A_A_im, A_B_re, A_B_im, A_C_re, A_C_im, A_log_dt, A_Dskip, B_x, B_w_in, B_w_sp, B_b_sp, B_w_out):

    def _A_ref(u, A_re, A_im, B_re, B_im, C_re, C_im, log_dt, Dskip):
        Bsz, L, D = u.shape
        dt = torch.exp(log_dt)[:, None]
        A = A_re + 1j * A_im
        Bc = B_re + 1j * B_im
        Cc = C_re + 1j * C_im
        logdA = dt * A
        dB = dt * Bc
        l = (lambda x, dt: x.to(dt))(torch.arange(L), A_re.dtype)
        P = torch.exp(logdA[:, :, None] * l[None, None, :])
        K = torch.einsum('dn,dnl,dn->dl', Cc, P, dB).real
        L2 = 2 * L
        Kp = _pad(K, ((0, 0), (0, L)))
        up = (lambda x, *d: x.permute(*d))(u, 0, 2, 1)
        up = _pad(up, ((0, 0), (0, 0), (0, L)))
        Kf = (lambda x, axes=(-2, -1): torch.fft.rfft2(x.float(), dim=axes))(Kp[:, None, :], axes=(-2, -1))
        Uf = (lambda x, axes=(-2, -1): torch.fft.rfft2(x.float(), dim=axes))(up[:, :, None, :], axes=(-2, -1))
        Yf = Uf * Kf[None, :, :, :]
        y = (lambda x, s, axes=(-2, -1): torch.fft.irfft2(x, s=s, dim=axes).to(torch.bfloat16))(Yf, (1, L2), axes=(-2, -1))[:, :, 0, :L]
        y = (lambda x, *d: x.permute(*d))(y, 0, 2, 1) + u * Dskip[None, None, :]
        return y

    def _B_ref(x, w_in, w_sp, b_sp, w_out):
        B, S, D = x.shape
        F = w_in.shape[-1]
        Fh = F // 2
        z = _gelu(torch.einsum('bsd,df->bsf', x, w_in))
        z1 = z[..., :Fh].clone()
        z2 = _layernorm(z[..., Fh:], axis=-1)
        g = torch.einsum('ts,bsf->btf', w_sp, z2) + b_sp[None, :, None]
        return torch.einsum('bsf,fd->bsd', z1 * g, w_out)
    x = A_u
    h = x + _A_ref(_layernorm(x, axis=-1), A_A_re, A_A_im, A_B_re, A_B_im, A_C_re, A_C_im, A_log_dt, A_Dskip)
    h2 = h + _B_ref(_layernorm(h, axis=-1), B_w_in, B_w_sp, B_b_sp, B_w_out)
    return h2
```

```asm
; @launch grid=(256,1,1) block=(256,1,1) lds=163840
.amdgcn_target "amdgcn-amd-amdhsa--gfx950"
.text
.globl sequential_preLN__ssm_conv_s4__mixer_gmlp__prompt_kernel
.p2align 8
.type sequential_preLN__ssm_conv_s4__mixer_gmlp__prompt_kernel,@function
sequential_preLN__ssm_conv_s4__mixer_gmlp__prompt_kernel:
    s_load_dwordx16 s[4:19], s[0:1], 0
    s_load_dwordx16 s[20:35], s[0:1], 64
    s_load_dwordx2 s[36:37], s[0:1], 128
    s_cmp_ge_u32 s2, 256
    s_cbranch_scc1 L_exit
    s_lshr_b32 s66, s2, 3
    v_lshrrev_b32 v2, 6, v0
    v_and_b32 v1, 63, v0
    v_readfirstlane_b32 s64, v2
    s_getpc_b64 s[38:39]
    s_lshl_b32 s3, s66, 11
    v_lshrrev_b32 v4, 4, v0
    v_lshl_add_u32 v4, v4, 7, s3
    v_min_u32 v4, 0xcb68, v4
    global_load_dword v254, v4, s[38:39]
    s_and_b32 s65, s2, 7
    s_cmp_lt_u32 s66, 12
    s_cbranch_scc1 L_helper
    s_mul_i32 s72, s65, 20
    s_add_u32 s72, s72, s66
    s_sub_u32 s74, s72, 12
    s_lshl_b32 s72, s74, 2
    s_add_u32 s72, s72, s64
    s_mul_i32 s73, s72, 384
    v_mul_u32_u24 v65, 6, v1
    v_and_b32 v65, -4, v65
    v_add_u32 v65, s73, v65
    s_lshl_b32 s72, s72, 1
    v_mov_b32 v67, s72
    s_waitcnt lgkmcnt(0)
    global_load_ushort v64, v67, s[18:19]
    global_load_dwordx2 v[52:53], v65, s[6:7]
    global_load_dwordx2 v[54:55], v65, s[8:9]
    global_load_dwordx2 v[56:57], v65, s[10:11]
    global_load_dwordx2 v[58:59], v65, s[12:13]
    global_load_dwordx2 v[60:61], v65, s[14:15]
    global_load_dwordx2 v[62:63], v65, s[16:17]
    global_load_ushort v68, v67, s[20:21]
    v_mov_b32 v3, 0
    s_lshr_b32 s72, s65, 1
    s_lshl_b32 s72, s72, 3
    s_and_b32 s73, s66, 7
    s_add_u32 s67, s72, s73
    s_and_b32 s72, s65, 1
    s_lshl_b32 s72, s72, 2
    s_lshr_b32 s73, s66, 3
    s_add_u32 s68, s72, s73
    s_lshl_b32 s72, s65, 2
    s_and_b32 s73, s66, 3
    s_add_u32 s69, s72, s73
    s_lshr_b32 s70, s66, 2
    s_mov_b32 s69, s67
    s_mov_b32 s70, s68
    s_nop 0
    s_mul_i32 s71, s64, 18432
    s_mul_i32 s95, s64, 22528
    s_add_u32 s95, s95, 73728
    s_mov_b32 s76, 65536
    s_mov_b32 s90, 0x3f803f80
    v_lshlrev_b32 v109, 4, v0
    s_mov_b64 s[60:61], s[36:37]
    s_mov_b32 s62, 33554432
    s_mov_b32 s63, 0x20000
    v_mov_b32 v2, 0
    buffer_load_dword v2, v2, s[60:63], 0 offen sc1
    v_and_b32 v92, 7, v1
    v_bfe_u32 v91, v1, 3, 1
    v_lshl_add_u32 v92, v92, 1, v91
    s_lshl_b32 s72, s67, 2
    s_add_u32 s72, s72, s64
    s_lshl_b32 s72, s72, 5
    v_lshl_add_u32 v92, v92, 1, s72
    global_load_ushort v92, v92, s[28:29]
    v_lshrrev_b32 v36, 1, v0
    v_mul_u32_u24 v36, 1280, v36
    v_and_b32 v37, 1, v0
    v_lshl_add_u32 v36, v37, 7, v36
    s_mul_i32 s72, s65, 160
    s_and_b32 s72, s72, 0xff80
    s_and_b32 s73, s66, 15
    s_mul_i32 s73, s73, 163840
    s_add_u32 s78, s72, s73
    v_mul_u32_u24 v65, 0x0202, v37
    v_lshlrev_b32 v65, 16, v65
    v_add_u32 v65, 0x01000c0c, v65
    v_add_u32 v66, 0x02020000, v65
    v_add_u32 v67, 0x04040000, v65
    v_mul_u32_u24 v37, 2560, v0
    s_lshl_b32 s92, s74, 3
    s_mov_b64 s[40:41], s[4:5]
    s_mov_b32 s42, 2621440
    s_mov_b32 s43, 0x20000
    buffer_load_dword v36, v36, s[40:43], s78 offen
    buffer_load_dwordx2 v[4:5], v37, s[40:43], s92 offen offset:0
    buffer_load_dwordx2 v[6:7], v37, s[40:43], s92 offen offset:1280
    s_add_u32 s92, s92, 655360
    s_sub_u32 s48, s26, 4096
    s_subb_u32 s49, s27, 0
    s_mov_b32 s50, 8392704
    s_mov_b32 s51, 0x20000
    s_mov_b64 s[56:57], s[32:33]
    s_mov_b32 s58, 2621440
    s_mov_b32 s59, 0x20000
    s_lshl_b32 s79, s74, 14
    s_add_u32 s79, s79, 1048576
    v_lshrrev_b32 v112, 3, v1
    v_and_b32 v113, 7, v1
    v_lshrrev_b32 v114, 1, v112
    v_xor_b32 v113, v113, v114
    v_lshlrev_b32 v113, 4, v113
    v_lshl_add_u32 v114, v112, 12, v113
    v_xor_b32 v115, 64, v114
    s_mul_i32 s77, s67, 262144
    s_lshl_b32 s72, s64, 10
    s_add_u32 s77, s77, s72
    v_add_u32 v114, s77, v114
    s_add_u32 s77, s77, 31744
    v_add_u32 v115, s77, v115
    s_add_u32 s72, s64, 0
    s_and_b32 s72, s72, 3
    s_lshl_b32 s72, s72, 16
    s_add_u32 s72, s72, 4096
    v_add_u32 v100, s72, v114
    v_add_u32 v101, s72, v115
    s_add_u32 s72, s64, 1
    s_and_b32 s72, s72, 3
    s_lshl_b32 s72, s72, 16
    s_add_u32 s72, s72, 2048
    v_add_u32 v102, s72, v114
    v_add_u32 v103, s72, v115
    s_add_u32 s72, s64, 2
    s_and_b32 s72, s72, 3
    s_lshl_b32 s72, s72, 16
    s_add_u32 s72, s72, 4096
    v_add_u32 v70, s72, v114
    v_add_u32 v71, s72, v115
    s_add_u32 s72, s64, 3
    s_and_b32 s72, s72, 3
    s_lshl_b32 s72, s72, 16
    s_add_u32 s72, s72, 2048
    v_add_u32 v72, s72, v114
    v_add_u32 v73, s72, v115
    v_and_b32 v112, 7, v1
    v_lshrrev_b32 v113, 4, v1
    v_xor_b32 v113, v113, v112
    v_lshlrev_b32 v113, 4, v113
    v_lshl_add_u32 v113, v112, 8, v113
    v_and_b32 v112, 8, v1
    v_lshl_add_u32 v113, v112, 4, v113
    v_xor_b32 v114, 64, v113
    v_add_u32 v104, s95, v113
    v_add_u32 v105, s95, v114
    s_lshl_b32 s99, s67, 3
    s_and_b32 s72, s68, 4
    s_add_u32 s99, s99, s72
    s_and_b32 s99, s99, 7
    s_lshl_b32 s98, s99, 7
    v_lshlrev_b32 v106, 4, v1
    v_and_b32 v112, 15, v1
    v_lshrrev_b32 v113, 4, v1
    v_mul_u32_u24 v114, 288, v112
    v_lshl_add_u32 v114, v113, 4, v114
    v_add_u32 v74, s71, v114
    s_add_u32 s72, s71, 16640
    v_cmp_gt_u32 vcc, 32, v1
    v_lshlrev_b32 v114, 3, v113
    v_lshl_add_u32 v75, v112, 5, v114
    v_add_u32 v75, s72, v75
    v_lshl_add_u32 v114, v112, 4, v114
    v_lshlrev_b32 v115, 7, v113
    v_lshl_add_u32 v116, v112, 3, v115
    v_cndmask_b32 v114, v116, v114, vcc
    v_add_u32 v76, s72, v114
    v_lshl_add_u32 v115, v112, 2, v115
    v_add_u32 v114, 1344, v115
    v_add_u32 v115, 768, v115
    v_cndmask_b32 v114, v115, v114, vcc
    v_add_u32 v77, s72, v114
    v_lshlrev_b32 v114, 2, v1
    s_add_u32 s73, s72, 1020
    v_sub_u32 v78, s73, v114
    v_lshlrev_b32 v114, 3, v1
    v_sub_u32 v114, 760, v114
    v_sub_u32 v115, 1008, v106
    v_cndmask_b32 v114, v115, v114, vcc
    v_add_u32 v79, s72, v114
    v_mov_b32 v80, 0x05040706
    v_mov_b32 v81, 0x05040706
    v_mov_b32 v82, 0x05040706
    v_mov_b32 v83, 0x05040706
    s_mov_b32 exec_hi, 0
    v_mov_b32 v80, 0x03020504
    v_mov_b32 v81, 0x01000100
    v_mov_b32 v82, 0x03020504
    v_mov_b32 v83, 0x01000100
    s_mov_b32 exec_hi, -1
    v_lshlrev_b32 v114, 2, v113
    v_sub_u32 v114, v112, v114
    s_add_u32 s73, s72, 1332
    v_lshl_add_u32 v86, v114, 2, s73
    v_lshlrev_b32 v114, 1, v112
    v_sub_u32 v114, v114, v113
    v_mov_b32 v84, 0x0c0c0c0c
    v_mov_b32 v115, 0x05040c0c
    v_cmp_le_i32 vcc, 23, v114
    v_mov_b32 v116, 0x05040504
    v_mul_u32_u24 v85, 2368, v113
    v_cndmask_b32 v84, v84, v115, vcc
    v_cmp_le_i32 vcc, 24, v114
    v_lshl_add_u32 v85, v112, 2, v85
    v_add_u32 v85, s71, v85
    v_cndmask_b32 v84, v84, v116, vcc
    s_mov_b32 s73, 0x03020504
    v_writelane_b32 v84, s73, 15
    v_and_b32 v114, 3, v1
    v_mul_u32_u24 v114, 2368, v114
    v_lshrrev_b32 v115, 2, v112
    v_lshlrev_b32 v115, 3, v115
    v_sub_u32 v114, v114, v115
    v_lshl_add_u32 v114, v113, 4, v114
    s_add_u32 s73, s71, 24
    v_add_u32 v88, s73, v114
    v_lshlrev_b32 v114, 4, v113
    v_lshl_add_u32 v114, v112, 5, v114
    s_add_u32 s73, s95, 16384
    v_add_u32 v89, s73, v114
    v_lshlrev_b32 v93, 2, v0
    v_add_u32 v93, 90592, v93
    v_add_u32 v87, s71, v106
    v_mov_b32 v116, 0
    v_mov_b32 v117, 0
    v_min_u32 v114, 59, v1
    v_lshl_add_u32 v114, v114, 3, s95
    v_lshl_add_u32 v115, v112, 2, s72
    v_mov_b32 v118, 0x3f80
    s_mov_b32 m0, s71
    ds_write_b64 v114, v[116:117] offset:16384
    ds_write_b32 v115, v116 offset:1280
    ds_write_addtid_b32 v118 offset:4608
    s_mov_b32 s80, 0x3fb8aa3b
    s_mov_b32 s81, 0x3e22f983
    s_nop 0
    s_mov_b32 s82, 0x41b8aa3b
    s_mov_b32 s83, 0x4022f983
    s_mov_b32 s84, 0x43b8aa3b
    s_mov_b32 s85, 0x4222f983
    buffer_load_dwordx2 v[8:9], v37, s[40:43], s92 offen offset:0
    buffer_load_dwordx2 v[10:11], v37, s[40:43], s92 offen offset:1280
    s_add_u32 s92, s92, 655360
    s_waitcnt vmcnt(8)
    v_lshlrev_b32 v124, 16, v64
    v_mul_f32 v124, 0x3fb8aa3b, v124
    v_exp_f32 v124, v124
    s_nop 0
    v_cvt_pk_bf16_f32 v124, 0, v124
    v_perm_b32 v126, v53, v52, v65
    v_perm_b32 v127, v55, v54, v65
    v_perm_b32 v128, v57, v56, v65
    v_perm_b32 v129, v59, v58, v65
    v_perm_b32 v130, v61, v60, v65
    v_perm_b32 v131, v63, v62, v65
    v_pk_mul_f32 v[126:127], v[126:127], v[124:125] op_sel_hi:[1,0]
    v_pk_mul_f32 v[128:129], v[128:129], v[124:125] op_sel_hi:[1,0]
    v_pk_mul_f32 v[174:175], v[126:127], s[80:81]
    v_pk_mul_f32 v[176:177], v[126:127], s[82:83]
    v_pk_mul_f32 v[178:179], v[126:127], s[84:85]
    v_pk_mul_f32 v[132:133], v[130:131], v[128:129] op_sel:[0,0] op_sel_hi:[0,1]
    v_pk_fma_f32 v[40:41], v[130:131], v[128:129], v[132:133] op_sel:[1,1,0] op_sel_hi:[1,0,1] neg_lo:[1,0,0] neg_hi:[1,0,1]
    v_fract_f32 v175, v175
    v_fract_f32 v177, v177
    v_fract_f32 v179, v179
    v_exp_f32 v174, v174
    v_cos_f32 v134, v175
    v_sin_f32 v135, v175
    v_exp_f32 v176, v176
    v_cos_f32 v136, v177
    v_sin_f32 v137, v177
    v_exp_f32 v178, v178
    v_cos_f32 v156, v179
    v_sin_f32 v157, v179
    v_pk_mul_f32 v[134:135], v[134:135], v[174:175] op_sel_hi:[1,0]
    v_pk_mul_f32 v[136:137], v[136:137], v[176:177] op_sel_hi:[1,0] neg_hi:[1,0]
    v_pk_mul_f32 v[156:157], v[156:157], v[178:179] op_sel_hi:[1,0]
    v_pk_mul_f32 v[132:133], v[40:41], v[136:137] op_sel:[0,0] op_sel_hi:[0,1]
    v_pk_fma_f32 v[42:43], v[40:41], v[136:137], v[132:133] op_sel:[1,1,0] op_sel_hi:[1,0,1] neg_lo:[1,0,0]
    v_pk_mul_f32 v[132:133], v[42:43], v[136:137] op_sel:[0,0] op_sel_hi:[0,1]
    v_pk_fma_f32 v[44:45], v[42:43], v[136:137], v[132:133] op_sel:[1,1,0] op_sel_hi:[1,0,1] neg_lo:[1,0,0]
    v_pk_mul_f32 v[132:133], v[44:45], v[136:137] op_sel:[0,0] op_sel_hi:[0,1]
    v_pk_fma_f32 v[46:47], v[44:45], v[136:137], v[132:133] op_sel:[1,1,0] op_sel_hi:[1,0,1] neg_lo:[1,0,0]
    v_pk_mul_f32 v[132:133], v[156:157], v[156:157] op_sel:[0,0] op_sel_hi:[0,1]
    v_pk_fma_f32 v[158:159], v[156:157], v[156:157], v[132:133] op_sel:[1,1,0] op_sel_hi:[1,0,1] neg_lo:[1,0,0]
    v_pk_mul_f32 v[132:133], v[158:159], v[156:157] op_sel:[0,0] op_sel_hi:[0,1]
    v_pk_fma_f32 v[160:161], v[158:159], v[156:157], v[132:133] op_sel:[1,1,0] op_sel_hi:[1,0,1] neg_lo:[1,0,0]
    v_pk_mul_f32 v[132:133], v[158:159], v[158:159] op_sel:[0,0] op_sel_hi:[0,1]
    v_pk_fma_f32 v[162:163], v[158:159], v[158:159], v[132:133] op_sel:[1,1,0] op_sel_hi:[1,0,1] neg_lo:[1,0,0]
    v_pk_mul_f32 v[132:133], v[136:137], v[162:163] op_sel:[0,0] op_sel_hi:[0,1]
    v_pk_fma_f32 v[164:165], v[136:137], v[162:163], v[132:133] op_sel:[1,1,0] op_sel_hi:[1,0,1] neg_hi:[1,0,0]
    v_pk_mul_f32 v[132:133], v[164:165], v[156:157] op_sel:[0,0] op_sel_hi:[0,1]
    v_pk_fma_f32 v[166:167], v[164:165], v[156:157], v[132:133] op_sel:[1,1,0] op_sel_hi:[1,0,1] neg_lo:[1,0,0]
    v_pk_mul_f32 v[132:133], v[164:165], v[158:159] op_sel:[0,0] op_sel_hi:[0,1]
    v_pk_fma_f32 v[168:169], v[164:165], v[158:159], v[132:133] op_sel:[1,1,0] op_sel_hi:[1,0,1] neg_lo:[1,0,0]
    v_pk_mul_f32 v[132:133], v[164:165], v[160:161] op_sel:[0,0] op_sel_hi:[0,1]
    v_pk_fma_f32 v[170:171], v[164:165], v[160:161], v[132:133] op_sel:[1,1,0] op_sel_hi:[1,0,1] neg_lo:[1,0,0]
    v_cvt_pk_bf16_f32 v180, v40, v41
    v_cvt_pk_bf16_f32 v181, v42, v43
    v_cvt_pk_bf16_f32 v182, v44, v45
    v_cvt_pk_bf16_f32 v183, v46, v47
    v_cvt_pk_bf16_f32 v184, v156, v157
    v_cvt_pk_bf16_f32 v185, v158, v159
    v_cvt_pk_bf16_f32 v186, v160, v161
    v_cvt_pk_bf16_f32 v187, v162, v163
    v_cvt_pk_bf16_f32 v188, v164, v165
    v_cvt_pk_bf16_f32 v189, v166, v167
    v_cvt_pk_bf16_f32 v190, v168, v169
    v_cvt_pk_bf16_f32 v191, v170, v171
    ds_write_addtid_b32 v180 offset:0
    ds_write_addtid_b32 v181 offset:288
    ds_write_addtid_b32 v182 offset:576
    ds_write_addtid_b32 v183 offset:864
    ds_write_addtid_b32 v184 offset:9216
    ds_write_addtid_b32 v185 offset:11520
    ds_write_addtid_b32 v186 offset:12672
    ds_write_addtid_b32 v187 offset:16128
    ds_write_addtid_b32 v188 offset:14112
    ds_write_addtid_b32 v189 offset:14688
    ds_write_addtid_b32 v190 offset:15264
    ds_write_addtid_b32 v191 offset:15840
    v_cvt_pk_bf16_f32 v180, v134, v135
    v_pk_mul_f32 v[132:133], v[134:135], v[134:135] op_sel:[0,0] op_sel_hi:[0,1]
    v_pk_fma_f32 v[142:143], v[134:135], v[134:135], v[132:133] op_sel:[1,1,0] op_sel_hi:[1,0,1] neg_lo:[1,0,0]
    v_cvt_pk_bf16_f32 v181, v142, v143
    v_pk_mul_f32 v[132:133], v[142:143], v[134:135] op_sel:[0,0] op_sel_hi:[0,1]
    v_pk_fma_f32 v[140:141], v[142:143], v[134:135], v[132:133] op_sel:[1,1,0] op_sel_hi:[1,0,1] neg_lo:[1,0,0]
    v_cvt_pk_bf16_f32 v182, v140, v141
    v_pk_mul_f32 v[132:133], v[46:47], v[136:137] op_sel:[0,0] op_sel_hi:[0,1]
    v_pk_fma_f32 v[138:139], v[46:47], v[136:137], v[132:133] op_sel:[1,1,0] op_sel_hi:[1,0,1] neg_lo:[1,0,0]
    v_cvt_pk_bf16_f32 v183, v138, v139
    v_pk_mul_f32 v[132:133], v[140:141], v[134:135] op_sel:[0,0] op_sel_hi:[0,1]
    v_pk_fma_f32 v[144:145], v[140:141], v[134:135], v[132:133] op_sel:[1,1,0] op_sel_hi:[1,0,1] neg_lo:[1,0,0]
    v_cvt_pk_bf16_f32 v184, v144, v145
    v_pk_mul_f32 v[132:133], v[138:139], v[136:137] op_sel:[0,0] op_sel_hi:[0,1]
    v_pk_fma_f32 v[138:139], v[138:139], v[136:137], v[132:133] op_sel:[1,1,0] op_sel_hi:[1,0,1] neg_lo:[1,0,0]
    v_cvt_pk_bf16_f32 v185, v138, v139
    v_pk_mul_f32 v[132:133], v[144:145], v[134:135] op_sel:[0,0] op_sel_hi:[0,1]
    v_pk_fma_f32 v[140:141], v[144:145], v[134:135], v[132:133] op_sel:[1,1,0] op_sel_hi:[1,0,1] neg_lo:[1,0,0]
    v_cvt_pk_bf16_f32 v186, v140, v141
    v_pk_mul_f32 v[132:133], v[138:139], v[136:137] op_sel:[0,0] op_sel_hi:[0,1]
    v_pk_fma_f32 v[138:139], v[138:139], v[136:137], v[132:133] op_sel:[1,1,0] op_sel_hi:[1,0,1] neg_lo:[1,0,0]
    v_cvt_pk_bf16_f32 v187, v138, v139
    v_pk_mul_f32 v[132:133], v[140:141], v[134:135] op_sel:[0,0] op_sel_hi:[0,1]
    v_pk_fma_f32 v[146:147], v[140:141], v[134:135], v[132:133] op_sel:[1,1,0] op_sel_hi:[1,0,1] neg_lo:[1,0,0]
    v_cvt_pk_bf16_f32 v188, v146, v147
    ds_write_addtid_b32 v180 offset:4896
    ds_write_addtid_b32 v181 offset:5184
    ds_write_addtid_b32 v182 offset:5472
    ds_write_addtid_b32 v183 offset:1152
    ds_write_addtid_b32 v184 offset:5760
    ds_write_addtid_b32 v185 offset:1440
    ds_write_addtid_b32 v186 offset:6048
    ds_write_addtid_b32 v187 offset:1728
    ds_write_addtid_b32 v188 offset:6336
    v_pk_mul_f32 v[132:133], v[138:139], v[136:137] op_sel:[0,0] op_sel_hi:[0,1]
    v_pk_fma_f32 v[138:139], v[138:139], v[136:137], v[132:133] op_sel:[1,1,0] op_sel_hi:[1,0,1] neg_lo:[1,0,0]
    v_cvt_pk_bf16_f32 v180, v138, v139
    v_pk_mul_f32 v[132:133], v[146:147], v[134:135] op_sel:[0,0] op_sel_hi:[0,1]
    v_pk_fma_f32 v[140:141], v[146:147], v[134:135], v[132:133] op_sel:[1,1,0] op_sel_hi:[1,0,1] neg_lo:[1,0,0]
    v_cvt_pk_bf16_f32 v181, v140, v141
    v_pk_mul_f32 v[132:133], v[138:139], v[136:137] op_sel:[0,0] op_sel_hi:[0,1]
    v_pk_fma_f32 v[138:139], v[138:139], v[136:137], v[132:133] op_sel:[1,1,0] op_sel_hi:[1,0,1] neg_lo:[1,0,0]
    v_cvt_pk_bf16_f32 v182, v138, v139
    v_pk_mul_f32 v[132:133], v[140:141], v[134:135] op_sel:[0,0] op_sel_hi:[0,1]
    v_pk_fma_f32 v[148:149], v[140:141], v[134:135], v[132:133] op_sel:[1,1,0] op_sel_hi:[1,0,1] neg_lo:[1,0,0]
    v_cvt_pk_bf16_f32 v183, v148, v149
    v_pk_mul_f32 v[132:133], v[138:139], v[136:137] op_sel:[0,0] op_sel_hi:[0,1]
    v_pk_fma_f32 v[138:139], v[138:139], v[136:137], v[132:133] op_sel:[1,1,0] op_sel_hi:[1,0,1] neg_lo:[1,0,0]
    v_cvt_pk_bf16_f32 v184, v138, v139
    v_pk_mul_f32 v[132:133], v[148:149], v[134:135] op_sel:[0,0] op_sel_hi:[0,1]
    v_pk_fma_f32 v[140:141], v[148:149], v[134:135], v[132:133] op_sel:[1,1,0] op_sel_hi:[1,0,1] neg_lo:[1,0,0]
    v_cvt_pk_bf16_f32 v185, v140, v141
    v_pk_mul_f32 v[132:133], v[138:139], v[136:137] op_sel:[0,0] op_sel_hi:[0,1]
    v_pk_fma_f32 v[138:139], v[138:139], v[136:137], v[132:133] op_sel:[1,1,0] op_sel_hi:[1,0,1] neg_lo:[1,0,0]
    v_cvt_pk_bf16_f32 v186, v138, v139
    v_pk_mul_f32 v[132:133], v[140:141], v[134:135] op_sel:[0,0] op_sel_hi:[0,1]
    v_pk_fma_f32 v[150:151], v[140:141], v[134:135], v[132:133] op_sel:[1,1,0] op_sel_hi:[1,0,1] neg_lo:[1,0,0]
    v_cvt_pk_bf16_f32 v187, v150, v151
    v_pk_mul_f32 v[132:133], v[138:139], v[136:137] op_sel:[0,0] op_sel_hi:[0,1]
    v_pk_fma_f32 v[138:139], v[138:139], v[136:137], v[132:133] op_sel:[1,1,0] op_sel_hi:[1,0,1] neg_lo:[1,0,0]
    v_cvt_pk_bf16_f32 v188, v138, v139
    ds_write_addtid_b32 v180 offset:2016
    ds_write_addtid_b32 v181 offset:6624
    ds_write_addtid_b32 v182 offset:2304
    ds_write_addtid_b32 v183 offset:6912
    ds_write_addtid_b32 v184 offset:2592
    ds_write_addtid_b32 v185 offset:7200
    ds_write_addtid_b32 v186 offset:2880
    ds_write_addtid_b32 v187 offset:7488
    ds_write_addtid_b32 v188 offset:3168
    v_pk_mul_f32 v[132:133], v[150:151], v[134:135] op_sel:[0,0] op_sel_hi:[0,1]
    v_pk_fma_f32 v[140:141], v[150:151], v[134:135], v[132:133] op_sel:[1,1,0] op_sel_hi:[1,0,1] neg_lo:[1,0,0]
    v_cvt_pk_bf16_f32 v180, v140, v141
    v_pk_mul_f32 v[132:133], v[138:139], v[136:137] op_sel:[0,0] op_sel_hi:[0,1]
    v_pk_fma_f32 v[138:139], v[138:139], v[136:137], v[132:133] op_sel:[1,1,0] op_sel_hi:[1,0,1] neg_lo:[1,0,0]
    v_cvt_pk_bf16_f32 v181, v138, v139
    v_pk_mul_f32 v[132:133], v[140:141], v[134:135] op_sel:[0,0] op_sel_hi:[0,1]
    v_pk_fma_f32 v[152:153], v[140:141], v[134:135], v[132:133] op_sel:[1,1,0] op_sel_hi:[1,0,1] neg_lo:[1,0,0]
    v_cvt_pk_bf16_f32 v182, v152, v153
    v_pk_mul_f32 v[132:133], v[138:139], v[136:137] op_sel:[0,0] op_sel_hi:[0,1]
    v_pk_fma_f32 v[138:139], v[138:139], v[136:137], v[132:133] op_sel:[1,1,0] op_sel_hi:[1,0,1] neg_lo:[1,0,0]
    v_cvt_pk_bf16_f32 v183, v138, v139
    v_pk_mul_f32 v[132:133], v[152:153], v[134:135] op_sel:[0,0] op_sel_hi:[0,1]
    v_pk_fma_f32 v[140:141], v[152:153], v[134:135], v[132:133] op_sel:[1,1,0] op_sel_hi:[1,0,1] neg_lo:[1,0,0]
    v_cvt_pk_bf16_f32 v184, v140, v141
    v_pk_mul_f32 v[132:133], v[138:139], v[136:137] op_sel:[0,0] op_sel_hi:[0,1]
    v_pk_fma_f32 v[138:139], v[138:139], v[136:137], v[132:133] op_sel:[1,1,0] op_sel_hi:[1,0,1] neg_lo:[1,0,0]
    v_cvt_pk_bf16_f32 v185, v138, v139
    v_pk_mul_f32 v[132:133], v[140:141], v[134:135] op_sel:[0,0] op_sel_hi:[0,1]
    v_pk_fma_f32 v[154:155], v[140:141], v[134:135], v[132:133] op_sel:[1,1,0] op_sel_hi:[1,0,1] neg_lo:[1,0,0]
    v_cvt_pk_bf16_f32 v186, v154, v155
    v_pk_mul_f32 v[132:133], v[138:139], v[136:137] op_sel:[0,0] op_sel_hi:[0,1]
    v_pk_fma_f32 v[138:139], v[138:139], v[136:137], v[132:133] op_sel:[1,1,0] op_sel_hi:[1,0,1] neg_lo:[1,0,0]
    v_cvt_pk_bf16_f32 v187, v138, v139
    v_pk_mul_f32 v[132:133], v[154:155], v[134:135] op_sel:[0,0] op_sel_hi:[0,1]
    v_pk_fma_f32 v[140:141], v[154:155], v[134:135], v[132:133] op_sel:[1,1,0] op_sel_hi:[1,0,1] neg_lo:[1,0,0]
    v_cvt_pk_bf16_f32 v188, v140, v141
    ds_write_addtid_b32 v180 offset:7776
    ds_write_addtid_b32 v181 offset:3456
    ds_write_addtid_b32 v182 offset:8064
    ds_write_addtid_b32 v183 offset:3744
    ds_write_addtid_b32 v184 offset:8352
    ds_write_addtid_b32 v185 offset:4032
    ds_write_addtid_b32 v186 offset:8640
    ds_write_addtid_b32 v187 offset:4320
    ds_write_addtid_b32 v188 offset:8928
    v_pk_mul_f32 v[132:133], v[162:163], v[148:149] op_sel:[0,0] op_sel_hi:[0,1]
    v_pk_fma_f32 v[138:139], v[162:163], v[148:149], v[132:133] op_sel:[1,1,0] op_sel_hi:[1,0,1] neg_lo:[1,0,0]
    v_cvt_pk_bf16_f32 v180, v138, v139
    v_pk_mul_f32 v[132:133], v[138:139], v[156:157] op_sel:[0,0] op_sel_hi:[0,1]
    v_pk_fma_f32 v[172:173], v[138:139], v[156:157], v[132:133] op_sel:[1,1,0] op_sel_hi:[1,0,1] neg_lo:[1,0,0]
    v_cvt_pk_bf16_f32 v181, v172, v173
    v_pk_mul_f32 v[132:133], v[138:139], v[158:159] op_sel:[0,0] op_sel_hi:[0,1]
    v_pk_fma_f32 v[172:173], v[138:139], v[158:159], v[132:133] op_sel:[1,1,0] op_sel_hi:[1,0,1] neg_lo:[1,0,0]
    v_cvt_pk_bf16_f32 v182, v172, v173
    ds_read_b128 v[192:195], v74 offset:0
    ds_read_b128 v[208:211], v74 offset:64
    ds_read_b128 v[224:227], v74 offset:128
    ds_read_b128 v[240:243], v74 offset:192
    v_pk_mul_f32 v[132:133], v[138:139], v[160:161] op_sel:[0,0] op_sel_hi:[0,1]
    v_pk_fma_f32 v[172:173], v[138:139], v[160:161], v[132:133] op_sel:[1,1,0] op_sel_hi:[1,0,1] neg_lo:[1,0,0]
    v_cvt_pk_bf16_f32 v183, v172, v173
    v_pk_mul_f32 v[132:133], v[156:157], v[142:143] op_sel:[0,0] op_sel_hi:[0,1]
    v_pk_fma_f32 v[172:173], v[156:157], v[142:143], v[132:133] op_sel:[1,1,0] op_sel_hi:[1,0,1] neg_lo:[1,0,0]
    v_cvt_pk_bf16_f32 v184, v172, v173
    v_pk_mul_f32 v[132:133], v[156:157], v[144:145] op_sel:[0,0] op_sel_hi:[0,1]
    v_pk_fma_f32 v[172:173], v[156:157], v[144:145], v[132:133] op_sel:[1,1,0] op_sel_hi:[1,0,1] neg_lo:[1,0,0]
    v_cvt_pk_bf16_f32 v185, v172, v173
    ds_read_b128 v[196:199], v74 offset:4608
    ds_read_b128 v[212:215], v74 offset:4672
    ds_read_b128 v[228:231], v74 offset:4736
    ds_read_b128 v[244:247], v74 offset:4800
    v_pk_mul_f32 v[132:133], v[156:157], v[146:147] op_sel:[0,0] op_sel_hi:[0,1]
    v_pk_fma_f32 v[172:173], v[156:157], v[146:147], v[132:133] op_sel:[1,1,0] op_sel_hi:[1,0,1] neg_lo:[1,0,0]
    v_cvt_pk_bf16_f32 v186, v172, v173
    v_pk_mul_f32 v[132:133], v[156:157], v[148:149] op_sel:[0,0] op_sel_hi:[0,1]
    v_pk_fma_f32 v[172:173], v[156:157], v[148:149], v[132:133] op_sel:[1,1,0] op_sel_hi:[1,0,1] neg_lo:[1,0,0]
    v_cvt_pk_bf16_f32 v187, v172, v173
    v_pk_mul_f32 v[132:133], v[156:157], v[150:151] op_sel:[0,0] op_sel_hi:[0,1]
    v_pk_fma_f32 v[172:173], v[156:157], v[150:151], v[132:133] op_sel:[1,1,0] op_sel_hi:[1,0,1] neg_lo:[1,0,0]
    v_cvt_pk_bf16_f32 v188, v172, v173
    ds_write_addtid_b32 v180 offset:13824
    ds_write_addtid_b32 v181 offset:14400
    ds_write_addtid_b32 v182 offset:14976
    ds_write_addtid_b32 v183 offset:15552
    ds_write_addtid_b32 v184 offset:9504
    ds_write_addtid_b32 v185 offset:9792
    ds_write_addtid_b32 v186 offset:10080
    ds_write_addtid_b32 v187 offset:10368
    ds_write_addtid_b32 v188 offset:10656
    v_pk_mul_f32 v[132:133], v[156:157], v[152:153] op_sel:[0,0] op_sel_hi:[0,1]
    v_pk_fma_f32 v[172:173], v[156:157], v[152:153], v[132:133] op_sel:[1,1,0] op_sel_hi:[1,0,1] neg_lo:[1,0,0]
    v_cvt_pk_bf16_f32 v180, v172, v173
    v_pk_mul_f32 v[132:133], v[156:157], v[154:155] op_sel:[0,0] op_sel_hi:[0,1]
    v_pk_fma_f32 v[172:173], v[156:157], v[154:155], v[132:133] op_sel:[1,1,0] op_sel_hi:[1,0,1] neg_lo:[1,0,0]
    v_cvt_pk_bf16_f32 v181, v172, v173
    v_pk_mul_f32 v[132:133], v[158:159], v[144:145] op_sel:[0,0] op_sel_hi:[0,1]
    v_pk_fma_f32 v[172:173], v[158:159], v[144:145], v[132:133] op_sel:[1,1,0] op_sel_hi:[1,0,1] neg_lo:[1,0,0]
    v_cvt_pk_bf16_f32 v182, v172, v173
    v_pk_mul_f32 v[132:133], v[158:159], v[148:149] op_sel:[0,0] op_sel_hi:[0,1]
    v_pk_fma_f32 v[172:173], v[158:159], v[148:149], v[132:133] op_sel:[1,1,0] op_sel_hi:[1,0,1] neg_lo:[1,0,0]
    v_cvt_pk_bf16_f32 v183, v172, v173
    ds_read_b128 v[204:207], v74 offset:13824
    ds_read_b128 v[220:223], v74 offset:13888
    ds_read_b128 v[236:239], v74 offset:13952
    ds_read_b128 v[252:255], v74 offset:14016
    v_pk_mul_f32 v[132:133], v[158:159], v[152:153] op_sel:[0,0] op_sel_hi:[0,1]
    v_pk_fma_f32 v[172:173], v[158:159], v[152:153], v[132:133] op_sel:[1,1,0] op_sel_hi:[1,0,1] neg_lo:[1,0,0]
    v_cvt_pk_bf16_f32 v184, v172, v173
    v_pk_mul_f32 v[132:133], v[160:161], v[144:145] op_sel:[0,0] op_sel_hi:[0,1]
    v_pk_fma_f32 v[172:173], v[160:161], v[144:145], v[132:133] op_sel:[1,1,0] op_sel_hi:[1,0,1] neg_lo:[1,0,0]
    v_cvt_pk_bf16_f32 v185, v172, v173
    v_pk_mul_f32 v[132:133], v[160:161], v[148:149] op_sel:[0,0] op_sel_hi:[0,1]
    v_pk_fma_f32 v[172:173], v[160:161], v[148:149], v[132:133] op_sel:[1,1,0] op_sel_hi:[1,0,1] neg_lo:[1,0,0]
    v_cvt_pk_bf16_f32 v186, v172, v173
    v_pk_mul_f32 v[132:133], v[160:161], v[152:153] op_sel:[0,0] op_sel_hi:[0,1]
    v_pk_fma_f32 v[172:173], v[160:161], v[152:153], v[132:133] op_sel:[1,1,0] op_sel_hi:[1,0,1] neg_lo:[1,0,0]
    v_cvt_pk_bf16_f32 v187, v172, v173
    ds_write_addtid_b32 v180 offset:10944
    ds_write_addtid_b32 v181 offset:11232
    ds_write_addtid_b32 v182 offset:11808
    ds_write_addtid_b32 v183 offset:12096
    ds_write_addtid_b32 v184 offset:12384
    ds_write_addtid_b32 v185 offset:12960
    ds_write_addtid_b32 v186 offset:13248
    ds_write_addtid_b32 v187 offset:13536
    ds_read_b128 v[200:203], v74 offset:9216
    ds_read_b128 v[216:219], v74 offset:9280
    ds_read_b128 v[232:235], v74 offset:9344
    ds_read_b128 v[248:251], v74 offset:9408
    v_perm_b32 v126, v53, v52, v66
    v_perm_b32 v127, v55, v54, v66
    v_perm_b32 v128, v57, v56, v66
    v_perm_b32 v129, v59, v58, v66
    v_perm_b32 v130, v61, v60, v66
    v_perm_b32 v131, v63, v62, v66
    v_pk_mul_f32 v[126:127], v[126:127], v[124:125] op_sel_hi:[1,0]
    v_pk_mul_f32 v[128:129], v[128:129], v[124:125] op_sel_hi:[1,0]
    v_pk_mul_f32 v[174:175], v[126:127], s[80:81]
    v_pk_mul_f32 v[176:177], v[126:127], s[82:83]
    v_pk_mul_f32 v[178:179], v[126:127], s[84:85]
    v_pk_mul_f32 v[132:133], v[130:131], v[128:129] op_sel:[0,0] op_sel_hi:[0,1]
    v_pk_fma_f32 v[40:41], v[130:131], v[128:129], v[132:133] op_sel:[1,1,0] op_sel_hi:[1,0,1] neg_lo:[1,0,0] neg_hi:[1,0,1]
    buffer_load_dwordx2 v[12:13], v37, s[40:43], s92 offen offset:0
    v_fract_f32 v175, v175
    v_fract_f32 v177, v177
    v_fract_f32 v179, v179
    v_exp_f32 v174, v174
    v_cos_f32 v134, v175
    v_sin_f32 v135, v175
    v_exp_f32 v176, v176
    v_cos_f32 v136, v177
    v_sin_f32 v137, v177
    v_exp_f32 v178, v178
    v_cos_f32 v156, v179
    v_sin_f32 v157, v179
    v_pk_mul_f32 v[134:135], v[134:135], v[174:175] op_sel_hi:[1,0]
    v_pk_mul_f32 v[136:137], v[136:137], v[176:177] op_sel_hi:[1,0] neg_hi:[1,0]
    v_pk_mul_f32 v[156:157], v[156:157], v[178:179] op_sel_hi:[1,0]
    v_pk_mul_f32 v[132:133], v[40:41], v[136:137] op_sel:[0,0] op_sel_hi:[0,1]
    v_pk_fma_f32 v[42:43], v[40:41], v[136:137], v[132:133] op_sel:[1,1,0] op_sel_hi:[1,0,1] neg_lo:[1,0,0]
    v_pk_mul_f32 v[132:133], v[42:43], v[136:137] op_sel:[0,0] op_sel_hi:[0,1]
    v_pk_fma_f32 v[44:45], v[42:43], v[136:137], v[132:133] op_sel:[1,1,0] op_sel_hi:[1,0,1] neg_lo:[1,0,0]
    v_pk_mul_f32 v[132:133], v[44:45], v[136:137] op_sel:[0,0] op_sel_hi:[0,1]
    v_pk_fma_f32 v[46:47], v[44:45], v[136:137], v[132:133] op_sel:[1,1,0] op_sel_hi:[1,0,1] neg_lo:[1,0,0]
    v_pk_mul_f32 v[132:133], v[156:157], v[156:157] op_sel:[0,0] op_sel_hi:[0,1]
    v_pk_fma_f32 v[158:159], v[156:157], v[156:157], v[132:133] op_sel:[1,1,0] op_sel_hi:[1,0,1] neg_lo:[1,0,0]
    v_pk_mul_f32 v[132:133], v[158:159], v[156:157] op_sel:[0,0] op_sel_hi:[0,1]
    v_pk_fma_f32 v[160:161], v[158:159], v[156:157], v[132:133] op_sel:[1,1,0] op_sel_hi:[1,0,1] neg_lo:[1,0,0]
    v_pk_mul_f32 v[132:133], v[158:159], v[158:159] op_sel:[0,0] op_sel_hi:[0,1]
    v_pk_fma_f32 v[162:163], v[158:159], v[158:159], v[132:133] op_sel:[1,1,0] op_sel_hi:[1,0,1] neg_lo:[1,0,0]
    v_pk_mul_f32 v[132:133], v[136:137], v[162:163] op_sel:[0,0] op_sel_hi:[0,1]
    v_pk_fma_f32 v[164:165], v[136:137], v[162:163], v[132:133] op_sel:[1,1,0] op_sel_hi:[1,0,1] neg_hi:[1,0,0]
    v_pk_mul_f32 v[132:133], v[164:165], v[156:157] op_sel:[0,0] op_sel_hi:[0,1]
    v_pk_fma_f32 v[166:167], v[164:165], v[156:157], v[132:133] op_sel:[1,1,0] op_sel_hi:[1,0,1] neg_lo:[1,0,0]
    v_pk_mul_f32 v[132:133], v[164:165], v[158:159] op_sel:[0,0] op_sel_hi:[0,1]
    v_pk_fma_f32 v[168:169], v[164:165], v[158:159], v[132:133] op_sel:[1,1,0] op_sel_hi:[1,0,1] neg_lo:[1,0,0]
    v_pk_mul_f32 v[132:133], v[164:165], v[160:161] op_sel:[0,0] op_sel_hi:[0,1]
    v_pk_fma_f32 v[170:171], v[164:165], v[160:161], v[132:133] op_sel:[1,1,0] op_sel_hi:[1,0,1] neg_lo:[1,0,0]
    v_cvt_pk_bf16_f32 v180, v40, v41
    v_cvt_pk_bf16_f32 v181, v42, v43
    v_cvt_pk_bf16_f32 v182, v44, v45
    s_waitcnt lgkmcnt(0)
    v_mfma_f32_16x16x32_bf16 v[112:115], v[196:199], v[192:195], 0
    ds_write_addtid_b32 v180 offset:0
    v_cvt_pk_bf16_f32 v183, v46, v47
    v_mfma_f32_16x16x32_bf16 v[116:119], v[200:203], v[192:195], 0
    ds_write_addtid_b32 v181 offset:288
    v_cvt_pk_bf16_f32 v184, v156, v157
    v_mfma_f32_16x16x32_bf16 v[120:123], v[204:207], v[192:195], 0
    ds_write_addtid_b32 v182 offset:576
    v_cvt_pk_bf16_f32 v185, v158, v159
    v_mfma_f32_16x16x32_bf16 v[112:115], v[212:215], v[208:211], v[112:115]
    ds_write_addtid_b32 v183 offset:864
    v_cvt_pk_bf16_f32 v186, v160, v161
    v_mfma_f32_16x16x32_bf16 v[116:119], v[216:219], v[208:211], v[116:119]
    ds_write_addtid_b32 v184 offset:9216
    v_cvt_pk_bf16_f32 v187, v162, v163
    v_mfma_f32_16x16x32_bf16 v[120:123], v[220:223], v[208:211], v[120:123]
    ds_write_addtid_b32 v185 offset:11520
    v_cvt_pk_bf16_f32 v188, v164, v165
    v_mfma_f32_16x16x32_bf16 v[112:115], v[228:231], v[224:227], v[112:115]
    ds_write_addtid_b32 v186 offset:12672
    v_cvt_pk_bf16_f32 v189, v166, v167
    v_mfma_f32_16x16x32_bf16 v[116:119], v[232:235], v[224:227], v[116:119]
    ds_write_addtid_b32 v187 offset:16128
    v_cvt_pk_bf16_f32 v190, v168, v169
    v_mfma_f32_16x16x32_bf16 v[120:123], v[236:239], v[224:227], v[120:123]
    ds_write_addtid_b32 v188 offset:14112
    v_cvt_pk_bf16_f32 v191, v170, v171
    v_mfma_f32_16x16x32_bf16 v[112:115], v[244:247], v[240:243], v[112:115]
    ds_write_addtid_b32 v189 offset:14688
    v_mfma_f32_16x16x32_bf16 v[116:119], v[248:251], v[240:243], v[116:119]
    ds_write_addtid_b32 v190 offset:15264
    v_mfma_f32_16x16x32_bf16 v[120:123], v[252:255], v[240:243], v[120:123]
    s_nop 0
    ds_write_addtid_b32 v191 offset:15840
    v_cvt_pk_bf16_f32 v180, v134, v135
    v_pk_mul_f32 v[132:133], v[134:135], v[134:135] op_sel:[0,0] op_sel_hi:[0,1]
    v_pk_fma_f32 v[142:143], v[134:135], v[134:135], v[132:133] op_sel:[1,1,0] op_sel_hi:[1,0,1] neg_lo:[1,0,0]
    v_cvt_pk_bf16_f32 v181, v142, v143
    v_pk_mul_f32 v[132:133], v[142:143], v[134:135] op_sel:[0,0] op_sel_hi:[0,1]
    v_pk_fma_f32 v[140:141], v[142:143], v[134:135], v[132:133] op_sel:[1,1,0] op_sel_hi:[1,0,1] neg_lo:[1,0,0]
    v_cvt_pk_bf16_f32 v182, v140, v141
    v_pk_mul_f32 v[132:133], v[46:47], v[136:137] op_sel:[0,0] op_sel_hi:[0,1]
    v_pk_fma_f32 v[138:139], v[46:47], v[136:137], v[132:133] op_sel:[1,1,0] op_sel_hi:[1,0,1] neg_lo:[1,0,0]
    v_cvt_pk_bf16_f32 v183, v138, v139
    v_pk_mul_f32 v[132:133], v[140:141], v[134:135] op_sel:[0,0] op_sel_hi:[0,1]
    v_pk_fma_f32 v[144:145], v[140:141], v[134:135], v[132:133] op_sel:[1,1,0] op_sel_hi:[1,0,1] neg_lo:[1,0,0]
    v_cvt_pk_bf16_f32 v184, v144, v145
    v_pk_mul_f32 v[132:133], v[138:139], v[136:137] op_sel:[0,0] op_sel_hi:[0,1]
    v_pk_fma_f32 v[138:139], v[138:139], v[136:137], v[132:133] op_sel:[1,1,0] op_sel_hi:[1,0,1] neg_lo:[1,0,0]
    v_cvt_pk_bf16_f32 v185, v138, v139
    v_pk_mul_f32 v[132:133], v[144:145], v[134:135] op_sel:[0,0] op_sel_hi:[0,1]
    v_pk_fma_f32 v[140:141], v[144:145], v[134:135], v[132:133] op_sel:[1,1,0] op_sel_hi:[1,0,1] neg_lo:[1,0,0]
    v_cvt_pk_bf16_f32 v186, v140, v141
    v_pk_mul_f32 v[132:133], v[138:139], v[136:137] op_sel:[0,0] op_sel_hi:[0,1]
    v_pk_fma_f32 v[138:139], v[138:139], v[136:137], v[132:133] op_sel:[1,1,0] op_sel_hi:[1,0,1] neg_lo:[1,0,0]
    v_cvt_pk_bf16_f32 v187, v138, v139
    v_pk_mul_f32 v[132:133], v[140:141], v[134:135] op_sel:[0,0] op_sel_hi:[0,1]
    v_pk_fma_f32 v[146:147], v[140:141], v[134:135], v[132:133] op_sel:[1,1,0] op_sel_hi:[1,0,1] neg_lo:[1,0,0]
    v_cvt_pk_bf16_f32 v188, v146, v147
    ds_write_addtid_b32 v180 offset:4896
    ds_write_addtid_b32 v181 offset:5184
    ds_write_addtid_b32 v182 offset:5472
    ds_write_addtid_b32 v183 offset:1152
    ds_write_addtid_b32 v184 offset:5760
    ds_write_addtid_b32 v185 offset:1440
    ds_write_addtid_b32 v186 offset:6048
    ds_write_addtid_b32 v187 offset:1728
    ds_write_addtid_b32 v188 offset:6336
    v_pk_mul_f32 v[132:133], v[138:139], v[136:137] op_sel:[0,0] op_sel_hi:[0,1]
    v_pk_fma_f32 v[138:139], v[138:139], v[136:137], v[132:133] op_sel:[1,1,0] op_sel_hi:[1,0,1] neg_lo:[1,0,0]
    v_cvt_pk_bf16_f32 v180, v138, v139
    v_pk_mul_f32 v[132:133], v[146:147], v[134:135] op_sel:[0,0] op_sel_hi:[0,1]
    v_pk_fma_f32 v[140:141], v[146:147], v[134:135], v[132:133] op_sel:[1,1,0] op_sel_hi:[1,0,1] neg_lo:[1,0,0]
    v_cvt_pk_bf16_f32 v181, v140, v141
    v_pk_mul_f32 v[132:133], v[138:139], v[136:137] op_sel:[0,0] op_sel_hi:[0,1]
    v_pk_fma_f32 v[138:139], v[138:139], v[136:137], v[132:133] op_sel:[1,1,0] op_sel_hi:[1,0,1] neg_lo:[1,0,0]
    v_cvt_pk_bf16_f32 v182, v138, v139
    v_pk_mul_f32 v[132:133], v[140:141], v[134:135] op_sel:[0,0] op_sel_hi:[0,1]
    v_pk_fma_f32 v[148:149], v[140:141], v[134:135], v[132:133] op_sel:[1,1,0] op_sel_hi:[1,0,1] neg_lo:[1,0,0]
    v_cvt_pk_bf16_f32 v183, v148, v149
    v_pk_mul_f32 v[132:133], v[138:139], v[136:137] op_sel:[0,0] op_sel_hi:[0,1]
    v_pk_fma_f32 v[138:139], v[138:139], v[136:137], v[132:133] op_sel:[1,1,0] op_sel_hi:[1,0,1] neg_lo:[1,0,0]
    v_cvt_pk_bf16_f32 v184, v138, v139
    v_pk_mul_f32 v[132:133], v[148:149], v[134:135] op_sel:[0,0] op_sel_hi:[0,1]
    v_pk_fma_f32 v[140:141], v[148:149], v[134:135], v[132:133] op_sel:[1,1,0] op_sel_hi:[1,0,1] neg_lo:[1,0,0]
    v_cvt_pk_bf16_f32 v185, v140, v141
    v_pk_mul_f32 v[132:133], v[138:139], v[136:137] op_sel:[0,0] op_sel_hi:[0,1]
    v_pk_fma_f32 v[138:139], v[138:139], v[136:137], v[132:133] op_sel:[1,1,0] op_sel_hi:[1,0,1] neg_lo:[1,0,0]
    v_cvt_pk_bf16_f32 v186, v138, v139
    v_pk_mul_f32 v[132:133], v[140:141], v[134:135] op_sel:[0,0] op_sel_hi:[0,1]
    v_pk_fma_f32 v[150:151], v[140:141], v[134:135], v[132:133] op_sel:[1,1,0] op_sel_hi:[1,0,1] neg_lo:[1,0,0]
    v_cvt_pk_bf16_f32 v187, v150, v151
    v_pk_mul_f32 v[132:133], v[138:139], v[136:137] op_sel:[0,0] op_sel_hi:[0,1]
    v_pk_fma_f32 v[138:139], v[138:139], v[136:137], v[132:133] op_sel:[1,1,0] op_sel_hi:[1,0,1] neg_lo:[1,0,0]
    v_cvt_pk_bf16_f32 v188, v138, v139
    ds_write_addtid_b32 v180 offset:2016
    ds_write_addtid_b32 v181 offset:6624
    ds_write_addtid_b32 v182 offset:2304
    ds_write_addtid_b32 v183 offset:6912
    ds_write_addtid_b32 v184 offset:2592
    ds_write_addtid_b32 v185 offset:7200
    ds_write_addtid_b32 v186 offset:2880
    ds_write_addtid_b32 v187 offset:7488
    ds_write_addtid_b32 v188 offset:3168
    buffer_load_dwordx2 v[14:15], v37, s[40:43], s92 offen offset:1280
    s_add_u32 s92, s92, 655360
    v_pk_mul_f32 v[132:133], v[150:151], v[134:135] op_sel:[0,0] op_sel_hi:[0,1]
    v_pk_fma_f32 v[140:141], v[150:151], v[134:135], v[132:133] op_sel:[1,1,0] op_sel_hi:[1,0,1] neg_lo:[1,0,0]
    v_cvt_pk_bf16_f32 v180, v140, v141
    v_pk_mul_f32 v[132:133], v[138:139], v[136:137] op_sel:[0,0] op_sel_hi:[0,1]
    v_pk_fma_f32 v[138:139], v[138:139], v[136:137], v[132:133] op_sel:[1,1,0] op_sel_hi:[1,0,1] neg_lo:[1,0,0]
    v_cvt_pk_bf16_f32 v181, v138, v139
    v_pk_mul_f32 v[132:133], v[140:141], v[134:135] op_sel:[0,0] op_sel_hi:[0,1]
    v_pk_fma_f32 v[152:153], v[140:141], v[134:135], v[132:133] op_sel:[1,1,0] op_sel_hi:[1,0,1] neg_lo:[1,0,0]
    v_cvt_pk_bf16_f32 v182, v152, v153
    v_pk_mul_f32 v[132:133], v[138:139], v[136:137] op_sel:[0,0] op_sel_hi:[0,1]
    v_pk_fma_f32 v[138:139], v[138:139], v[136:137], v[132:133] op_sel:[1,1,0] op_sel_hi:[1,0,1] neg_lo:[1,0,0]
    v_cvt_pk_bf16_f32 v183, v138, v139
    v_pk_mul_f32 v[132:133], v[152:153], v[134:135] op_sel:[0,0] op_sel_hi:[0,1]
    v_pk_fma_f32 v[140:141], v[152:153], v[134:135], v[132:133] op_sel:[1,1,0] op_sel_hi:[1,0,1] neg_lo:[1,0,0]
    v_cvt_pk_bf16_f32 v184, v140, v141
    v_pk_mul_f32 v[132:133], v[138:139], v[136:137] op_sel:[0,0] op_sel_hi:[0,1]
    v_pk_fma_f32 v[138:139], v[138:139], v[136:137], v[132:133] op_sel:[1,1,0] op_sel_hi:[1,0,1] neg_lo:[1,0,0]
    v_cvt_pk_bf16_f32 v185, v138, v139
    v_pk_mul_f32 v[132:133], v[140:141], v[134:135] op_sel:[0,0] op_sel_hi:[0,1]
    v_pk_fma_f32 v[154:155], v[140:141], v[134:135], v[132:133] op_sel:[1,1,0] op_sel_hi:[1,0,1] neg_lo:[1,0,0]
    v_cvt_pk_bf16_f32 v186, v154, v155
    v_pk_mul_f32 v[132:133], v[138:139], v[136:137] op_sel:[0,0] op_sel_hi:[0,1]
    v_pk_fma_f32 v[138:139], v[138:139], v[136:137], v[132:133] op_sel:[1,1,0] op_sel_hi:[1,0,1] neg_lo:[1,0,0]
    v_cvt_pk_bf16_f32 v187, v138, v139
    v_pk_mul_f32 v[132:133], v[154:155], v[134:135] op_sel:[0,0] op_sel_hi:[0,1]
    v_pk_fma_f32 v[140:141], v[154:155], v[134:135], v[132:133] op_sel:[1,1,0] op_sel_hi:[1,0,1] neg_lo:[1,0,0]
    v_cvt_pk_bf16_f32 v188, v140, v141
    ds_write_addtid_b32 v180 offset:7776
    ds_write_addtid_b32 v181 offset:3456
    ds_write_addtid_b32 v182 offset:8064
    ds_write_addtid_b32 v183 offset:3744
    ds_write_addtid_b32 v184 offset:8352
    ds_write_addtid_b32 v185 offset:4032
    ds_write_addtid_b32 v186 offset:8640
    ds_write_addtid_b32 v187 offset:4320
    ds_write_addtid_b32 v188 offset:8928
    v_pk_mul_f32 v[132:133], v[162:163], v[148:149] op_sel:[0,0] op_sel_hi:[0,1]
    v_pk_fma_f32 v[138:139], v[162:163], v[148:149], v[132:133] op_sel:[1,1,0] op_sel_hi:[1,0,1] neg_lo:[1,0,0]
    v_cvt_pk_bf16_f32 v180, v138, v139
    v_pk_mul_f32 v[132:133], v[138:139], v[156:157] op_sel:[0,0] op_sel_hi:[0,1]
    v_pk_fma_f32 v[172:173], v[138:139], v[156:157], v[132:133] op_sel:[1,1,0] op_sel_hi:[1,0,1] neg_lo:[1,0,0]
    v_cvt_pk_bf16_f32 v181, v172, v173
    v_pk_mul_f32 v[132:133], v[138:139], v[158:159] op_sel:[0,0] op_sel_hi:[0,1]
    v_pk_fma_f32 v[172:173], v[138:139], v[158:159], v[132:133] op_sel:[1,1,0] op_sel_hi:[1,0,1] neg_lo:[1,0,0]
    v_cvt_pk_bf16_f32 v182, v172, v173
    ds_read_b128 v[192:195], v74 offset:0
    ds_read_b128 v[208:211], v74 offset:64
    ds_read_b128 v[224:227], v74 offset:128
    ds_read_b128 v[240:243], v74 offset:192
    v_pk_mul_f32 v[132:133], v[138:139], v[160:161] op_sel:[0,0] op_sel_hi:[0,1]
    v_pk_fma_f32 v[172:173], v[138:139], v[160:161], v[132:133] op_sel:[1,1,0] op_sel_hi:[1,0,1] neg_lo:[1,0,0]
    v_cvt_pk_bf16_f32 v183, v172, v173
    v_pk_mul_f32 v[132:133], v[156:157], v[142:143] op_sel:[0,0] op_sel_hi:[0,1]
    v_pk_fma_f32 v[172:173], v[156:157], v[142:143], v[132:133] op_sel:[1,1,0] op_sel_hi:[1,0,1] neg_lo:[1,0,0]
    v_cvt_pk_bf16_f32 v184, v172, v173
    v_pk_mul_f32 v[132:133], v[156:157], v[144:145] op_sel:[0,0] op_sel_hi:[0,1]
    v_pk_fma_f32 v[172:173], v[156:157], v[144:145], v[132:133] op_sel:[1,1,0] op_sel_hi:[1,0,1] neg_lo:[1,0,0]
    v_cvt_pk_bf16_f32 v185, v172, v173
    ds_read_b128 v[196:199], v74 offset:4608
    ds_read_b128 v[212:215], v74 offset:4672
    ds_read_b128 v[228:231], v74 offset:4736
    ds_read_b128 v[244:247], v74 offset:4800
    v_pk_mul_f32 v[132:133], v[156:157], v[146:147] op_sel:[0,0] op_sel_hi:[0,1]
    v_pk_fma_f32 v[172:173], v[156:157], v[146:147], v[132:133] op_sel:[1,1,0] op_sel_hi:[1,0,1] neg_lo:[1,0,0]
    v_cvt_pk_bf16_f32 v186, v172, v173
    v_pk_mul_f32 v[132:133], v[156:157], v[148:149] op_sel:[0,0] op_sel_hi:[0,1]
    v_pk_fma_f32 v[172:173], v[156:157], v[148:149], v[132:133] op_sel:[1,1,0] op_sel_hi:[1,0,1] neg_lo:[1,0,0]
    v_cvt_pk_bf16_f32 v187, v172, v173
    v_pk_mul_f32 v[132:133], v[156:157], v[150:151] op_sel:[0,0] op_sel_hi:[0,1]
    v_pk_fma_f32 v[172:173], v[156:157], v[150:151], v[132:133] op_sel:[1,1,0] op_sel_hi:[1,0,1] neg_lo:[1,0,0]
    v_cvt_pk_bf16_f32 v188, v172, v173
    ds_write_addtid_b32 v180 offset:13824
    ds_write_addtid_b32 v181 offset:14400
    ds_write_addtid_b32 v182 offset:14976
    ds_write_addtid_b32 v183 offset:15552
    ds_write_addtid_b32 v184 offset:9504
    ds_write_addtid_b32 v185 offset:9792
    ds_write_addtid_b32 v186 offset:10080
    ds_write_addtid_b32 v187 offset:10368
    ds_write_addtid_b32 v188 offset:10656
    v_pk_mul_f32 v[132:133], v[156:157], v[152:153] op_sel:[0,0] op_sel_hi:[0,1]
    v_pk_fma_f32 v[172:173], v[156:157], v[152:153], v[132:133] op_sel:[1,1,0] op_sel_hi:[1,0,1] neg_lo:[1,0,0]
    v_cvt_pk_bf16_f32 v180, v172, v173
    v_pk_mul_f32 v[132:133], v[156:157], v[154:155] op_sel:[0,0] op_sel_hi:[0,1]
    v_pk_fma_f32 v[172:173], v[156:157], v[154:155], v[132:133] op_sel:[1,1,0] op_sel_hi:[1,0,1] neg_lo:[1,0,0]
    v_cvt_pk_bf16_f32 v181, v172, v173
    v_pk_mul_f32 v[132:133], v[158:159], v[144:145] op_sel:[0,0] op_sel_hi:[0,1]
    v_pk_fma_f32 v[172:173], v[158:159], v[144:145], v[132:133] op_sel:[1,1,0] op_sel_hi:[1,0,1] neg_lo:[1,0,0]
    v_cvt_pk_bf16_f32 v182, v172, v173
    v_pk_mul_f32 v[132:133], v[158:159], v[148:149] op_sel:[0,0] op_sel_hi:[0,1]
    v_pk_fma_f32 v[172:173], v[158:159], v[148:149], v[132:133] op_sel:[1,1,0] op_sel_hi:[1,0,1] neg_lo:[1,0,0]
    v_cvt_pk_bf16_f32 v183, v172, v173
    ds_read_b128 v[204:207], v74 offset:13824
    ds_read_b128 v[220:223], v74 offset:13888
    ds_read_b128 v[236:239], v74 offset:13952
    ds_read_b128 v[252:255], v74 offset:14016
    v_pk_mul_f32 v[132:133], v[158:159], v[152:153] op_sel:[0,0] op_sel_hi:[0,1]
    v_pk_fma_f32 v[172:173], v[158:159], v[152:153], v[132:133] op_sel:[1,1,0] op_sel_hi:[1,0,1] neg_lo:[1,0,0]
    v_cvt_pk_bf16_f32 v184, v172, v173
    v_pk_mul_f32 v[132:133], v[160:161], v[144:145] op_sel:[0,0] op_sel_hi:[0,1]
    v_pk_fma_f32 v[172:173], v[160:161], v[144:145], v[132:133] op_sel:[1,1,0] op_sel_hi:[1,0,1] neg_lo:[1,0,0]
    v_cvt_pk_bf16_f32 v185, v172, v173
    v_pk_mul_f32 v[132:133], v[160:161], v[148:149] op_sel:[0,0] op_sel_hi:[0,1]
    v_pk_fma_f32 v[172:173], v[160:161], v[148:149], v[132:133] op_sel:[1,1,0] op_sel_hi:[1,0,1] neg_lo:[1,0,0]
    v_cvt_pk_bf16_f32 v186, v172, v173
    v_pk_mul_f32 v[132:133], v[160:161], v[152:153] op_sel:[0,0] op_sel_hi:[0,1]
    v_pk_fma_f32 v[172:173], v[160:161], v[152:153], v[132:133] op_sel:[1,1,0] op_sel_hi:[1,0,1] neg_lo:[1,0,0]
    v_cvt_pk_bf16_f32 v187, v172, v173
    ds_write_addtid_b32 v180 offset:10944
    ds_write_addtid_b32 v181 offset:11232
    ds_write_addtid_b32 v182 offset:11808
    ds_write_addtid_b32 v183 offset:12096
    ds_write_addtid_b32 v184 offset:12384
    ds_write_addtid_b32 v185 offset:12960
    ds_write_addtid_b32 v186 offset:13248
    ds_write_addtid_b32 v187 offset:13536
    ds_read_b128 v[200:203], v74 offset:9216
    ds_read_b128 v[216:219], v74 offset:9280
    ds_read_b128 v[232:235], v74 offset:9344
    ds_read_b128 v[248:251], v74 offset:9408
    v_perm_b32 v126, v53, v52, v67
    v_perm_b32 v127, v55, v54, v67
    v_perm_b32 v128, v57, v56, v67
    v_perm_b32 v129, v59, v58, v67
    v_perm_b32 v130, v61, v60, v67
    buffer_load_dwordx2 v[16:17], v37, s[40:43], s92 offen offset:0
    v_perm_b32 v131, v63, v62, v67
    v_pk_mul_f32 v[126:127], v[126:127], v[124:125] op_sel_hi:[1,0]
    v_pk_mul_f32 v[128:129], v[128:129], v[124:125] op_sel_hi:[1,0]
    v_pk_mul_f32 v[174:175], v[126:127], s[80:81]
    v_pk_mul_f32 v[176:177], v[126:127], s[82:83]
    v_pk_mul_f32 v[178:179], v[126:127], s[84:85]
    v_pk_mul_f32 v[132:133], v[130:131], v[128:129] op_sel:[0,0] op_sel_hi:[0,1]
    v_pk_fma_f32 v[40:41], v[130:131], v[128:129], v[132:133] op_sel:[1,1,0] op_sel_hi:[1,0,1] neg_lo:[1,0,0] neg_hi:[1,0,1]
    v_fract_f32 v175, v175
    v_fract_f32 v177, v177
    v_fract_f32 v179, v179
    v_exp_f32 v174, v174
    v_cos_f32 v134, v175
    v_sin_f32 v135, v175
    v_exp_f32 v176, v176
    v_cos_f32 v136, v177
    v_sin_f32 v137, v177
    v_exp_f32 v178, v178
    v_cos_f32 v156, v179
    v_sin_f32 v157, v179
    v_pk_mul_f32 v[134:135], v[134:135], v[174:175] op_sel_hi:[1,0]
    v_pk_mul_f32 v[136:137], v[136:137], v[176:177] op_sel_hi:[1,0] neg_hi:[1,0]
    v_pk_mul_f32 v[156:157], v[156:157], v[178:179] op_sel_hi:[1,0]
    v_pk_mul_f32 v[132:133], v[40:41], v[136:137] op_sel:[0,0] op_sel_hi:[0,1]
    v_pk_fma_f32 v[42:43], v[40:41], v[136:137], v[132:133] op_sel:[1,1,0] op_sel_hi:[1,0,1] neg_lo:[1,0,0]
    v_pk_mul_f32 v[132:133], v[42:43], v[136:137] op_sel:[0,0] op_sel_hi:[0,1]
    v_pk_fma_f32 v[44:45], v[42:43], v[136:137], v[132:133] op_sel:[1,1,0] op_sel_hi:[1,0,1] neg_lo:[1,0,0]
    v_pk_mul_f32 v[132:133], v[44:45], v[136:137] op_sel:[0,0] op_sel_hi:[0,1]
    v_pk_fma_f32 v[46:47], v[44:45], v[136:137], v[132:133] op_sel:[1,1,0] op_sel_hi:[1,0,1] neg_lo:[1,0,0]
    v_pk_mul_f32 v[132:133], v[156:157], v[156:157] op_sel:[0,0] op_sel_hi:[0,1]
    v_pk_fma_f32 v[158:159], v[156:157], v[156:157], v[132:133] op_sel:[1,1,0] op_sel_hi:[1,0,1] neg_lo:[1,0,0]
    v_pk_mul_f32 v[132:133], v[158:159], v[156:157] op_sel:[0,0] op_sel_hi:[0,1]
    v_pk_fma_f32 v[160:161], v[158:159], v[156:157], v[132:133] op_sel:[1,1,0] op_sel_hi:[1,0,1] neg_lo:[1,0,0]
    v_pk_mul_f32 v[132:133], v[158:159], v[158:159] op_sel:[0,0] op_sel_hi:[0,1]
    v_pk_fma_f32 v[162:163], v[158:159], v[158:159], v[132:133] op_sel:[1,1,0] op_sel_hi:[1,0,1] neg_lo:[1,0,0]
    v_pk_mul_f32 v[132:133], v[136:137], v[162:163] op_sel:[0,0] op_sel_hi:[0,1]
    v_pk_fma_f32 v[164:165], v[136:137], v[162:163], v[132:133] op_sel:[1,1,0] op_sel_hi:[1,0,1] neg_hi:[1,0,0]
    v_pk_mul_f32 v[132:133], v[164:165], v[156:157] op_sel:[0,0] op_sel_hi:[0,1]
    v_pk_fma_f32 v[166:167], v[164:165], v[156:157], v[132:133] op_sel:[1,1,0] op_sel_hi:[1,0,1] neg_lo:[1,0,0]
    v_pk_mul_f32 v[132:133], v[164:165], v[158:159] op_sel:[0,0] op_sel_hi:[0,1]
    v_pk_fma_f32 v[168:169], v[164:165], v[158:159], v[132:133] op_sel:[1,1,0] op_sel_hi:[1,0,1] neg_lo:[1,0,0]
    v_pk_mul_f32 v[132:133], v[164:165], v[160:161] op_sel:[0,0] op_sel_hi:[0,1]
    v_pk_fma_f32 v[170:171], v[164:165], v[160:161], v[132:133] op_sel:[1,1,0] op_sel_hi:[1,0,1] neg_lo:[1,0,0]
    v_cvt_pk_bf16_f32 v180, v40, v41
    v_cvt_pk_bf16_f32 v181, v42, v43
    v_cvt_pk_bf16_f32 v182, v44, v45
    s_waitcnt lgkmcnt(0)
    v_mfma_f32_16x16x32_bf16 v[112:115], v[196:199], v[192:195], v[112:115]
    ds_write_addtid_b32 v180 offset:0
    v_cvt_pk_bf16_f32 v183, v46, v47
    v_mfma_f32_16x16x32_bf16 v[116:119], v[200:203], v[192:195], v[116:119]
    ds_write_addtid_b32 v181 offset:288
    v_cvt_pk_bf16_f32 v184, v156, v157
    v_mfma_f32_16x16x32_bf16 v[120:123], v[204:207], v[192:195], v[120:123]
    ds_write_addtid_b32 v182 offset:576
    v_cvt_pk_bf16_f32 v185, v158, v159
    v_mfma_f32_16x16x32_bf16 v[112:115], v[212:215], v[208:211], v[112:115]
    ds_write_addtid_b32 v183 offset:864
    v_cvt_pk_bf16_f32 v186, v160, v161
    v_mfma_f32_16x16x32_bf16 v[116:119], v[216:219], v[208:211], v[116:119]
    ds_write_addtid_b32 v184 offset:9216
    v_cvt_pk_bf16_f32 v187, v162, v163
    v_mfma_f32_16x16x32_bf16 v[120:123], v[220:223], v[208:211], v[120:123]
    ds_write_addtid_b32 v185 offset:11520
    v_cvt_pk_bf16_f32 v188, v164, v165
    v_mfma_f32_16x16x32_bf16 v[112:115], v[228:231], v[224:227], v[112:115]
    ds_write_addtid_b32 v186 offset:12672
    v_cvt_pk_bf16_f32 v189, v166, v167
    v_mfma_f32_16x16x32_bf16 v[116:119], v[232:235], v[224:227], v[116:119]
    ds_write_addtid_b32 v187 offset:16128
    v_cvt_pk_bf16_f32 v190, v168, v169
    v_mfma_f32_16x16x32_bf16 v[120:123], v[236:239], v[224:227], v[120:123]
    ds_write_addtid_b32 v188 offset:14112
    v_cvt_pk_bf16_f32 v191, v170, v171
    v_mfma_f32_16x16x32_bf16 v[112:115], v[244:247], v[240:243], v[112:115]
    ds_write_addtid_b32 v189 offset:14688
    v_mfma_f32_16x16x32_bf16 v[116:119], v[248:251], v[240:243], v[116:119]
    ds_write_addtid_b32 v190 offset:15264
    v_mfma_f32_16x16x32_bf16 v[120:123], v[252:255], v[240:243], v[120:123]
    s_nop 0
    ds_write_addtid_b32 v191 offset:15840
    v_cvt_pk_bf16_f32 v180, v134, v135
    v_pk_mul_f32 v[132:133], v[134:135], v[134:135] op_sel:[0,0] op_sel_hi:[0,1]
    v_pk_fma_f32 v[142:143], v[134:135], v[134:135], v[132:133] op_sel:[1,1,0] op_sel_hi:[1,0,1] neg_lo:[1,0,0]
    v_cvt_pk_bf16_f32 v181, v142, v143
    v_pk_mul_f32 v[132:133], v[142:143], v[134:135] op_sel:[0,0] op_sel_hi:[0,1]
    v_pk_fma_f32 v[140:141], v[142:143], v[134:135], v[132:133] op_sel:[1,1,0] op_sel_hi:[1,0,1] neg_lo:[1,0,0]
    v_cvt_pk_bf16_f32 v182, v140, v141
    v_pk_mul_f32 v[132:133], v[46:47], v[136:137] op_sel:[0,0] op_sel_hi:[0,1]
    v_pk_fma_f32 v[138:139], v[46:47], v[136:137], v[132:133] op_sel:[1,1,0] op_sel_hi:[1,0,1] neg_lo:[1,0,0]
    v_cvt_pk_bf16_f32 v183, v138, v139
    v_pk_mul_f32 v[132:133], v[140:141], v[134:135] op_sel:[0,0] op_sel_hi:[0,1]
    v_pk_fma_f32 v[144:145], v[140:141], v[134:135], v[132:133] op_sel:[1,1,0] op_sel_hi:[1,0,1] neg_lo:[1,0,0]
    v_cvt_pk_bf16_f32 v184, v144, v145
    v_pk_mul_f32 v[132:133], v[138:139], v[136:137] op_sel:[0,0] op_sel_hi:[0,1]
    v_pk_fma_f32 v[138:139], v[138:139], v[136:137], v[132:133] op_sel:[1,1,0] op_sel_hi:[1,0,1] neg_lo:[1,0,0]
    v_cvt_pk_bf16_f32 v185, v138, v139
    v_pk_mul_f32 v[132:133], v[144:145], v[134:135] op_sel:[0,0] op_sel_hi:[0,1]
    v_pk_fma_f32 v[140:141], v[144:145], v[134:135], v[132:133] op_sel:[1,1,0] op_sel_hi:[1,0,1] neg_lo:[1,0,0]
    v_cvt_pk_bf16_f32 v186, v140, v141
    v_pk_mul_f32 v[132:133], v[138:139], v[136:137] op_sel:[0,0] op_sel_hi:[0,1]
    v_pk_fma_f32 v[138:139], v[138:139], v[136:137], v[132:133] op_sel:[1,1,0] op_sel_hi:[1,0,1] neg_lo:[1,0,0]
    v_cvt_pk_bf16_f32 v187, v138, v139
    v_pk_mul_f32 v[132:133], v[140:141], v[134:135] op_sel:[0,0] op_sel_hi:[0,1]
    v_pk_fma_f32 v[146:147], v[140:141], v[134:135], v[132:133] op_sel:[1,1,0] op_sel_hi:[1,0,1] neg_lo:[1,0,0]
    v_cvt_pk_bf16_f32 v188, v146, v147
    ds_write_addtid_b32 v180 offset:4896
    ds_write_addtid_b32 v181 offset:5184
    ds_write_addtid_b32 v182 offset:5472
    ds_write_addtid_b32 v183 offset:1152
    ds_write_addtid_b32 v184 offset:5760
    ds_write_addtid_b32 v185 offset:1440
    ds_write_addtid_b32 v186 offset:6048
    ds_write_addtid_b32 v187 offset:1728
    ds_write_addtid_b32 v188 offset:6336
    v_pk_mul_f32 v[132:133], v[138:139], v[136:137] op_sel:[0,0] op_sel_hi:[0,1]
    v_pk_fma_f32 v[138:139], v[138:139], v[136:137], v[132:133] op_sel:[1,1,0] op_sel_hi:[1,0,1] neg_lo:[1,0,0]
    v_cvt_pk_bf16_f32 v180, v138, v139
    v_pk_mul_f32 v[132:133], v[146:147], v[134:135] op_sel:[0,0] op_sel_hi:[0,1]
    v_pk_fma_f32 v[140:141], v[146:147], v[134:135], v[132:133] op_sel:[1,1,0] op_sel_hi:[1,0,1] neg_lo:[1,0,0]
    v_cvt_pk_bf16_f32 v181, v140, v141
    v_pk_mul_f32 v[132:133], v[138:139], v[136:137] op_sel:[0,0] op_sel_hi:[0,1]
    v_pk_fma_f32 v[138:139], v[138:139], v[136:137], v[132:133] op_sel:[1,1,0] op_sel_hi:[1,0,1] neg_lo:[1,0,0]
    v_cvt_pk_bf16_f32 v182, v138, v139
    v_pk_mul_f32 v[132:133], v[140:141], v[134:135] op_sel:[0,0] op_sel_hi:[0,1]
    v_pk_fma_f32 v[148:149], v[140:141], v[134:135], v[132:133] op_sel:[1,1,0] op_sel_hi:[1,0,1] neg_lo:[1,0,0]
    v_cvt_pk_bf16_f32 v183, v148, v149
    v_pk_mul_f32 v[132:133], v[138:139], v[136:137] op_sel:[0,0] op_sel_hi:[0,1]
    v_pk_fma_f32 v[138:139], v[138:139], v[136:137], v[132:133] op_sel:[1,1,0] op_sel_hi:[1,0,1] neg_lo:[1,0,0]
    v_cvt_pk_bf16_f32 v184, v138, v139
    v_pk_mul_f32 v[132:133], v[148:149], v[134:135] op_sel:[0,0] op_sel_hi:[0,1]
    v_pk_fma_f32 v[140:141], v[148:149], v[134:135], v[132:133] op_sel:[1,1,0] op_sel_hi:[1,0,1] neg_lo:[1,0,0]
    v_cvt_pk_bf16_f32 v185, v140, v141
    v_pk_mul_f32 v[132:133], v[138:139], v[136:137] op_sel:[0,0] op_sel_hi:[0,1]
    v_pk_fma_f32 v[138:139], v[138:139], v[136:137], v[132:133] op_sel:[1,1,0] op_sel_hi:[1,0,1] neg_lo:[1,0,0]
    buffer_load_dwordx2 v[18:19], v37, s[40:43], s92 offen offset:1280
    s_add_u32 s92, s92, 655360
    v_cvt_pk_bf16_f32 v186, v138, v139
    v_pk_mul_f32 v[132:133], v[140:141], v[134:135] op_sel:[0,0] op_sel_hi:[0,1]
    v_pk_fma_f32 v[150:151], v[140:141], v[134:135], v[132:133] op_sel:[1,1,0] op_sel_hi:[1,0,1] neg_lo:[1,0,0]
    v_cvt_pk_bf16_f32 v187, v150, v151
    v_pk_mul_f32 v[132:133], v[138:139], v[136:137] op_sel:[0,0] op_sel_hi:[0,1]
    v_pk_fma_f32 v[138:139], v[138:139], v[136:137], v[132:133] op_sel:[1,1,0] op_sel_hi:[1,0,1] neg_lo:[1,0,0]
    v_cvt_pk_bf16_f32 v188, v138, v139
    ds_write_addtid_b32 v180 offset:2016
    ds_write_addtid_b32 v181 offset:6624
    ds_write_addtid_b32 v182 offset:2304
    ds_write_addtid_b32 v183 offset:6912
    ds_write_addtid_b32 v184 offset:2592
    ds_write_addtid_b32 v185 offset:7200
    ds_write_addtid_b32 v186 offset:2880
    ds_write_addtid_b32 v187 offset:7488
    ds_write_addtid_b32 v188 offset:3168
    v_pk_mul_f32 v[132:133], v[150:151], v[134:135] op_sel:[0,0] op_sel_hi:[0,1]
    v_pk_fma_f32 v[140:141], v[150:151], v[134:135], v[132:133] op_sel:[1,1,0] op_sel_hi:[1,0,1] neg_lo:[1,0,0]
    v_cvt_pk_bf16_f32 v180, v140, v141
    v_pk_mul_f32 v[132:133], v[138:139], v[136:137] op_sel:[0,0] op_sel_hi:[0,1]
    v_pk_fma_f32 v[138:139], v[138:139], v[136:137], v[132:133] op_sel:[1,1,0] op_sel_hi:[1,0,1] neg_lo:[1,0,0]
    v_cvt_pk_bf16_f32 v181, v138, v139
    v_pk_mul_f32 v[132:133], v[140:141], v[134:135] op_sel:[0,0] op_sel_hi:[0,1]
    v_pk_fma_f32 v[152:153], v[140:141], v[134:135], v[132:133] op_sel:[1,1,0] op_sel_hi:[1,0,1] neg_lo:[1,0,0]
    v_cvt_pk_bf16_f32 v182, v152, v153
    v_pk_mul_f32 v[132:133], v[138:139], v[136:137] op_sel:[0,0] op_sel_hi:[0,1]
    v_pk_fma_f32 v[138:139], v[138:139], v[136:137], v[132:133] op_sel:[1,1,0] op_sel_hi:[1,0,1] neg_lo:[1,0,0]
    v_cvt_pk_bf16_f32 v183, v138, v139
    v_pk_mul_f32 v[132:133], v[152:153], v[134:135] op_sel:[0,0] op_sel_hi:[0,1]
    v_pk_fma_f32 v[140:141], v[152:153], v[134:135], v[132:133] op_sel:[1,1,0] op_sel_hi:[1,0,1] neg_lo:[1,0,0]
    v_cvt_pk_bf16_f32 v184, v140, v141
    v_pk_mul_f32 v[132:133], v[138:139], v[136:137] op_sel:[0,0] op_sel_hi:[0,1]
    v_pk_fma_f32 v[138:139], v[138:139], v[136:137], v[132:133] op_sel:[1,1,0] op_sel_hi:[1,0,1] neg_lo:[1,0,0]
    v_cvt_pk_bf16_f32 v185, v138, v139
    v_pk_mul_f32 v[132:133], v[140:141], v[134:135] op_sel:[0,0] op_sel_hi:[0,1]
    v_pk_fma_f32 v[154:155], v[140:141], v[134:135], v[132:133] op_sel:[1,1,0] op_sel_hi:[1,0,1] neg_lo:[1,0,0]
    v_cvt_pk_bf16_f32 v186, v154, v155
    v_pk_mul_f32 v[132:133], v[138:139], v[136:137] op_sel:[0,0] op_sel_hi:[0,1]
    v_pk_fma_f32 v[138:139], v[138:139], v[136:137], v[132:133] op_sel:[1,1,0] op_sel_hi:[1,0,1] neg_lo:[1,0,0]
    v_cvt_pk_bf16_f32 v187, v138, v139
    v_pk_mul_f32 v[132:133], v[154:155], v[134:135] op_sel:[0,0] op_sel_hi:[0,1]
    v_pk_fma_f32 v[140:141], v[154:155], v[134:135], v[132:133] op_sel:[1,1,0] op_sel_hi:[1,0,1] neg_lo:[1,0,0]
    v_cvt_pk_bf16_f32 v188, v140, v141
    ds_write_addtid_b32 v180 offset:7776
    ds_write_addtid_b32 v181 offset:3456
    ds_write_addtid_b32 v182 offset:8064
    ds_write_addtid_b32 v183 offset:3744
    ds_write_addtid_b32 v184 offset:8352
    ds_write_addtid_b32 v185 offset:4032
    ds_write_addtid_b32 v186 offset:8640
    ds_write_addtid_b32 v187 offset:4320
    ds_write_addtid_b32 v188 offset:8928
    v_pk_mul_f32 v[132:133], v[162:163], v[148:149] op_sel:[0,0] op_sel_hi:[0,1]
    v_pk_fma_f32 v[138:139], v[162:163], v[148:149], v[132:133] op_sel:[1,1,0] op_sel_hi:[1,0,1] neg_lo:[1,0,0]
    v_cvt_pk_bf16_f32 v180, v138, v139
    v_pk_mul_f32 v[132:133], v[138:139], v[156:157] op_sel:[0,0] op_sel_hi:[0,1]
    v_pk_fma_f32 v[172:173], v[138:139], v[156:157], v[132:133] op_sel:[1,1,0] op_sel_hi:[1,0,1] neg_lo:[1,0,0]
    v_cvt_pk_bf16_f32 v181, v172, v173
    v_pk_mul_f32 v[132:133], v[138:139], v[158:159] op_sel:[0,0] op_sel_hi:[0,1]
    v_pk_fma_f32 v[172:173], v[138:139], v[158:159], v[132:133] op_sel:[1,1,0] op_sel_hi:[1,0,1] neg_lo:[1,0,0]
    v_cvt_pk_bf16_f32 v182, v172, v173
    ds_read_b128 v[192:195], v74 offset:0
    ds_read_b128 v[208:211], v74 offset:64
    ds_read_b128 v[224:227], v74 offset:128
    ds_read_b128 v[240:243], v74 offset:192
    v_pk_mul_f32 v[132:133], v[138:139], v[160:161] op_sel:[0,0] op_sel_hi:[0,1]
    v_pk_fma_f32 v[172:173], v[138:139], v[160:161], v[132:133] op_sel:[1,1,0] op_sel_hi:[1,0,1] neg_lo:[1,0,0]
    v_cvt_pk_bf16_f32 v183, v172, v173
    v_pk_mul_f32 v[132:133], v[156:157], v[142:143] op_sel:[0,0] op_sel_hi:[0,1]
    v_pk_fma_f32 v[172:173], v[156:157], v[142:143], v[132:133] op_sel:[1,1,0] op_sel_hi:[1,0,1] neg_lo:[1,0,0]
    v_cvt_pk_bf16_f32 v184, v172, v173
    v_pk_mul_f32 v[132:133], v[156:157], v[144:145] op_sel:[0,0] op_sel_hi:[0,1]
    v_pk_fma_f32 v[172:173], v[156:157], v[144:145], v[132:133] op_sel:[1,1,0] op_sel_hi:[1,0,1] neg_lo:[1,0,0]
    v_cvt_pk_bf16_f32 v185, v172, v173
    ds_read_b128 v[196:199], v74 offset:4608
    ds_read_b128 v[212:215], v74 offset:4672
    ds_read_b128 v[228:231], v74 offset:4736
    ds_read_b128 v[244:247], v74 offset:4800
    v_pk_mul_f32 v[132:133], v[156:157], v[146:147] op_sel:[0,0] op_sel_hi:[0,1]
    v_pk_fma_f32 v[172:173], v[156:157], v[146:147], v[132:133] op_sel:[1,1,0] op_sel_hi:[1,0,1] neg_lo:[1,0,0]
    v_cvt_pk_bf16_f32 v186, v172, v173
    v_pk_mul_f32 v[132:133], v[156:157], v[148:149] op_sel:[0,0] op_sel_hi:[0,1]
    v_pk_fma_f32 v[172:173], v[156:157], v[148:149], v[132:133] op_sel:[1,1,0] op_sel_hi:[1,0,1] neg_lo:[1,0,0]
    v_cvt_pk_bf16_f32 v187, v172, v173
    v_pk_mul_f32 v[132:133], v[156:157], v[150:151] op_sel:[0,0] op_sel_hi:[0,1]
    v_pk_fma_f32 v[172:173], v[156:157], v[150:151], v[132:133] op_sel:[1,1,0] op_sel_hi:[1,0,1] neg_lo:[1,0,0]
    v_cvt_pk_bf16_f32 v188, v172, v173
    ds_write_addtid_b32 v180 offset:13824
    ds_write_addtid_b32 v181 offset:14400
    ds_write_addtid_b32 v182 offset:14976
    ds_write_addtid_b32 v183 offset:15552
    ds_write_addtid_b32 v184 offset:9504
    ds_write_addtid_b32 v185 offset:9792
    ds_write_addtid_b32 v186 offset:10080
    ds_write_addtid_b32 v187 offset:10368
    ds_write_addtid_b32 v188 offset:10656
    v_pk_mul_f32 v[132:133], v[156:157], v[152:153] op_sel:[0,0] op_sel_hi:[0,1]
    v_pk_fma_f32 v[172:173], v[156:157], v[152:153], v[132:133] op_sel:[1,1,0] op_sel_hi:[1,0,1] neg_lo:[1,0,0]
    v_cvt_pk_bf16_f32 v180, v172, v173
    v_pk_mul_f32 v[132:133], v[156:157], v[154:155] op_sel:[0,0] op_sel_hi:[0,1]
    v_pk_fma_f32 v[172:173], v[156:157], v[154:155], v[132:133] op_sel:[1,1,0] op_sel_hi:[1,0,1] neg_lo:[1,0,0]
    v_cvt_pk_bf16_f32 v181, v172, v173
    v_pk_mul_f32 v[132:133], v[158:159], v[144:145] op_sel:[0,0] op_sel_hi:[0,1]
    v_pk_fma_f32 v[172:173], v[158:159], v[144:145], v[132:133] op_sel:[1,1,0] op_sel_hi:[1,0,1] neg_lo:[1,0,0]
    v_cvt_pk_bf16_f32 v182, v172, v173
    v_pk_mul_f32 v[132:133], v[158:159], v[148:149] op_sel:[0,0] op_sel_hi:[0,1]
    v_pk_fma_f32 v[172:173], v[158:159], v[148:149], v[132:133] op_sel:[1,1,0] op_sel_hi:[1,0,1] neg_lo:[1,0,0]
    v_cvt_pk_bf16_f32 v183, v172, v173
    ds_read_b128 v[204:207], v74 offset:13824
    ds_read_b128 v[220:223], v74 offset:13888
    ds_read_b128 v[236:239], v74 offset:13952
    ds_read_b128 v[252:255], v74 offset:14016
    v_pk_mul_f32 v[132:133], v[158:159], v[152:153] op_sel:[0,0] op_sel_hi:[0,1]
    v_pk_fma_f32 v[172:173], v[158:159], v[152:153], v[132:133] op_sel:[1,1,0] op_sel_hi:[1,0,1] neg_lo:[1,0,0]
    v_cvt_pk_bf16_f32 v184, v172, v173
    v_pk_mul_f32 v[132:133], v[160:161], v[144:145] op_sel:[0,0] op_sel_hi:[0,1]
    v_pk_fma_f32 v[172:173], v[160:161], v[144:145], v[132:133] op_sel:[1,1,0] op_sel_hi:[1,0,1] neg_lo:[1,0,0]
    v_cvt_pk_bf16_f32 v185, v172, v173
    v_pk_mul_f32 v[132:133], v[160:161], v[148:149] op_sel:[0,0] op_sel_hi:[0,1]
    v_pk_fma_f32 v[172:173], v[160:161], v[148:149], v[132:133] op_sel:[1,1,0] op_sel_hi:[1,0,1] neg_lo:[1,0,0]
    v_cvt_pk_bf16_f32 v186, v172, v173
    v_pk_mul_f32 v[132:133], v[160:161], v[152:153] op_sel:[0,0] op_sel_hi:[0,1]
    v_pk_fma_f32 v[172:173], v[160:161], v[152:153], v[132:133] op_sel:[1,1,0] op_sel_hi:[1,0,1] neg_lo:[1,0,0]
    v_cvt_pk_bf16_f32 v187, v172, v173
    ds_write_addtid_b32 v180 offset:10944
    ds_write_addtid_b32 v181 offset:11232
    ds_write_addtid_b32 v182 offset:11808
    ds_write_addtid_b32 v183 offset:12096
    ds_write_addtid_b32 v184 offset:12384
    ds_write_addtid_b32 v185 offset:12960
    ds_write_addtid_b32 v186 offset:13248
    ds_write_addtid_b32 v187 offset:13536
    ds_read_b128 v[200:203], v74 offset:9216
    ds_read_b128 v[216:219], v74 offset:9280
    ds_read_b128 v[232:235], v74 offset:9344
    ds_read_b128 v[248:251], v74 offset:9408
    s_waitcnt vmcnt(11)
    v_lshlrev_b32 v68, 16, v68
    s_waitcnt vmcnt(10)
    s_nop 0
    v_add_u32 v2, 2654435761, v2
    s_mov_b32 s91, 16384
    buffer_load_dwordx4 v[20:23], v109, s[60:63], s91 offen sc1
    s_mov_b32 s91, 20480
    buffer_load_dwordx4 v[24:27], v109, s[60:63], s91 offen sc1
    s_mov_b32 s91, 24576
    buffer_load_dwordx4 v[28:31], v109, s[60:63], s91 offen sc1
    s_mov_b32 s91, 28672
    buffer_load_dwordx4 v[32:35], v109, s[60:63], s91 offen sc1
    s_waitcnt lgkmcnt(0)
    v_mfma_f32_16x16x32_bf16 v[112:115], v[196:199], v[192:195], v[112:115]
    s_waitcnt vmcnt(8)
    v_lshlrev_b32 v36, 16, v4
    v_and_b32 v44, 0xffff0000, v4
    v_mfma_f32_16x16x32_bf16 v[116:119], v[200:203], v[192:195], v[116:119]
    v_lshlrev_b32 v52, 16, v5
    v_and_b32 v60, 0xffff0000, v5
    v_mfma_f32_16x16x32_bf16 v[120:123], v[204:207], v[192:195], v[120:123]
    v_lshlrev_b32 v37, 16, v6
    v_and_b32 v45, 0xffff0000, v6
    v_mfma_f32_16x16x32_bf16 v[112:115], v[212:215], v[208:211], v[112:115]
    v_lshlrev_b32 v53, 16, v7
    v_and_b32 v61, 0xffff0000, v7
    v_mfma_f32_16x16x32_bf16 v[116:119], v[216:219], v[208:211], v[116:119]
    v_lshlrev_b32 v38, 16, v8
    v_and_b32 v46, 0xffff0000, v8
    v_mfma_f32_16x16x32_bf16 v[120:123], v[220:223], v[208:211], v[120:123]
    v_lshlrev_b32 v54, 16, v9
    v_and_b32 v62, 0xffff0000, v9
    v_mfma_f32_16x16x32_bf16 v[112:115], v[228:231], v[224:227], v[112:115]
    v_lshlrev_b32 v39, 16, v10
    v_and_b32 v47, 0xffff0000, v10
    v_lshlrev_b32 v55, 16, v11
    v_mfma_f32_16x16x32_bf16 v[116:119], v[232:235], v[224:227], v[116:119]
    v_and_b32 v63, 0xffff0000, v11
    s_waitcnt vmcnt(6)
    v_mfma_f32_16x16x32_bf16 v[120:123], v[236:239], v[224:227], v[120:123]
    v_lshlrev_b32 v40, 16, v12
    v_and_b32 v48, 0xffff0000, v12
    v_mfma_f32_16x16x32_bf16 v[112:115], v[244:247], v[240:243], v[112:115]
    v_lshlrev_b32 v56, 16, v13
    v_and_b32 v64, 0xffff0000, v13
    v_mfma_f32_16x16x32_bf16 v[116:119], v[248:251], v[240:243], v[116:119]
    v_lshlrev_b32 v41, 16, v14
    v_and_b32 v49, 0xffff0000, v14
    v_mfma_f32_16x16x32_bf16 v[120:123], v[252:255], v[240:243], v[120:123]
    v_lshlrev_b32 v57, 16, v15
    v_and_b32 v65, 0xffff0000, v15
    s_mov_b64 exec, 1
    v_add_f32 v112, v112, v68
    s_mov_b64 exec, -1
    v_cvt_pk_bf16_f32 v172, v112, v113
    v_cvt_pk_bf16_f32 v173, v114, v115
    v_cvt_pk_bf16_f32 v174, v116, v117
    v_cvt_pk_bf16_f32 v175, v118, v119
    v_cvt_pk_bf16_f32 v176, v120, v121
    v_cvt_pk_bf16_f32 v177, v122, v123
    ds_write2_b32 v77, v176, v177 offset0:0 offset1:16
    ds_write_b64 v76, v[174:175] offset:512
    ds_write_b64 v75, v[172:173]
    ds_read_u16 v178, v78 offset:4
    ds_read_b32 v179, v78
    ds_read_b64 v[180:181], v79
    ds_read_b64 v[182:183], v79 offset:8
    ds_read2_b32 v[240:241], v86 offset0:3 offset1:2
    ds_read2_b32 v[242:243], v86 offset0:1 offset1:0
    ds_read2_b32 v[244:245], v86 offset0:19 offset1:18
    ds_read2_b32 v[246:247], v86 offset0:17 offset1:16
    ds_read2_b32 v[248:249], v86 offset0:35 offset1:34
    ds_read2_b32 v[250:251], v86 offset0:33 offset1:32
    ds_read2_b32 v[252:253], v86 offset0:51 offset1:50
    ds_read2_b32 v[254:255], v86 offset0:49 offset1:48
    s_mov_b32 s80, 0x05040504
    s_mov_b32 s81, 0x01000100
    s_mov_b32 s82, 0x03020302
    s_mov_b32 s83, 0x01000302
    s_mov_b32 vcc_lo, 0
    s_mov_b32 vcc_hi, -1
    s_waitcnt lgkmcnt(8)
    v_readfirstlane_b32 s72, v178
    v_readfirstlane_b32 s73, v179
    v_cndmask_b32 v183, v182, v183, vcc
    v_perm_b32 v192, v178, v179, s80
    v_perm_b32 v193, v178, v179, s82
    v_perm_b32 v200, v178, v179, s82
    v_perm_b32 v194, v178, v179, s83
    v_perm_b32 v201, v178, v179, s83
    v_perm_b32 v195, v178, v179, s81
    v_perm_b32 v202, v178, v179, s81
    v_perm_b32 v208, v183, v181, v80
    v_perm_b32 v209, v182, v181, v81
    v_perm_b32 v216, v182, v181, v81
    v_perm_b32 v210, v181, v180, v82
    v_perm_b32 v217, v181, v180, v82
    v_perm_b32 v211, v180, v180, v83
    v_perm_b32 v218, v180, v180, v83
    v_mov_b32 v184, s73
    v_mov_b32_dpp v203, v208 wave_rol:1 row_mask:0xf bank_mask:0xf
    v_mov_b32_dpp v219, v208 wave_shl:1 row_mask:0xf bank_mask:0xf bound_ctrl:0
    v_perm_b32 v184, s72, v184, v84
    v_mov_b32 v185, 0
    v_mov_b32_dpp v203, v192 wave_shl:1 row_mask:0xf bank_mask:0xf
    v_alignbit_b32 v196, v200, v192, 16
    v_alignbit_b32 v197, v201, v193, 16
    v_alignbit_b32 v204, v201, v193, 16
    v_alignbit_b32 v198, v202, v194, 16
    v_alignbit_b32 v205, v202, v194, 16
    v_alignbit_b32 v199, v203, v195, 16
    v_alignbit_b32 v206, v203, v195, 16
    v_alignbit_b32 v212, v216, v208, 16
    v_alignbit_b32 v213, v217, v209, 16
    v_alignbit_b32 v220, v217, v209, 16
    v_alignbit_b32 v214, v218, v210, 16
    v_alignbit_b32 v221, v218, v210, 16
    v_alignbit_b32 v215, v219, v211, 16
    v_alignbit_b32 v222, v219, v211, 16
    v_mov_b32_dpp v207, v212 wave_rol:1 row_mask:0xf bank_mask:0xf
    v_mov_b32_dpp v223, v212 wave_shl:1 row_mask:0xf bank_mask:0xf bound_ctrl:0
    s_nop 0
    s_nop 0
    v_mov_b32_dpp v207, v196 wave_shl:1 row_mask:0xf bank_mask:0xf
    ds_write_b32 v85, v184
    ds_write_b32 v85, v185 offset:2112
    ds_write_b128 v87, v[208:211] offset:8192
    ds_write_b128 v87, v[212:215] offset:5824
    ds_write_b128 v87, v[216:219] offset:3456
    ds_write_b128 v87, v[220:223] offset:1088
    s_waitcnt vmcnt(0)
    v_xor_b32 v128, v21, v2
    v_bitop3_b32 v128, v23, v2, v128 bitop3:0xbe
    v_bitop3_b32 v128, v25, v2, v128 bitop3:0xbe
    v_bitop3_b32 v128, v27, v2, v128 bitop3:0xbe
    v_bitop3_b32 v128, v29, v2, v128 bitop3:0xbe
    v_bitop3_b32 v128, v31, v2, v128 bitop3:0xbe
    v_bitop3_b32 v128, v33, v2, v128 bitop3:0xbe
    v_bitop3_b32 v128, v35, v2, v128 bitop3:0xbe
    v_cmp_ne_u32 vcc, 0, v128
    s_cbranch_vccnz L_stub_st
L_ok_st:
    v_and_b32 v160, 0xffff0000, v20
    ds_write_b128 v87, v[192:195] offset:7168
    s_add_u32 m0, s95, 0
    s_nop 0
    buffer_load_dwordx4 v100, s[48:51], s98 offen offset:0 lds
    v_and_b32 v161, 0xffff0000, v22
    v_and_b32 v162, 0xffff0000, v24
    v_and_b32 v163, 0xffff0000, v26
    v_and_b32 v164, 0xffff0000, v28
    v_and_b32 v165, 0xffff0000, v30
    v_and_b32 v166, 0xffff0000, v32
    v_and_b32 v167, 0xffff0000, v34
    v_rcp_f32 v160, v160
    v_rcp_f32 v161, v161
    v_rcp_f32 v162, v162
    v_rcp_f32 v163, v163
    ds_write_b128 v87, v[196:199] offset:4800
    buffer_load_dwordx4 v101, s[48:51], s98 offen offset:1024 lds
    v_rcp_f32 v164, v164
    v_rcp_f32 v165, v165
    v_rcp_f32 v166, v166
    v_rcp_f32 v167, v167
    v_lshlrev_b32 v224, 16, v20
    v_lshlrev_b32 v225, 16, v22
    v_lshlrev_b32 v226, 16, v24
    v_lshlrev_b32 v227, 16, v26
    v_lshlrev_b32 v228, 16, v28
    v_lshlrev_b32 v229, 16, v30
    v_lshlrev_b32 v230, 16, v32
    v_lshlrev_b32 v231, 16, v34
    ds_write_b128 v87, v[200:203] offset:2432
    buffer_load_dwordx4 v102, s[48:51], s98 offen offset:2048 lds
    v_pk_mul_f32 v[224:225], v[224:225], v[160:161] neg_lo:[1,0] neg_hi:[1,0]
    v_pk_mul_f32 v[226:227], v[226:227], v[162:163] neg_lo:[1,0] neg_hi:[1,0]
    v_pk_mul_f32 v[228:229], v[228:229], v[164:165] neg_lo:[1,0] neg_hi:[1,0]
    v_pk_mul_f32 v[230:231], v[230:231], v[166:167] neg_lo:[1,0] neg_hi:[1,0]
    v_lshlrev_b32 v42, 16, v16
    v_and_b32 v50, 0xffff0000, v16
    v_lshlrev_b32 v58, 16, v17
    v_and_b32 v66, 0xffff0000, v17
    v_lshlrev_b32 v43, 16, v18
    v_and_b32 v51, 0xffff0000, v18
    v_lshlrev_b32 v59, 16, v19
    ds_write_b128 v87, v[204:207] offset:64
    buffer_load_dwordx4 v103, s[48:51], s98 offen offset:3072 lds
    v_and_b32 v67, 0xffff0000, v19
    v_pk_fma_f32 v[128:129], v[36:37], v[160:161], v[224:225]
    v_pk_fma_f32 v[130:131], v[38:39], v[162:163], v[226:227]
    v_pk_fma_f32 v[132:133], v[40:41], v[164:165], v[228:229]
    v_pk_fma_f32 v[134:135], v[42:43], v[166:167], v[230:231]
    v_pk_fma_f32 v[136:137], v[44:45], v[160:161], v[224:225]
    v_pk_fma_f32 v[138:139], v[46:47], v[162:163], v[226:227]
    v_pk_fma_f32 v[140:141], v[48:49], v[164:165], v[228:229]
    v_pk_fma_f32 v[142:143], v[50:51], v[166:167], v[230:231]
    v_pk_fma_f32 v[144:145], v[52:53], v[160:161], v[224:225]
    v_pk_fma_f32 v[146:147], v[54:55], v[162:163], v[226:227]
    s_add_u32 m0, s95, 4096
    s_nop 0
    s_nop 0
    buffer_load_dwordx4 v70, s[48:51], s98 offen offset:0 lds
    v_pk_fma_f32 v[148:149], v[56:57], v[164:165], v[228:229]
    v_pk_fma_f32 v[150:151], v[58:59], v[166:167], v[230:231]
    v_pk_fma_f32 v[152:153], v[60:61], v[160:161], v[224:225]
    v_pk_fma_f32 v[154:155], v[62:63], v[162:163], v[226:227]
    v_pk_fma_f32 v[156:157], v[64:65], v[164:165], v[228:229]
    v_pk_fma_f32 v[158:159], v[66:67], v[166:167], v[230:231]
    v_cvt_pk_bf16_f32 v4, v128, v129
    v_cvt_pk_bf16_f32 v5, v130, v131
    v_cvt_pk_bf16_f32 v6, v132, v133
    v_cvt_pk_bf16_f32 v7, v134, v135
    v_cvt_pk_bf16_f32 v8, v136, v137
    v_cvt_pk_bf16_f32 v9, v138, v139
    buffer_load_dwordx4 v71, s[48:51], s98 offen offset:1024 lds
    v_cvt_pk_bf16_f32 v10, v140, v141
    v_cvt_pk_bf16_f32 v11, v142, v143
    v_cvt_pk_bf16_f32 v12, v144, v145
    v_cvt_pk_bf16_f32 v13, v146, v147
    v_cvt_pk_bf16_f32 v14, v148, v149
    v_cvt_pk_bf16_f32 v15, v150, v151
    v_cvt_pk_bf16_f32 v16, v152, v153
    v_cvt_pk_bf16_f32 v17, v154, v155
    v_cvt_pk_bf16_f32 v18, v156, v157
    v_cvt_pk_bf16_f32 v19, v158, v159
    v_add_u32 v176, 45056, v93
    ds_write2st64_b32 v93, v4, v5 offset0:0 offset1:4
    ds_write2st64_b32 v93, v6, v7 offset0:8 offset1:12
    ds_write2st64_b32 v93, v8, v9 offset0:88 offset1:92
    ds_write2st64_b32 v93, v10, v11 offset0:96 offset1:100
    ds_write2st64_b32 v176, v12, v13 offset0:0 offset1:4
    ds_write2st64_b32 v176, v14, v15 offset0:8 offset1:12
    ds_write2st64_b32 v176, v16, v17 offset0:88 offset1:92
    ds_write2st64_b32 v176, v18, v19 offset0:96 offset1:100
    ds_read_b64 v[144:145], v88 offset:2048
    ds_read_b64 v[146:147], v88 offset:2056
    ds_read_b64 v[148:149], v88 offset:1536
    ds_read_b64 v[150:151], v88 offset:1544
    ds_read_b64 v[152:153], v88 offset:1024
    ds_read_b64 v[154:155], v88 offset:1032
    ds_read_b64 v[156:157], v88 offset:512
    ds_read_b64 v[158:159], v88 offset:520
    ds_read_b64 v[124:125], v88 offset:0
    ds_read_b64 v[126:127], v88 offset:8
    buffer_load_dwordx4 v72, s[48:51], s98 offen offset:2048 lds
    buffer_load_dwordx4 v73, s[48:51], s98 offen offset:3072 lds
    s_add_u32 s98, s98, 128
    s_and_b32 s98, s98, 1023
    s_waitcnt lgkmcnt(10)
    s_barrier
    ds_read_b128 v[160:163], v89 offset:448
    ds_read_b128 v[164:167], v89 offset:960
    ds_read_b128 v[168:171], v89 offset:1472
    ds_read_b128 v[172:175], v89 offset:1984
    ds_read_b128 v[176:179], v89 offset:2496
    ds_read_b128 v[180:183], v89 offset:3008
    ds_read_b128 v[184:187], v89 offset:3520
    ds_read_b128 v[188:191], v89 offset:4032
    s_waitcnt lgkmcnt(6)
    v_mfma_f32_16x16x32_bf16 v[4:7], v[144:147], v[160:163], 0
    ds_read_b128 v[208:211], v89 offset:384
    v_and_b32 v112, 15, v1
    v_mfma_f32_16x16x32_bf16 v[8:11], v[148:151], v[160:163], 0
    ds_read_b64 v[192:193], v88 offset:1984
    v_lshrrev_b32 v113, 4, v1
    v_mfma_f32_16x16x32_bf16 v[12:15], v[148:151], v[164:167], 0
    v_lshlrev_b32 v113, 3, v113
    v_mfma_f32_16x16x32_bf16 v[8:11], v[144:147], v[164:167], v[8:11]
    s_waitcnt lgkmcnt(6)
    ds_read_b64 v[194:195], v88 offset:1992
    s_mov_b32 s73, 0xfe00
    v_mfma_f32_16x16x32_bf16 v[12:15], v[152:155], v[160:163], v[12:15]
    s_add_u32 m0, s95, 8192
    s_nop 0
    buffer_load_dwordx4 v100, s[48:51], s98 offen offset:0 lds
    v_mfma_f32_16x16x32_bf16 v[16:19], v[152:155], v[164:167], 0
    ds_read_b128 v[212:215], v89 offset:896
    v_lshlrev_b32 v119, v112, s73
    v_mfma_f32_16x16x32_bf16 v[20:23], v[152:155], v[168:171], 0
    ds_read_b64 v[196:197], v88 offset:1472
    s_mov_b32 s73, 0x1ff
    v_mfma_f32_16x16x32_bf16 v[12:15], v[144:147], v[168:171], v[12:15]
    buffer_load_dwordx4 v101, s[48:51], s98 offen offset:1024 lds
    v_lshlrev_b32 v123, v112, s73
    v_mfma_f32_16x16x32_bf16 v[16:19], v[148:151], v[168:171], v[16:19]
    ds_read_b64 v[198:199], v88 offset:1480
    v_lshrrev_b32 v119, v113, v119
    v_mfma_f32_16x16x32_bf16 v[16:19], v[156:159], v[160:163], v[16:19]
    v_mfma_f32_16x16x32_bf16 v[20:23], v[156:159], v[164:167], v[20:23]
    ds_read_b128 v[216:219], v89 offset:1408
    v_lshrrev_b32 v123, v113, v123
    v_mfma_f32_16x16x32_bf16 v[24:27], v[156:159], v[168:171], 0
    buffer_load_dwordx4 v102, s[48:51], s98 offen offset:2048 lds
    v_bfe_u32 v116, v119, 0, 2
    v_mfma_f32_16x16x32_bf16 v[28:31], v[156:159], v[172:175], 0
    ds_read_b64 v[200:201], v88 offset:960
    v_lshl_or_b32 v116, v116, 15, v116
    v_mfma_f32_16x16x32_bf16 v[16:19], v[144:147], v[172:175], v[16:19]
    ds_read_b64 v[202:203], v88 offset:968
    v_and_b32 v116, 0x10001, v116
    v_mfma_f32_16x16x32_bf16 v[20:23], v[148:151], v[172:175], v[20:23]
    buffer_load_dwordx4 v103, s[48:51], s98 offen offset:3072 lds
    v_mfma_f32_16x16x32_bf16 v[24:27], v[152:155], v[172:175], v[24:27]
    s_waitcnt lgkmcnt(11)
    ds_read_b128 v[220:223], v89 offset:1920
    v_mul_u32_u24 v116, 0x3f80, v116
    v_mfma_f32_16x16x32_bf16 v[20:23], v[144:147], v[176:179], v[20:23]
    ds_read_b64 v[204:205], v88 offset:448
    v_bfe_u32 v117, v119, 2, 2
    v_mfma_f32_16x16x32_bf16 v[24:27], v[148:151], v[176:179], v[24:27]
    s_add_u32 m0, s95, 12288
    s_nop 0
    buffer_load_dwordx4 v70, s[48:51], s98 offen offset:0 lds
    v_mfma_f32_16x16x32_bf16 v[28:31], v[152:155], v[176:179], v[28:31]
    ds_read_b64 v[206:207], v88 offset:456
    v_lshl_or_b32 v117, v117, 15, v117
    v_mfma_f32_16x16x32_bf16 v[32:35], v[156:159], v[176:179], 0
    v_and_b32 v117, 0x10001, v117
    v_mfma_f32_16x16x32_bf16 v[20:23], v[124:127], v[160:163], v[20:23]
    ds_read_b128 v[224:227], v89 offset:2432
    v_mul_u32_u24 v117, 0x3f80, v117
    v_mfma_f32_16x16x32_bf16 v[24:27], v[124:127], v[164:167], v[24:27]
    s_waitcnt vmcnt(11)
    ds_read_b128 v[228:231], v89 offset:2944
    v_bfe_u32 v118, v119, 4, 2
    v_mfma_f32_16x16x32_bf16 v[28:31], v[124:127], v[168:171], v[28:31]
    ds_read_b128 a[0:3], v104 offset:0
    v_lshl_or_b32 v118, v118, 15, v118
    v_mfma_f32_16x16x32_bf16 v[32:35], v[124:127], v[172:175], v[32:35]
    buffer_load_dwordx4 v71, s[48:51], s98 offen offset:1024 lds
    v_mfma_f32_16x16x32_bf16 v[24:27], v[144:147], v[180:183], v[24:27]
    ds_read_b128 v[232:235], v89 offset:3456
    v_and_b32 v118, 0x10001, v118
    v_mfma_f32_16x16x32_bf16 v[28:31], v[148:151], v[180:183], v[28:31]
    ds_read_b128 a[4:7], v105 offset:0
    v_mul_u32_u24 v118, 0x3f80, v118
    v_mfma_f32_16x16x32_bf16 v[32:35], v[152:155], v[180:183], v[32:35]
    s_waitcnt lgkmcnt(15)
    buffer_load_dwordx4 v72, s[48:51], s98 offen offset:2048 lds
    v_bfe_u32 v119, v119, 6, 2
    v_mfma_f32_16x16x32_bf16 v[28:31], v[144:147], v[184:187], v[28:31]
    ds_read_b128 v[236:239], v89 offset:3968
    v_lshl_or_b32 v119, v119, 15, v119
    v_mfma_f32_16x16x32_bf16 v[32:35], v[148:151], v[184:187], v[32:35]
    s_waitcnt vmcnt(11)
    ds_read_b128 a[64:67], v104 offset:2048
    v_mfma_f32_16x16x32_bf16 v[32:35], v[144:147], v[188:191], v[32:35]
    s_waitcnt lgkmcnt(13)
    buffer_load_dwordx4 v73, s[48:51], s98 offen offset:3072 lds
    s_add_u32 s98, s98, 128
    v_mfma_f32_16x16x32_bf16 v[4:7], v[192:195], v[208:211], v[4:7]
    ds_read_b128 v[160:163], v89 offset:320
    s_and_b32 s98, s98, 1023
    v_mfma_f32_16x16x32_bf16 v[8:11], v[196:199], v[208:211], v[8:11]
    ds_read_b64 v[144:145], v88 offset:1920
    v_and_b32 v119, 0x10001, v119
    v_mfma_f32_16x16x32_bf16 v[12:15], v[196:199], v[212:215], v[12:15]
    ds_read_b128 a[68:71], v105 offset:2048
    s_add_u32 m0, s95, 0
    v_mfma_f32_16x16x32_bf16 v[8:11], v[192:195], v[212:215], v[8:11]
    s_waitcnt lgkmcnt(10)
    s_waitcnt lgkmcnt(5)
    buffer_load_dwordx4 v100, s[48:51], s98 offen offset:0 lds
    v_mul_u32_u24 v119, 0x3f80, v119
    v_mfma_f32_16x16x32_bf16 v[12:15], v[200:203], v[208:211], v[12:15]
    ds_read_b64 v[146:147], v88 offset:1928
    v_bfe_u32 v120, v123, 0, 2
    v_mfma_f32_16x16x32_bf16 v[16:19], v[200:203], v[212:215], v[16:19]
    s_waitcnt vmcnt(11)
    ds_read_b128 v[164:167], v89 offset:832
    v_lshl_or_b32 v120, v120, 15, v120
    v_mfma_f32_16x16x32_bf16 v[20:23], v[200:203], v[216:219], v[20:23]
    ds_read_b64 v[148:149], v88 offset:1408
    v_and_b32 v120, 0x10001, v120
    v_mfma_f32_16x16x32_bf16 v[12:15], v[192:195], v[216:219], v[12:15]
    ds_read_b128 a[128:131], v104 offset:4096
    v_mul_u32_u24 v120, 0x3f80, v120
    v_mfma_f32_16x16x32_bf16 v[16:19], v[196:199], v[216:219], v[16:19]
    buffer_load_dwordx4 v101, s[48:51], s98 offen offset:1024 lds
    v_bfe_u32 v121, v123, 2, 2
    v_mfma_f32_16x16x32_bf16 v[16:19], v[204:207], v[208:211], v[16:19]
    ds_read_b64 v[150:151], v88 offset:1416
    v_lshl_or_b32 v121, v121, 15, v121
    v_mfma_f32_16x16x32_bf16 v[20:23], v[204:207], v[212:215], v[20:23]
    ds_read_b128 v[168:171], v89 offset:1344
    v_and_b32 v121, 0x10001, v121
    v_mfma_f32_16x16x32_bf16 v[24:27], v[204:207], v[216:219], v[24:27]
    ds_read_b64 v[152:153], v88 offset:896
    v_mul_u32_u24 v121, 0x3f80, v121
    v_mfma_f32_16x16x32_bf16 v[28:31], v[204:207], v[220:223], v[28:31]
    ds_read_b128 a[132:135], v105 offset:4096
    s_waitcnt lgkmcnt(8)
    buffer_load_dwordx4 v102, s[48:51], s98 offen offset:2048 lds
    v_mfma_f32_16x16x32_bf16 v[16:19], v[192:195], v[220:223], v[16:19]
    s_waitcnt vmcnt(11)
    ds_read_b64 v[154:155], v88 offset:904
    v_bfe_u32 v122, v123, 4, 2
    v_mfma_f32_16x16x32_bf16 v[20:23], v[196:199], v[220:223], v[20:23]
    ds_read_b128 v[172:175], v89 offset:1856
    v_lshl_or_b32 v122, v122, 15, v122
    v_mfma_f32_16x16x32_bf16 v[24:27], v[200:203], v[220:223], v[24:27]
    ds_read_b64 v[156:157], v88 offset:384
    v_and_b32 v122, 0x10001, v122
    v_mfma_f32_16x16x32_bf16 v[20:23], v[192:195], v[224:227], v[20:23]
    ds_read_b128 a[192:195], v104 offset:6144
    buffer_load_dwordx4 v103, s[48:51], s98 offen offset:3072 lds
    v_mfma_f32_16x16x32_bf16 v[24:27], v[196:199], v[224:227], v[24:27]
    ds_read_b64 v[158:159], v88 offset:392
    v_mul_u32_u24 v122, 0x3f80, v122
    v_mfma_f32_16x16x32_bf16 v[28:31], v[200:203], v[224:227], v[28:31]
    ds_read_b128 v[176:179], v89 offset:2368
    v_bfe_u32 v123, v123, 6, 2
    v_mfma_f32_16x16x32_bf16 v[32:35], v[204:207], v[224:227], v[32:35]
    ds_read_b128 a[196:199], v105 offset:6144
    s_add_u32 m0, s95, 4096
    s_waitcnt lgkmcnt(7)
    buffer_load_dwordx4 v70, s[48:51], s98 offen offset:0 lds
    v_mfma_f32_16x16x32_bf16 v[24:27], v[192:195], v[228:231], v[24:27]
    s_waitcnt vmcnt(11)
    ds_read_b128 v[180:183], v89 offset:2880
    v_lshl_or_b32 v123, v123, 15, v123
    v_mfma_f32_16x16x32_bf16 v[28:31], v[196:199], v[228:231], v[28:31]
    ds_read_b128 v[184:187], v89 offset:3392
    v_and_b32 v123, 0x10001, v123
    v_mfma_f32_16x16x32_bf16 v[32:35], v[200:203], v[228:231], v[32:35]
    ds_read_b128 v[188:191], v89 offset:3904
    v_mul_u32_u24 v123, 0x3f80, v123
    v_mfma_f32_16x16x32_bf16 v[28:31], v[192:195], v[232:235], v[28:31]
    ds_read_b128 a[8:11], v104 offset:8192
    buffer_load_dwordx4 v71, s[48:51], s98 offen offset:1024 lds
    ds_read_b64 v[128:129], v89 offset:440
    ds_read_b64 v[130:131], v89 offset:448
    v_mfma_f32_16x16x32_bf16 v[32:35], v[196:199], v[232:235], v[32:35]
    ds_read_b128 a[12:15], v105 offset:8192
    v_mfma_f32_16x16x32_bf16 v[32:35], v[192:195], v[236:239], v[32:35]
    s_waitcnt lgkmcnt(7)
    buffer_load_dwordx4 v72, s[48:51], s98 offen offset:2048 lds
    s_waitcnt lgkmcnt(1)
    v_mfma_f32_16x16x32_bf16 v[132:135], v[128:131], v[116:119], 0
    s_waitcnt vmcnt(11)
    ds_read_b128 v[208:211], v89 offset:256
    s_mul_i32 s72, s68, 3
    v_mfma_f32_16x16x32_bf16 v[136:139], v[128:131], v[120:123], 0
    ds_read_b128 a[72:75], v104 offset:10240
    v_mfma_f32_16x16x32_bf16 v[4:7], v[144:147], v[160:163], v[4:7]
    buffer_load_dwordx4 v73, s[48:51], s98 offen offset:3072 lds
    s_add_u32 s98, s98, 128
    v_mfma_f32_16x16x32_bf16 v[8:11], v[148:151], v[160:163], v[8:11]
    ds_read_b64 v[192:193], v88 offset:1856
    s_and_b32 s98, s98, 1023
    v_mfma_f32_16x16x32_bf16 v[12:15], v[148:151], v[164:167], v[12:15]
    ds_read_b64 v[194:195], v88 offset:1864
    s_lshr_b32 s72, s72, 1
    v_mfma_f32_16x16x32_bf16 v[8:11], v[144:147], v[164:167], v[8:11]
    ds_read_b128 a[76:79], v105 offset:10240
    s_add_u32 m0, s95, 8192
    v_mfma_f32_16x16x32_bf16 v[12:15], v[152:155], v[160:163], v[12:15]
    s_waitcnt lgkmcnt(5)
    buffer_load_dwordx4 v100, s[48:51], s98 offen offset:0 lds
    v_and_b32 v107, 2, v1
    v_mfma_f32_16x16x32_bf16 v[16:19], v[152:155], v[164:167], v[16:19]
    s_waitcnt vmcnt(11)
    ds_read_b128 v[212:215], v89 offset:768
    v_mad_u32_u24 v107, v107, 5, s72
    v_mfma_f32_16x16x32_bf16 v[20:23], v[152:155], v[168:171], v[20:23]
    ds_read_b64 v[196:197], v88 offset:1344
    v_mfma_f32_16x16x32_bf16 v[12:15], v[144:147], v[168:171], v[12:15]
    ds_read_b128 a[136:139], v104 offset:12288
    s_mul_i32 s72, s64, 24
    v_mfma_f32_16x16x32_bf16 v[16:19], v[148:151], v[168:171], v[16:19]
    buffer_load_dwordx4 v101, s[48:51], s98 offen offset:1024 lds
    v_mfma_f32_16x16x32_bf16 v[16:19], v[156:159], v[160:163], v[16:19]
    ds_read_b64 v[198:199], v88 offset:1352
    s_sub_u32 s72, s72, 4
    v_mfma_f32_16x16x32_bf16 v[20:23], v[156:159], v[164:167], v[20:23]
    ds_read_b128 v[216:219], v89 offset:1280
    v_mfma_f32_16x16x32_bf16 v[24:27], v[156:159], v[168:171], v[24:27]
    ds_read_b128 a[140:143], v105 offset:12288
    v_mfma_f32_16x16x32_bf16 v[28:31], v[156:159], v[172:175], v[28:31]
    s_waitcnt lgkmcnt(6)
    buffer_load_dwordx4 v102, s[48:51], s98 offen offset:2048 lds
    v_mov_b32 v108, s72
    v_mfma_f32_16x16x32_bf16 v[16:19], v[144:147], v[172:175], v[16:19]
    s_waitcnt vmcnt(11)
    ds_read_b64 v[200:201], v88 offset:832
    v_mfma_f32_16x16x32_bf16 v[20:23], v[148:151], v[172:175], v[20:23]
    ds_read_b64 v[202:203], v88 offset:840
    s_mov_b64 vcc, 15
    v_mfma_f32_16x16x32_bf16 v[24:27], v[152:155], v[172:175], v[24:27]
    v_cvt_pk_bf16_f32 v140, v132, v136
    v_cvt_pk_bf16_f32 v141, v133, v137
    v_cvt_pk_bf16_f32 v142, v134, v138
    v_cvt_pk_bf16_f32 v143, v135, v139
    v_mfma_f32_16x16x32_bf16 v[20:23], v[144:147], v[176:179], v[20:23]
    ds_read_b128 v[220:223], v89 offset:1792
    ds_read_b128 a[200:203], v104 offset:14336
    buffer_load_dwordx4 v103, s[48:51], s98 offen offset:3072 lds
    v_mfma_f32_16x16x32_bf16 v[24:27], v[148:151], v[176:179], v[24:27]
    ds_read_b64 v[204:205], v88 offset:320
    v_cndmask_b32 v107, v108, v107, vcc
    v_mfma_f32_16x16x32_bf16 v[28:31], v[152:155], v[176:179], v[28:31]
    ds_read_b64 v[206:207], v88 offset:328
    v_mfma_f32_16x16x32_bf16 v[32:35], v[156:159], v[176:179], v[32:35]
    ds_read_b128 a[204:207], v105 offset:14336
    s_add_u32 m0, s95, 12288
    s_waitcnt lgkmcnt(7)
    buffer_load_dwordx4 v70, s[48:51], s98 offen offset:0 lds
    v_mfma_f32_16x16x32_bf16 v[24:27], v[144:147], v[180:183], v[24:27]
    s_waitcnt vmcnt(11)
    ds_read_b128 v[224:227], v89 offset:2304
    v_min_u32 v108, 27, v1
    v_mfma_f32_16x16x32_bf16 v[28:31], v[148:151], v[180:183], v[28:31]
    ds_read_b128 v[228:231], v89 offset:2816
    v_add_lshl_u32 v107, v107, v108, 7
    v_mfma_f32_16x16x32_bf16 v[32:35], v[152:155], v[180:183], v[32:35]
    ds_read_b128 a[16:19], v104 offset:0
    v_mfma_f32_16x16x32_bf16 v[28:31], v[144:147], v[184:187], v[28:31]
    buffer_load_dwordx4 v71, s[48:51], s98 offen offset:1024 lds
    v_add_u32 v107, 4096, v107
    v_mfma_f32_16x16x32_bf16 v[32:35], v[148:151], v[184:187], v[32:35]
    ds_read_b128 v[232:235], v89 offset:3328
    v_mfma_f32_16x16x32_bf16 v[32:35], v[144:147], v[188:191], v[32:35]
    ds_read_b128 v[236:239], v89 offset:3840
    v_mfma_f32_16x16x32_bf16 v[20:23], v[140:143], v[240:243], v[20:23]
    ds_read_b128 a[20:23], v105 offset:0
    s_waitcnt lgkmcnt(6)
    buffer_load_dwordx4 v72, s[48:51], s98 offen offset:2048 lds
    v_mfma_f32_16x16x32_bf16 v[24:27], v[140:143], v[244:247], v[24:27]
    s_waitcnt vmcnt(11)
    ds_read_b64 v[128:129], v89 offset:952
    ds_read_b64 v[130:131], v89 offset:960
    v_mfma_f32_16x16x32_bf16 v[28:31], v[140:143], v[248:251], v[28:31]
    ds_read_b128 a[80:83], v104 offset:2048
    v_mfma_f32_16x16x32_bf16 v[32:35], v[140:143], v[252:255], v[32:35]
    buffer_load_dwordx4 v73, s[48:51], s98 offen offset:3072 lds
    s_add_u32 s98, s98, 128
    s_waitcnt lgkmcnt(1)
    v_mfma_f32_16x16x32_bf16 v[132:135], v[128:131], v[116:119], 0
    ds_read_b128 v[160:163], v89 offset:192
    s_and_b32 s98, s98, 1023
    v_mfma_f32_16x16x32_bf16 v[136:139], v[128:131], v[120:123], 0
    ds_read_b128 a[84:87], v105 offset:2048
    s_add_u32 m0, s95, 0
    v_mfma_f32_16x16x32_bf16 v[4:7], v[192:195], v[208:211], v[4:7]
    buffer_load_dwordx4 v100, s[48:51], s98 offen offset:0 lds
    s_mul_i32 s75, s68, 122880
    v_mfma_f32_16x16x32_bf16 v[8:11], v[196:199], v[208:211], v[8:11]
    s_waitcnt vmcnt(11)
    ds_read_b64 v[144:145], v88 offset:1792
    s_mul_i32 s72, s64, 6144
    v_mfma_f32_16x16x32_bf16 v[12:15], v[196:199], v[212:215], v[12:15]
    ds_read_b64 v[146:147], v88 offset:1800
    v_mfma_f32_16x16x32_bf16 v[8:11], v[192:195], v[212:215], v[8:11]
    ds_read_b128 a[144:147], v104 offset:4096
    v_mfma_f32_16x16x32_bf16 v[12:15], v[200:203], v[208:211], v[12:15]
    buffer_load_dwordx4 v101, s[48:51], s98 offen offset:1024 lds
    v_mfma_f32_16x16x32_bf16 v[16:19], v[200:203], v[212:215], v[16:19]
    ds_read_b128 v[164:167], v89 offset:704
    s_add_u32 s75, s75, s72
    v_mfma_f32_16x16x32_bf16 v[20:23], v[200:203], v[216:219], v[20:23]
    ds_read_b64 v[148:149], v88 offset:1280
    v_mfma_f32_16x16x32_bf16 v[12:15], v[192:195], v[216:219], v[12:15]
    ds_read_b128 a[148:151], v105 offset:4096
    v_mfma_f32_16x16x32_bf16 v[16:19], v[196:199], v[216:219], v[16:19]
    s_waitcnt lgkmcnt(6)
    buffer_load_dwordx4 v102, s[48:51], s98 offen offset:2048 lds
    v_mfma_f32_16x16x32_bf16 v[16:19], v[204:207], v[208:211], v[16:19]
    s_waitcnt vmcnt(11)
    ds_read_b64 v[150:151], v88 offset:1288
    s_add_u32 s75, s75, 10223616
    v_mfma_f32_16x16x32_bf16 v[20:23], v[204:207], v[212:215], v[20:23]
    ds_read_b128 v[168:171], v89 offset:1216
    v_mfma_f32_16x16x32_bf16 v[24:27], v[204:207], v[216:219], v[24:27]
    ds_read_b64 v[152:153], v88 offset:768
    v_mfma_f32_16x16x32_bf16 v[28:31], v[204:207], v[220:223], v[28:31]
    ds_read_b128 a[208:211], v104 offset:6144
    buffer_load_dwordx4 v103, s[48:51], s98 offen offset:3072 lds
    v_mfma_f32_16x16x32_bf16 v[16:19], v[192:195], v[220:223], v[16:19]
    ds_read_b64 v[154:155], v88 offset:776
    v_and_b32 v112, 15, v1
    v_mfma_f32_16x16x32_bf16 v[20:23], v[196:199], v[220:223], v[20:23]
    ds_read_b128 a[212:215], v105 offset:6144
    s_add_u32 m0, s95, 4096
    v_mfma_f32_16x16x32_bf16 v[24:27], v[200:203], v[220:223], v[24:27]
    v_cvt_pk_bf16_f32 v140, v132, v136
    v_cvt_pk_bf16_f32 v141, v133, v137
    v_cvt_pk_bf16_f32 v142, v134, v138
    v_cvt_pk_bf16_f32 v143, v135, v139
    s_waitcnt lgkmcnt(6)
    buffer_load_dwordx4 v70, s[48:51], s98 offen offset:0 lds
    v_mfma_f32_16x16x32_bf16 v[20:23], v[192:195], v[224:227], v[20:23]
    s_waitcnt vmcnt(11)
    ds_read_b128 v[172:175], v89 offset:1728
    v_lshrrev_b32 v113, 4, v1
    v_mfma_f32_16x16x32_bf16 v[24:27], v[196:199], v[224:227], v[24:27]
    ds_read_b64 v[156:157], v88 offset:256
    v_mfma_f32_16x16x32_bf16 v[28:31], v[200:203], v[224:227], v[28:31]
    ds_read_b64 v[158:159], v88 offset:264
    v_mfma_f32_16x16x32_bf16 v[32:35], v[204:207], v[224:227], v[32:35]
    ds_read_b128 a[24:27], v104 offset:8192
    buffer_load_dwordx4 v71, s[48:51], s98 offen offset:1024 lds
    v_mfma_f32_16x16x32_bf16 v[24:27], v[192:195], v[228:231], v[24:27]
    ds_read_b128 v[176:179], v89 offset:2240
    v_lshl_add_u32 v113, v112, 2, v113
    v_mfma_f32_16x16x32_bf16 v[28:31], v[196:199], v[228:231], v[28:31]
    ds_read_b128 v[180:183], v89 offset:2752
    v_mfma_f32_16x16x32_bf16 v[32:35], v[200:203], v[228:231], v[32:35]
    ds_read_b128 a[28:31], v105 offset:8192
    s_waitcnt lgkmcnt(7)
    buffer_load_dwordx4 v72, s[48:51], s98 offen offset:2048 lds
    v_mfma_f32_16x16x32_bf16 v[28:31], v[192:195], v[232:235], v[28:31]
    s_waitcnt vmcnt(11)
    ds_read_b128 v[184:187], v89 offset:3264
    v_bfe_u32 v112, v112, 1, 2
    v_mfma_f32_16x16x32_bf16 v[32:35], v[196:199], v[232:235], v[32:35]
    ds_read_b128 v[188:191], v89 offset:3776
    v_mfma_f32_16x16x32_bf16 v[32:35], v[192:195], v[236:239], v[32:35]
    ds_read_b64 v[128:129], v89 offset:1464
    v_mfma_f32_16x16x32_bf16 v[24:27], v[140:143], v[240:243], v[24:27]
    ds_read_b128 a[88:91], v104 offset:10240
    buffer_load_dwordx4 v73, s[48:51], s98 offen offset:3072 lds
    ds_read_b64 v[130:131], v89 offset:1472
    s_add_u32 s98, s98, 128
    s_and_b32 s98, s98, 1023
    v_mfma_f32_16x16x32_bf16 v[28:31], v[140:143], v[244:247], v[28:31]
    ds_read_b128 a[92:95], v105 offset:10240
    s_add_u32 m0, s95, 8192
    v_mfma_f32_16x16x32_bf16 v[32:35], v[140:143], v[248:251], v[32:35]
    s_waitcnt lgkmcnt(6)
    buffer_load_dwordx4 v100, s[48:51], s98 offen offset:0 lds
    v_xor_b32 v112, v112, v113
    s_waitcnt lgkmcnt(1)
    v_mfma_f32_16x16x32_bf16 v[132:135], v[128:131], v[116:119], 0
    s_waitcnt vmcnt(11)
    ds_read_b128 v[208:211], v89 offset:128
    v_mfma_f32_16x16x32_bf16 v[136:139], v[128:131], v[120:123], 0
    ds_read_b128 a[152:155], v104 offset:12288
    v_mfma_f32_16x16x32_bf16 v[4:7], v[144:147], v[160:163], v[4:7]
    buffer_load_dwordx4 v101, s[48:51], s98 offen offset:1024 lds
    s_add_u32 s73, s95, 14336
    v_mfma_f32_16x16x32_bf16 v[8:11], v[148:151], v[160:163], v[8:11]
    ds_read_b64 v[192:193], v88 offset:1728
    v_mfma_f32_16x16x32_bf16 v[12:15], v[148:151], v[164:167], v[12:15]
    ds_read_b64 v[194:195], v88 offset:1736
    v_mfma_f32_16x16x32_bf16 v[8:11], v[144:147], v[164:167], v[8:11]
    ds_read_b128 a[156:159], v105 offset:12288
    v_lshl_add_u32 v97, v112, 4, s73
    v_mfma_f32_16x16x32_bf16 v[12:15], v[152:155], v[160:163], v[12:15]
    s_waitcnt lgkmcnt(5)
    buffer_load_dwordx4 v102, s[48:51], s98 offen offset:2048 lds
    v_mfma_f32_16x16x32_bf16 v[16:19], v[152:155], v[164:167], v[16:19]
    s_waitcnt vmcnt(11)
    ds_read_b128 v[212:215], v89 offset:640
    v_mfma_f32_16x16x32_bf16 v[20:23], v[152:155], v[168:171], v[20:23]
    ds_read_b64 v[196:197], v88 offset:1216
    v_mfma_f32_16x16x32_bf16 v[12:15], v[144:147], v[168:171], v[12:15]
    ds_read_b64 v[198:199], v88 offset:1224
    v_lshrrev_b32 v112, 1, v0
    v_mfma_f32_16x16x32_bf16 v[16:19], v[148:151], v[168:171], v[16:19]
    ds_read_b128 a[216:219], v104 offset:14336
    v_mfma_f32_16x16x32_bf16 v[16:19], v[156:159], v[160:163], v[16:19]
    buffer_load_dwordx4 v103, s[48:51], s98 offen offset:3072 lds
    v_mfma_f32_16x16x32_bf16 v[20:23], v[156:159], v[164:167], v[20:23]
    ds_read_b128 v[216:219], v89 offset:1152
    v_mfma_f32_16x16x32_bf16 v[24:27], v[156:159], v[168:171], v[24:27]
    ds_read_b64 v[200:201], v88 offset:704
    v_bfe_u32 v113, v0, 4, 2
    v_mfma_f32_16x16x32_bf16 v[28:31], v[156:159], v[172:175], v[28:31]
    ds_read_b128 a[220:223], v105 offset:14336
    s_add_u32 m0, s95, 12288
    s_waitcnt lgkmcnt(7)
    buffer_load_dwordx4 v70, s[48:51], s98 offen offset:0 lds
    v_mfma_f32_16x16x32_bf16 v[16:19], v[144:147], v[172:175], v[16:19]
    s_waitcnt vmcnt(11)
    ds_read_b64 v[202:203], v88 offset:712
    v_mfma_f32_16x16x32_bf16 v[20:23], v[148:151], v[172:175], v[20:23]
    ds_read_b128 v[220:223], v89 offset:1664
    v_xor_b32 v112, v112, v113
    v_mfma_f32_16x16x32_bf16 v[24:27], v[152:155], v[172:175], v[24:27]
    v_cvt_pk_bf16_f32 v140, v132, v136
    v_cvt_pk_bf16_f32 v141, v133, v137
    v_cvt_pk_bf16_f32 v142, v134, v138
    v_cvt_pk_bf16_f32 v143, v135, v139
    v_mfma_f32_16x16x32_bf16 v[20:23], v[144:147], v[176:179], v[20:23]
    ds_read_b128 a[32:35], v104 offset:0
    buffer_load_dwordx4 v71, s[48:51], s98 offen offset:1024 lds
    v_mfma_f32_16x16x32_bf16 v[24:27], v[148:151], v[176:179], v[24:27]
    ds_read_b64 v[204:205], v88 offset:192
    v_mfma_f32_16x16x32_bf16 v[28:31], v[152:155], v[176:179], v[28:31]
    ds_read_b64 v[206:207], v88 offset:200
    v_and_b32 v113, 1, v0
    v_mfma_f32_16x16x32_bf16 v[32:35], v[156:159], v[176:179], v[32:35]
    ds_read_b128 a[36:39], v105 offset:0
    s_waitcnt lgkmcnt(6)
    buffer_load_dwordx4 v72, s[48:51], s98 offen offset:2048 lds
    v_mfma_f32_16x16x32_bf16 v[24:27], v[144:147], v[180:183], v[24:27]
    s_waitcnt vmcnt(11)
    ds_read_b128 v[224:227], v89 offset:2176
    v_mfma_f32_16x16x32_bf16 v[28:31], v[148:151], v[180:183], v[28:31]
    ds_read_b128 v[228:231], v89 offset:2688
    v_mfma_f32_16x16x32_bf16 v[32:35], v[152:155], v[180:183], v[32:35]
    ds_read_b128 v[232:235], v89 offset:3200
    v_lshlrev_b32 v113, 3, v113
    v_mfma_f32_16x16x32_bf16 v[28:31], v[144:147], v[184:187], v[28:31]
    ds_read_b128 a[96:99], v104 offset:2048
    buffer_load_dwordx4 v73, s[48:51], s98 offen offset:3072 lds
    s_add_u32 s98, s98, 128
    s_and_b32 s98, s98, 1023
    v_mfma_f32_16x16x32_bf16 v[32:35], v[148:151], v[184:187], v[32:35]
    ds_read_b128 v[236:239], v89 offset:3712
    v_mfma_f32_16x16x32_bf16 v[32:35], v[144:147], v[188:191], v[32:35]
    ds_read_b64 v[128:129], v89 offset:1976
    ds_read_b64 v[130:131], v89 offset:1984
    v_mfma_f32_16x16x32_bf16 v[28:31], v[140:143], v[240:243], v[28:31]
    ds_read_b128 a[100:103], v105 offset:2048
    s_add_u32 m0, s95, 0
    s_waitcnt lgkmcnt(8)
    buffer_load_dwordx4 v100, s[48:51], s98 offen offset:0 lds
    v_mfma_f32_16x16x32_bf16 v[32:35], v[140:143], v[244:247], v[32:35]
    s_waitcnt vmcnt(11)
    ds_read_b128 a[160:163], v104 offset:4096
    v_lshl_add_u32 v112, v112, 4, v113
    s_waitcnt lgkmcnt(2)
    v_mfma_f32_16x16x32_bf16 v[132:135], v[128:131], v[116:119], 0
    buffer_load_dwordx4 v101, s[48:51], s98 offen offset:1024 lds
    v_mfma_f32_16x16x32_bf16 v[136:139], v[128:131], v[120:123], 0
    ds_read_b128 v[160:163], v89 offset:64
    v_add_u32 v98, 88064, v112
    v_mfma_f32_16x16x32_bf16 v[4:7], v[192:195], v[208:211], v[4:7]
    ds_read_b64 v[144:145], v88 offset:1664
    v_mfma_f32_16x16x32_bf16 v[8:11], v[196:199], v[208:211], v[8:11]
    ds_read_b128 a[164:167], v105 offset:4096
    v_mfma_f32_16x16x32_bf16 v[12:15], v[196:199], v[212:215], v[12:15]
    s_waitcnt lgkmcnt(4)
    buffer_load_dwordx4 v102, s[48:51], s98 offen offset:2048 lds
    v_mfma_f32_16x16x32_bf16 v[8:11], v[192:195], v[212:215], v[8:11]
    s_waitcnt vmcnt(11)
    ds_read_b64 v[146:147], v88 offset:1672
    v_add_u32 v99, 133120, v112
    v_mfma_f32_16x16x32_bf16 v[12:15], v[200:203], v[208:211], v[12:15]
    ds_read_b128 v[164:167], v89 offset:576
    v_mfma_f32_16x16x32_bf16 v[16:19], v[200:203], v[212:215], v[16:19]
    ds_read_b128 a[224:227], v104 offset:6144
    v_mfma_f32_16x16x32_bf16 v[20:23], v[200:203], v[216:219], v[20:23]
    buffer_load_dwordx4 v103, s[48:51], s98 offen offset:3072 lds
    v_min_u32 v114, 47, v1
    v_mfma_f32_16x16x32_bf16 v[12:15], v[192:195], v[216:219], v[12:15]
    ds_read_b64 v[148:149], v88 offset:1152
    v_mfma_f32_16x16x32_bf16 v[16:19], v[196:199], v[216:219], v[16:19]
    ds_read_b64 v[150:151], v88 offset:1160
    v_mfma_f32_16x16x32_bf16 v[16:19], v[204:207], v[208:211], v[16:19]
    ds_read_b128 a[228:231], v105 offset:6144
    s_add_u32 m0, s95, 4096
    v_mfma_f32_16x16x32_bf16 v[20:23], v[204:207], v[212:215], v[20:23]
    s_waitcnt lgkmcnt(6)
    buffer_load_dwordx4 v70, s[48:51], s98 offen offset:0 lds
    v_lshlrev_b32 v114, 4, v114
    v_mfma_f32_16x16x32_bf16 v[24:27], v[204:207], v[216:219], v[24:27]
    s_waitcnt vmcnt(11)
    ds_read_b128 v[168:171], v89 offset:1088
    v_mfma_f32_16x16x32_bf16 v[28:31], v[204:207], v[220:223], v[28:31]
    ds_read_b64 v[152:153], v88 offset:640
    v_mfma_f32_16x16x32_bf16 v[16:19], v[192:195], v[220:223], v[16:19]
    ds_read_b128 a[40:43], v104 offset:8192
    v_mfma_f32_16x16x32_bf16 v[20:23], v[196:199], v[220:223], v[20:23]
    buffer_load_dwordx4 v71, s[48:51], s98 offen offset:1024 lds
    v_cmp_gt_u32 vcc, 24, v1
    v_mfma_f32_16x16x32_bf16 v[24:27], v[200:203], v[220:223], v[24:27]
    s_nop 0
    v_cvt_pk_bf16_f32 v140, v132, v136
    v_cvt_pk_bf16_f32 v141, v133, v137
    v_cvt_pk_bf16_f32 v142, v134, v138
    v_cvt_pk_bf16_f32 v143, v135, v139
    ds_read_b64 v[154:155], v88 offset:648
    v_mfma_f32_16x16x32_bf16 v[20:23], v[192:195], v[224:227], v[20:23]
    ds_read_b128 v[172:175], v89 offset:1600
    v_mfma_f32_16x16x32_bf16 v[24:27], v[196:199], v[224:227], v[24:27]
    ds_read_b128 a[44:47], v105 offset:8192
    s_waitcnt lgkmcnt(6)
    buffer_load_dwordx4 v72, s[48:51], s98 offen offset:2048 lds
    v_mfma_f32_16x16x32_bf16 v[28:31], v[200:203], v[224:227], v[28:31]
    s_waitcnt vmcnt(11)
    ds_read_b64 v[156:157], v88 offset:128
    v_add_u32 v115, 2688, v114
    v_mfma_f32_16x16x32_bf16 v[32:35], v[204:207], v[224:227], v[32:35]
    ds_read_b64 v[158:159], v88 offset:136
    v_mfma_f32_16x16x32_bf16 v[24:27], v[192:195], v[228:231], v[24:27]
    ds_read_b128 v[176:179], v89 offset:2112
    v_mfma_f32_16x16x32_bf16 v[28:31], v[196:199], v[228:231], v[28:31]
    ds_read_b128 a[104:107], v104 offset:10240
    buffer_load_dwordx4 v73, s[48:51], s98 offen offset:3072 lds
    s_add_u32 s98, s98, 128
    s_and_b32 s98, s98, 1023
    v_mfma_f32_16x16x32_bf16 v[32:35], v[200:203], v[228:231], v[32:35]
    ds_read_b128 v[180:183], v89 offset:2624
    v_cndmask_b32 v114, v115, v114, vcc
    v_mfma_f32_16x16x32_bf16 v[28:31], v[192:195], v[232:235], v[28:31]
    ds_read_b128 v[184:187], v89 offset:3136
    v_mfma_f32_16x16x32_bf16 v[32:35], v[196:199], v[232:235], v[32:35]
    ds_read_b128 a[108:111], v105 offset:10240
    ds_read_b128 v[188:191], v89 offset:3648
    s_add_u32 m0, s95, 8192
    s_waitcnt lgkmcnt(8)
    buffer_load_dwordx4 v100, s[48:51], s98 offen offset:0 lds
    v_mfma_f32_16x16x32_bf16 v[32:35], v[192:195], v[236:239], v[32:35]
    s_waitcnt vmcnt(11)
    ds_read_b128 a[168:171], v104 offset:12288
    v_mfma_f32_16x16x32_bf16 v[32:35], v[140:143], v[240:243], v[32:35]
    buffer_load_dwordx4 v101, s[48:51], s98 offen offset:1024 lds
    v_mfma_f32_16x16x32_bf16 v[4:7], v[144:147], v[160:163], v[4:7]
    ds_read_b128 v[208:211], v89 offset:0
    v_mfma_f32_16x16x32_bf16 v[8:11], v[148:151], v[160:163], v[8:11]
    ds_read_b128 a[172:175], v105 offset:12288
    v_mfma_f32_16x16x32_bf16 v[12:15], v[148:151], v[164:167], v[12:15]
    s_waitcnt lgkmcnt(4)
    buffer_load_dwordx4 v102, s[48:51], s98 offen offset:2048 lds
    v_mfma_f32_16x16x32_bf16 v[8:11], v[144:147], v[164:167], v[8:11]
    ds_read_b64 v[192:193], v88 offset:1600
    v_mfma_f32_16x16x32_bf16 v[12:15], v[152:155], v[160:163], v[12:15]
    s_waitcnt vmcnt(11)
    ds_read_b64 v[194:195], v88 offset:1608
    v_mfma_f32_16x16x32_bf16 v[16:19], v[152:155], v[164:167], v[16:19]
    ds_read_b128 v[212:215], v89 offset:512
    v_mfma_f32_16x16x32_bf16 v[20:23], v[152:155], v[168:171], v[20:23]
    ds_read_b128 a[232:235], v104 offset:14336
    v_mfma_f32_16x16x32_bf16 v[12:15], v[144:147], v[168:171], v[12:15]
    buffer_load_dwordx4 v103, s[48:51], s98 offen offset:3072 lds
    v_mfma_f32_16x16x32_bf16 v[16:19], v[148:151], v[168:171], v[16:19]
    ds_read_b64 v[196:197], v88 offset:1088
    v_mfma_f32_16x16x32_bf16 v[16:19], v[156:159], v[160:163], v[16:19]
    ds_read_b64 v[198:199], v88 offset:1096
    v_mfma_f32_16x16x32_bf16 v[20:23], v[156:159], v[164:167], v[20:23]
    ds_read_b128 a[236:239], v105 offset:14336
    s_add_u32 m0, s95, 12288
    v_mfma_f32_16x16x32_bf16 v[24:27], v[156:159], v[168:171], v[24:27]
    s_waitcnt lgkmcnt(7)
    buffer_load_dwordx4 v70, s[48:51], s98 offen offset:0 lds
    v_mfma_f32_16x16x32_bf16 v[28:31], v[156:159], v[172:175], v[28:31]
    s_waitcnt vmcnt(11)
    ds_read_b128 v[216:219], v89 offset:1024
    v_mfma_f32_16x16x32_bf16 v[16:19], v[144:147], v[172:175], v[16:19]
    ds_read_b64 v[200:201], v88 offset:576
    v_mfma_f32_16x16x32_bf16 v[20:23], v[148:151], v[172:175], v[20:23]
    ds_read_b64 v[202:203], v88 offset:584
    v_mfma_f32_16x16x32_bf16 v[24:27], v[152:155], v[172:175], v[24:27]
    ds_read_b128 a[48:51], v104 offset:0
    buffer_load_dwordx4 v71, s[48:51], s98 offen offset:1024 lds
    v_mfma_f32_16x16x32_bf16 v[20:23], v[144:147], v[176:179], v[20:23]
    ds_read_b128 v[220:223], v89 offset:1536
    v_mfma_f32_16x16x32_bf16 v[24:27], v[148:151], v[176:179], v[24:27]
    ds_read_b64 v[204:205], v88 offset:64
    v_mfma_f32_16x16x32_bf16 v[28:31], v[152:155], v[176:179], v[28:31]
    ds_read_b128 a[52:55], v105 offset:0
    s_waitcnt lgkmcnt(7)
    buffer_load_dwordx4 v72, s[48:51], s98 offen offset:2048 lds
    v_mfma_f32_16x16x32_bf16 v[32:35], v[156:159], v[176:179], v[32:35]
    s_waitcnt vmcnt(11)
    ds_read_b64 v[206:207], v88 offset:72
    v_mfma_f32_16x16x32_bf16 v[24:27], v[144:147], v[180:183], v[24:27]
    ds_read_b128 v[224:227], v89 offset:2048
    v_mfma_f32_16x16x32_bf16 v[28:31], v[148:151], v[180:183], v[28:31]
    ds_read_b128 v[228:231], v89 offset:2560
    v_mfma_f32_16x16x32_bf16 v[32:35], v[152:155], v[180:183], v[32:35]
    ds_read_b128 a[112:115], v104 offset:2048
    buffer_load_dwordx4 v73, s[48:51], s98 offen offset:3072 lds
    buffer_load_dword v110, v107, s[60:63], 0 offen sc1
    v_mfma_f32_16x16x32_bf16 v[28:31], v[144:147], v[184:187], v[28:31]
    ds_read_b128 v[232:235], v89 offset:3072
    ds_read_b128 v[236:239], v89 offset:3584
    v_mfma_f32_16x16x32_bf16 v[32:35], v[148:151], v[184:187], v[32:35]
    ds_read_b128 a[116:119], v105 offset:2048
    v_mfma_f32_16x16x32_bf16 v[32:35], v[144:147], v[188:191], v[32:35]
    s_waitcnt lgkmcnt(1)
    s_waitcnt vmcnt(11)
    ds_read_b128 a[176:179], v104 offset:4096
    v_mfma_f32_16x16x32_bf16 v[32:35], v[192:195], v[236:239], v[32:35]
    ds_read_b128 a[180:183], v105 offset:4096
    v_mfma_f32_16x16x32_bf16 v[32:35], v[196:199], v[232:235], v[32:35]
    v_mfma_f32_16x16x32_bf16 v[32:35], v[200:203], v[228:231], v[32:35]
    s_waitcnt vmcnt(9)
    ds_read_b128 a[240:243], v104 offset:6144
    v_and_b32 v102, 7, v1
    v_mfma_f32_16x16x32_bf16 v[32:35], v[204:207], v[224:227], v[32:35]
    v_bfe_u32 v91, v1, 3, 1
    v_mfma_f32_16x16x32_bf16 v[28:31], v[192:195], v[232:235], v[28:31]
    ds_read_b128 a[244:247], v105 offset:6144
    v_lshrrev_b32 v103, 4, v1
    v_mfma_f32_16x16x32_bf16 v[28:31], v[196:199], v[228:231], v[28:31]
    v_lshl_add_u32 v111, v102, 1, v91
    v_mfma_f32_16x16x32_bf16 v[28:31], v[200:203], v[224:227], v[28:31]
    v_lshlrev_b32 v90, 4, v102
    v_mfma_f32_16x16x32_bf16 v[28:31], v[204:207], v[220:223], v[28:31]
    s_waitcnt vmcnt(7)
    ds_read_b128 a[56:59], v104 offset:8192
    v_lshl_add_u32 v90, v103, 14, v90
    v_mfma_f32_16x16x32_bf16 v[24:27], v[192:195], v[228:231], v[24:27]
    v_lshl_add_u32 v90, v91, 16, v90
    v_mfma_f32_16x16x32_bf16 v[24:27], v[196:199], v[224:227], v[24:27]
    ds_read_b128 a[60:63], v105 offset:8192
    v_and_b32 v102, 15, v1
    v_mfma_f32_16x16x32_bf16 v[24:27], v[200:203], v[220:223], v[24:27]
    s_lshl_b32 s72, s67, 2
    v_mfma_f32_16x16x32_bf16 v[24:27], v[204:207], v[216:219], v[24:27]
    ds_write_b128 v97, v[32:35] offset:7168
    v_mfma_f32_16x16x32_bf16 v[20:23], v[192:195], v[224:227], v[20:23]
    s_waitcnt vmcnt(5)
    ds_read_b128 a[120:123], v104 offset:10240
    s_add_u32 s74, s72, s64
    v_mfma_f32_16x16x32_bf16 v[20:23], v[196:199], v[220:223], v[20:23]
    ds_read_b128 a[124:127], v105 offset:10240
    s_lshl_b32 s92, s74, 7
    v_mfma_f32_16x16x32_bf16 v[20:23], v[200:203], v[216:219], v[20:23]
    s_add_u32 s92, s92, 1048576
    v_mov_b32 v94, v106
    v_mfma_f32_16x16x32_bf16 v[20:23], v[204:207], v[212:215], v[20:23]
    ds_write_b128 v97, v[28:31] offset:6144
    v_mfma_f32_16x16x32_bf16 v[16:19], v[192:195], v[220:223], v[16:19]
    s_waitcnt vmcnt(3)
    ds_read_b128 a[184:187], v104 offset:12288
    v_add_u32 v95, 57344, v106
    v_mfma_f32_16x16x32_bf16 v[16:19], v[196:199], v[216:219], v[16:19]
    v_add_u32 v96, 114688, v106
    s_add_u32 s72, s95, 6144
    v_mfma_f32_16x16x32_bf16 v[16:19], v[200:203], v[212:215], v[16:19]
    ds_read_b128 a[188:191], v105 offset:12288
    v_lshl_add_u32 v100, v102, 2, s72
    v_mfma_f32_16x16x32_bf16 v[16:19], v[204:207], v[208:211], v[16:19]
    ds_write_b128 v97, v[24:27] offset:5120
    v_mfma_f32_16x16x32_bf16 v[12:15], v[192:195], v[216:219], v[12:15]
    s_waitcnt vmcnt(1)
    ds_read_b128 a[248:251], v104 offset:14336
    v_lshl_add_u32 v101, v103, 4, s72
    v_mfma_f32_16x16x32_bf16 v[12:15], v[196:199], v[212:215], v[12:15]
    v_mov_b32 v144, s90
    v_mov_b32 v145, s90
    v_mfma_f32_16x16x32_bf16 v[12:15], v[200:203], v[208:211], v[12:15]
    ds_write_b128 v97, v[20:23] offset:4096
    v_mfma_f32_16x16x32_bf16 v[8:11], v[192:195], v[212:215], v[8:11]
    ds_read_b128 a[252:255], v105 offset:14336
    v_mov_b32 v146, s90
    v_mfma_f32_16x16x32_bf16 v[8:11], v[196:199], v[208:211], v[8:11]
    ds_write_b128 v97, v[16:19] offset:3072
    v_mfma_f32_16x16x32_bf16 v[4:7], v[192:195], v[208:211], v[4:7]
    s_nop 0
    ds_write_b128 v97, v[12:15] offset:2048
    v_mov_b32 v147, s90
    s_nop 2
    ds_write_b128 v97, v[8:11] offset:1024
    s_nop 0
    ds_write_b128 v97, v[4:7] offset:0
    s_waitcnt lgkmcnt(4)
    s_waitcnt vmcnt(0)
    v_xor_b32 v112, v110, v2
    v_cmp_ne_u32 vcc, 0, v112
    s_cbranch_vccnz L_stub_flgc
L_ok_flgc:
    s_add_u32 m0, s71, 12288
    s_add_u32 s78, s75, 983040
    buffer_load_dwordx4 v106, s[60:63], s78 offen offset:0 sc1 lds
    buffer_load_dwordx4 v106, s[60:63], s78 offen offset:1024 sc1 lds
    buffer_load_dwordx4 v106, s[60:63], s78 offen offset:2048 sc1 lds
    buffer_load_dwordx4 v106, s[60:63], s78 offen offset:3072 sc1 lds
    s_add_u32 m0, s71, 16384
    s_add_u32 s78, s75, 987136
    buffer_load_dwordx4 v106, s[60:63], s78 offen offset:0 sc1 lds
    buffer_load_dwordx4 v106, s[60:63], s78 offen offset:1024 sc1 lds
    s_waitcnt lgkmcnt(0)
    s_barrier
    ds_read_b64 v[148:149], v98 offset:0
    ds_read_b64 v[156:157], v98 offset:22528
    ds_read_b64 v[164:165], v99 offset:0
    ds_read_b64 v[172:173], v99 offset:22528
    ds_read_b64 v[150:151], v98 offset:2048
    ds_read_b64 v[158:159], v98 offset:24576
    ds_read_b64 v[166:167], v99 offset:2048
    ds_read_b64 v[174:175], v99 offset:24576
    ds_read_b64 v[152:153], v98 offset:4096
    ds_read_b64 v[160:161], v98 offset:26624
    ds_read_b64 v[168:169], v99 offset:4096
    ds_read_b64 v[176:177], v99 offset:26624
    ds_read_b64 v[154:155], v98 offset:6144
    ds_read_b64 v[162:163], v98 offset:28672
    ds_read_b64 v[170:171], v99 offset:6144
    ds_read_b64 v[178:179], v99 offset:28672
    s_waitcnt lgkmcnt(12)
    s_nop 0
    v_pk_add_f32 v[148:149], v[148:149], v[36:37]
    v_pk_add_f32 v[156:157], v[156:157], v[44:45]
    v_pk_add_f32 v[164:165], v[164:165], v[52:53]
    v_pk_add_f32 v[172:173], v[172:173], v[60:61]
    v_cvt_pk_bf16_f32 v180, v148, v156
    v_cvt_pk_bf16_f32 v181, v164, v172
    v_cvt_pk_bf16_f32 v182, v149, v157
    v_cvt_pk_bf16_f32 v183, v165, v173
    buffer_store_dwordx4 v[180:183], v109, s[60:63], s79 offen sc1
    s_add_u32 s79, s79, 4096
    s_waitcnt lgkmcnt(8)
    s_nop 0
    v_pk_add_f32 v[150:151], v[150:151], v[38:39]
    v_pk_add_f32 v[158:159], v[158:159], v[46:47]
    v_pk_add_f32 v[166:167], v[166:167], v[54:55]
    v_pk_add_f32 v[174:175], v[174:175], v[62:63]
    v_cvt_pk_bf16_f32 v184, v150, v158
    v_cvt_pk_bf16_f32 v185, v166, v174
    v_cvt_pk_bf16_f32 v186, v151, v159
    v_cvt_pk_bf16_f32 v187, v167, v175
    buffer_store_dwordx4 v[184:187], v109, s[60:63], s79 offen sc1
    s_add_u32 s79, s79, 4096
    s_waitcnt lgkmcnt(4)
    s_nop 0
    v_pk_add_f32 v[152:153], v[152:153], v[40:41]
    v_pk_add_f32 v[160:161], v[160:161], v[48:49]
    v_pk_add_f32 v[168:169], v[168:169], v[56:57]
    v_pk_add_f32 v[176:177], v[176:177], v[64:65]
    v_cvt_pk_bf16_f32 v188, v152, v160
    v_cvt_pk_bf16_f32 v189, v168, v176
    v_cvt_pk_bf16_f32 v190, v153, v161
    v_cvt_pk_bf16_f32 v191, v169, v177
    buffer_store_dwordx4 v[188:191], v109, s[60:63], s79 offen sc1
    s_add_u32 s79, s79, 4096
    s_waitcnt lgkmcnt(0)
    s_nop 0
    v_pk_add_f32 v[154:155], v[154:155], v[42:43]
    v_pk_add_f32 v[162:163], v[162:163], v[50:51]
    v_pk_add_f32 v[170:171], v[170:171], v[58:59]
    v_pk_add_f32 v[178:179], v[178:179], v[66:67]
    v_cvt_pk_bf16_f32 v192, v154, v162
    v_cvt_pk_bf16_f32 v193, v170, v178
    v_cvt_pk_bf16_f32 v194, v155, v163
    v_cvt_pk_bf16_f32 v195, v171, v179
    buffer_store_dwordx4 v[192:195], v109, s[60:63], s79 offen sc1
    s_add_u32 m0, s95, 0
    s_nop 0
    s_add_u32 s78, s75, 1007616
    buffer_load_dwordx4 v106, s[60:63], s78 offen offset:0 sc1 lds
    buffer_load_dwordx4 v106, s[60:63], s78 offen offset:1024 sc1 lds
    buffer_load_dwordx4 v106, s[60:63], s78 offen offset:2048 sc1 lds
    buffer_load_dwordx4 v106, s[60:63], s78 offen offset:3072 sc1 lds
    s_add_u32 m0, s95, 4096
    s_add_u32 s78, s75, 1011712
    buffer_load_dwordx4 v106, s[60:63], s78 offen offset:0 sc1 lds
    buffer_load_dwordx4 v106, s[60:63], s78 offen offset:1024 sc1 lds
L_join:
    s_lshl_b32 s93, s74, 10
    s_add_u32 m0, s95, 6144
    s_add_u32 s93, s93, 3670016
    s_lshl_b32 s12, s68, 7
    s_add_u32 s12, s12, s93
    s_mul_i32 s14, s74, 24576
    s_mul_i32 s78, s68, 384
    s_lshl_b32 s72, s68, 10
    s_add_u32 s14, s14, s72
    s_nop 0
    s_add_u32 s14, s14, 6946816
    s_add_u32 s16, s14, 8192
    s_add_u32 s78, s78, 40960
    s_add_u32 s20, s14, 16384
    s_mul_i32 s94, s68, 393216
    s_add_u32 s94, s94, 3801088
    s_lshr_b32 s72, s74, 1
    buffer_load_dwordx4 v114, s[60:63], s78 offen sc1 lds
    s_lshl_b32 s72, s72, 11
    s_and_b32 s73, s64, 1
    s_lshl_b32 s73, s73, 9
    s_add_u32 s72, s72, s73
    s_add_u32 m0, s95, 8192
    s_add_u32 s13, s72, s94
    s_add_u32 s21, s13, 131072
    s_add_u32 s22, s13, 262144
    s_lshl_b32 s23, s64, 15
    s_add_u32 s78, s75, 1032192
    s_lshl_b32 s72, s68, 7
    s_add_u32 s23, s23, s72
    s_add_u32 s23, s23, 3670016
    s_mul_i32 s15, s70, 122880
    buffer_load_dwordx4 v106, s[60:63], s78 offen offset:0 sc1 lds
    s_mul_i32 s72, s64, 15360
    s_add_u32 s15, s15, s72
    s_add_u32 s15, s15, 12189696
    s_mov_b32 s80, 0x22222222
    buffer_load_dwordx4 v106, s[60:63], s78 offen offset:1024 sc1 lds
    s_mov_b32 s81, 0x22222222
    s_mov_b32 s82, 0x44444444
    s_mov_b32 s83, 0x44444444
    s_mov_b32 s84, 0x88888888
    buffer_load_dwordx4 v106, s[60:63], s78 offen offset:2048 sc1 lds
    s_mov_b32 s85, 0x88888888
    v_and_b32 v103, 15, v1
    v_lshrrev_b32 v104, 2, v103
    v_lshl_add_u32 v104, v104, 4, v103
    buffer_load_dwordx4 v106, s[60:63], s78 offen offset:3072 sc1 lds
    v_lshlrev_b32 v97, 2, v104
    v_lshrrev_b32 v104, 4, v1
    v_mul_u32_u24 v98, 80, v104
    v_and_b32 v105, 1, v1
    s_add_u32 m0, s95, 12288
    v_lshlrev_b32 v105, 4, v105
    v_lshl_add_u32 v93, v104, 5, v105
    v_bfe_u32 v105, v1, 1, 3
    v_lshl_add_u32 v91, v105, 7, v93
    s_add_u32 s78, s75, 1036288
    v_bfe_u32 v105, v1, 4, 1
    v_lshlrev_b32 v105, 8, v105
    v_lshl_add_u32 v103, v103, 4, v105
    v_lshrrev_b32 v105, 5, v1
    buffer_load_dwordx4 v106, s[60:63], s78 offen offset:0 sc1 lds
    v_lshl_add_u32 v99, v105, 10, v103
    v_and_b32 v107, 31, v1
    v_lshlrev_b32 v107, 10, v107
    v_mov_b32 v148, -1
    buffer_load_dwordx4 v106, s[60:63], s78 offen offset:1024 sc1 lds
    v_mov_b32 v149, -1
    v_mov_b32 v150, -1
    v_mov_b32 v151, -1
    s_lshl_b32 s3, s64, 8
    s_add_u32 s3, s3, s2
    s_cmp_ge_u32 s3, 96
    s_cbranch_scc1 L_ok_pre
    s_lshl_b32 s3, s2, 14
    s_add_u32 s3, s3, 1589240
    v_mov_b32 v7, 0
    buffer_load_dwordx2 v[4:5], v7, s[60:63], s3 offen sc1
    s_waitcnt vmcnt(0)
    v_max_u32 v6, v4, v5
    v_cmp_eq_u32 vcc, -1, v6
    s_cbranch_vccnz L_stub_pre
L_ok_pre:
    s_waitcnt vmcnt(7)
    s_barrier
    s_getpc_b64 s[38:39]
    s_lshl_b32 s3, s66, 2
    s_add_u32 s3, s3, s64
    s_lshl_b32 s3, s3, 7
    v_mov_b32 v206, s3
    global_load_dword v206, v206, s[38:39]
    s_add_u32 s91, s92, 0
    s_nop 0
    ds_read_b128 v[208:211], v94 offset:12288
    buffer_load_dwordx4 v[4:7], v90, s[60:63], s91 offen sc1
    ds_read_b128 v[212:215], v94 offset:13312
    s_add_u32 s91, s92, 131072
    buffer_load_dwordx4 v[8:11], v90, s[60:63], s91 offen sc1
    ds_read_b128 v[216:219], v94 offset:14336
    s_add_u32 s91, s92, 262144
    buffer_load_dwordx4 v[12:15], v90, s[60:63], s91 offen sc1
    ds_read_b128 v[220:223], v94 offset:15360
    s_add_u32 s91, s92, 393216
    ds_read_b128 v[224:227], v94 offset:16384
    buffer_load_dwordx4 v[16:19], v90, s[60:63], s91 offen sc1
    s_add_u32 s91, s92, 524288
    ds_read_b128 v[228:231], v94 offset:17408
    buffer_load_dwordx4 v[20:23], v90, s[60:63], s91 offen sc1
    s_add_u32 s91, s92, 655360
    ds_read_b128 v[232:235], v94 offset:30720
    buffer_load_dwordx4 v[24:27], v90, s[60:63], s91 offen sc1
    s_add_u32 s91, s92, 786432
    ds_read_b128 v[236:239], v94 offset:31744
    buffer_load_dwordx4 v[28:31], v90, s[60:63], s91 offen sc1
    ds_read_b128 v[240:243], v94 offset:32768
    s_add_u32 s91, s92, 917504
    buffer_load_dwordx4 v[32:35], v90, s[60:63], s91 offen sc1
    ds_read_b128 v[244:247], v94 offset:33792
    s_add_u32 s91, s92, 1048576
    buffer_load_dwordx4 v[36:39], v90, s[60:63], s91 offen sc1
    ds_read_b128 v[248:251], v94 offset:34816
    s_add_u32 s91, s92, 1179648
    ds_read_b128 v[252:255], v94 offset:35840
    buffer_load_dwordx4 v[40:43], v90, s[60:63], s91 offen sc1
    s_add_u32 s91, s92, 1310720
    ds_read_b128 v[172:175], v94 offset:49152
    buffer_load_dwordx4 v[44:47], v90, s[60:63], s91 offen sc1
    s_add_u32 s91, s92, 1441792
    ds_read_b128 v[176:179], v94 offset:50176
    buffer_load_dwordx4 v[48:51], v90, s[60:63], s91 offen sc1
    s_waitcnt vmcnt(8)
    s_nop 0
    v_max3_u32 v102, v4, v5, v6
    v_max3_u32 v102, v102, v7, v8
    v_max3_u32 v102, v102, v9, v10
    v_max3_u32 v102, v102, v11, v12
    v_max3_u32 v102, v102, v13, v14
    v_max3_u32 v102, v102, v15, v16
    v_max3_u32 v102, v102, v17, v18
    v_max_u32 v102, v102, v19
    v_cmp_eq_u32 vcc, -1, v102
    s_cbranch_vccnz L_stub_h0
L_ok_h0:
    v_mov_b64 v[206:207], v[6:7]
    v_mov_b32_dpp v6, v4 row_ror:8 row_mask:0xf bank_mask:0x3
    v_mov_b32_dpp v7, v5 row_ror:8 row_mask:0xf bank_mask:0x3
    v_mov_b32_dpp v4, v206 row_ror:8 row_mask:0xf bank_mask:0xc
    v_mov_b32_dpp v5, v207 row_ror:8 row_mask:0xf bank_mask:0xc
    s_waitcnt lgkmcnt(11)
    s_nop 0
    v_mfma_f32_16x16x32_bf16 v[112:115], v[4:7], v[208:211], 0
    ds_read_b128 v[180:183], v94 offset:51200
    s_add_u32 s91, s92, 1572864
    v_mfma_f32_16x16x32_bf16 v[116:119], v[4:7], v[212:215], 0
    ds_read_b128 v[184:187], v94 offset:52224
    v_mov_b64 v[206:207], v[10:11]
    v_mfma_f32_16x16x32_bf16 v[136:139], v[4:7], v[144:147], 0
    buffer_load_dwordx4 v[52:55], v90, s[60:63], s91 offen sc1
    s_add_u32 m0, s71, 0
    v_mfma_f32_16x16x32_bf16 v[120:123], v[4:7], v[216:219], 0
    s_waitcnt lgkmcnt(10)
    ds_read_b128 v[188:191], v94 offset:53248
    v_mov_b32_dpp v10, v8 row_ror:8 row_mask:0xf bank_mask:0x3
    v_mfma_f32_16x16x32_bf16 v[124:127], v[4:7], v[220:223], 0
    ds_read_b128 v[192:195], v94 offset:54272
    s_add_u32 s91, s92, 1703936
    v_mfma_f32_16x16x32_bf16 v[128:131], v[4:7], v[224:227], 0
    ds_read_b128 v[208:211], v95 offset:10240
    s_add_u32 s78, s75, 1056768
    v_mov_b32_dpp v11, v9 row_ror:8 row_mask:0xf bank_mask:0x3
    v_mfma_f32_16x16x32_bf16 v[140:143], v[4:7], v[4:7], 0
    buffer_load_dwordx4 v[56:59], v90, s[60:63], s91 offen sc1
    v_mov_b32_dpp v8, v206 row_ror:8 row_mask:0xf bank_mask:0xc
    v_mfma_f32_16x16x32_bf16 v[132:135], v[4:7], v[228:231], 0
    s_waitcnt lgkmcnt(10)
    ds_read_b128 v[212:215], v95 offset:11264
    v_mov_b32_dpp v9, v207 row_ror:8 row_mask:0xf bank_mask:0xc
    s_nop 1
    v_mfma_f32_16x16x32_bf16 v[112:115], v[8:11], v[232:235], v[112:115]
    ds_read_b128 v[216:219], v95 offset:12288
    s_add_u32 s91, s92, 1835008
    v_mov_b64 v[206:207], v[14:15]
    v_mfma_f32_16x16x32_bf16 v[116:119], v[8:11], v[236:239], v[116:119]
    buffer_load_dwordx4 v106, s[60:63], s78 offen offset:0 sc1 lds
    v_mov_b32_dpp v14, v12 row_ror:8 row_mask:0xf bank_mask:0x3
    v_mfma_f32_16x16x32_bf16 v[136:139], v[8:11], v[144:147], v[136:139]
    ds_read_b128 v[220:223], v95 offset:13312
    v_mov_b32_dpp v15, v13 row_ror:8 row_mask:0xf bank_mask:0x3
    v_mfma_f32_16x16x32_bf16 v[120:123], v[8:11], v[240:243], v[120:123]
    s_waitcnt lgkmcnt(10)
    buffer_load_dwordx4 v[60:63], v90, s[60:63], s91 offen sc1
    v_mov_b32_dpp v12, v206 row_ror:8 row_mask:0xf bank_mask:0xc
    v_mfma_f32_16x16x32_bf16 v[124:127], v[8:11], v[244:247], v[124:127]
    ds_read_b128 v[224:227], v95 offset:14336
    s_add_u32 s91, s92, 1966080
    v_mov_b32_dpp v13, v207 row_ror:8 row_mask:0xf bank_mask:0xc
    v_mfma_f32_16x16x32_bf16 v[128:131], v[8:11], v[248:251], v[128:131]
    buffer_load_dwordx4 v106, s[60:63], s78 offen offset:1024 sc1 lds
    v_mov_b64 v[206:207], v[18:19]
    v_mfma_f32_16x16x32_bf16 v[140:143], v[8:11], v[8:11], v[140:143]
    ds_read_b128 v[228:231], v95 offset:15360
    v_mov_b32_dpp v18, v16 row_ror:8 row_mask:0xf bank_mask:0x3
    v_mfma_f32_16x16x32_bf16 v[132:135], v[8:11], v[252:255], v[132:135]
    s_waitcnt lgkmcnt(9)
    ds_read_b128 v[232:235], v95 offset:16384
    v_mov_b32_dpp v19, v17 row_ror:8 row_mask:0xf bank_mask:0x3
    v_mfma_f32_16x16x32_bf16 v[112:115], v[12:15], v[172:175], v[112:115]
    buffer_load_dwordx4 v[64:67], v90, s[60:63], s91 offen sc1
    v_mov_b32_dpp v16, v206 row_ror:8 row_mask:0xf bank_mask:0xc
    v_mfma_f32_16x16x32_bf16 v[116:119], v[12:15], v[176:179], v[116:119]
    buffer_load_dwordx4 v106, s[60:63], s78 offen offset:2048 sc1 lds
    v_mov_b32_dpp v17, v207 row_ror:8 row_mask:0xf bank_mask:0xc
    v_mfma_f32_16x16x32_bf16 v[136:139], v[12:15], v[144:147], v[136:139]
    s_waitcnt vmcnt(11)
    ds_read_b128 v[236:239], v95 offset:17408
    v_max3_u32 v102, v20, v21, v22
    v_mfma_f32_16x16x32_bf16 v[120:123], v[12:15], v[180:183], v[120:123]
    s_waitcnt lgkmcnt(8)
    ds_read_b128 v[240:243], v95 offset:18432
    v_max3_u32 v102, v102, v23, v24
    v_mfma_f32_16x16x32_bf16 v[124:127], v[12:15], v[184:187], v[124:127]
    ds_read_b128 v[244:247], v95 offset:19456
    v_max3_u32 v102, v102, v25, v26
    v_mfma_f32_16x16x32_bf16 v[128:131], v[12:15], v[188:191], v[128:131]
    buffer_load_dwordx4 v106, s[60:63], s78 offen offset:3072 sc1 lds
    s_add_u32 m0, s71, 4096
    v_max3_u32 v102, v102, v27, v28
    v_mfma_f32_16x16x32_bf16 v[140:143], v[12:15], v[12:15], v[140:143]
    ds_read_b128 v[248:251], v95 offset:20480
    v_max3_u32 v102, v102, v29, v30
    v_max3_u32 v102, v102, v31, v32
    v_mfma_f32_16x16x32_bf16 v[132:135], v[12:15], v[192:195], v[132:135]
    s_waitcnt lgkmcnt(8)
    ds_read_b128 v[252:255], v95 offset:21504
    s_add_u32 s78, s75, 1060864
    v_max3_u32 v102, v102, v33, v34
    v_mfma_f32_16x16x32_bf16 v[112:115], v[16:19], v[208:211], v[112:115]
    ds_read_b128 v[172:175], v95 offset:38912
    v_max_u32 v102, v102, v35
    v_mfma_f32_16x16x32_bf16 v[116:119], v[16:19], v[212:215], v[116:119]
    ds_read_b128 v[176:179], v95 offset:39936
    v_cmp_eq_u32 vcc, -1, v102
    v_mfma_f32_16x16x32_bf16 v[136:139], v[16:19], v[144:147], v[136:139]
    ds_read_b128 v[180:183], v95 offset:40960
    s_cbranch_vccnz L_stub_h1
L_ok_h1:
    v_mfma_f32_16x16x32_bf16 v[120:123], v[16:19], v[216:219], v[120:123]
    s_waitcnt lgkmcnt(9)
    ds_read_b128 v[184:187], v95 offset:41984
    v_mov_b64 v[206:207], v[22:23]
    v_mfma_f32_16x16x32_bf16 v[124:127], v[16:19], v[220:223], v[124:127]
    buffer_load_dwordx4 v106, s[60:63], s78 offen offset:0 sc1 lds
    v_mov_b32_dpp v22, v20 row_ror:8 row_mask:0xf bank_mask:0x3
    v_mfma_f32_16x16x32_bf16 v[128:131], v[16:19], v[224:227], v[128:131]
    ds_read_b128 v[188:191], v95 offset:43008
    v_mov_b32_dpp v23, v21 row_ror:8 row_mask:0xf bank_mask:0x3
    v_mfma_f32_16x16x32_bf16 v[140:143], v[16:19], v[16:19], v[140:143]
    ds_read_b128 v[192:195], v95 offset:44032
    v_mov_b32_dpp v20, v206 row_ror:8 row_mask:0xf bank_mask:0xc
    v_mfma_f32_16x16x32_bf16 v[132:135], v[16:19], v[228:231], v[132:135]
    s_waitcnt lgkmcnt(9)
    ds_read_b128 v[208:211], v96 offset:4096
    v_mov_b32_dpp v21, v207 row_ror:8 row_mask:0xf bank_mask:0xc
    s_nop 1
    v_mfma_f32_16x16x32_bf16 v[112:115], v[20:23], v[232:235], v[112:115]
    buffer_load_dwordx4 v106, s[60:63], s78 offen offset:1024 sc1 lds
    s_add_u32 s91, s92, 2097152
    v_mfma_f32_16x16x32_bf16 v[116:119], v[20:23], v[236:239], v[116:119]
    ds_read_b128 v[212:215], v96 offset:5120
    s_add_u32 m0, s71, 6144
    v_mfma_f32_16x16x32_bf16 v[136:139], v[20:23], v[144:147], v[136:139]
    ds_read_b128 v[216:219], v96 offset:6144
    v_mov_b64 v[206:207], v[26:27]
    v_mfma_f32_16x16x32_bf16 v[120:123], v[20:23], v[240:243], v[120:123]
    s_waitcnt lgkmcnt(9)
    ds_read_b128 v[220:223], v96 offset:7168
    s_add_u32 s78, s75, 1081344
    v_mfma_f32_16x16x32_bf16 v[124:127], v[20:23], v[244:247], v[124:127]
    buffer_load_dwordx4 v[68:71], v90, s[60:63], s91 offen sc1
    s_add_u32 s91, s92, 2228224
    v_mov_b32_dpp v26, v24 row_ror:8 row_mask:0xf bank_mask:0x3
    v_mfma_f32_16x16x32_bf16 v[128:131], v[20:23], v[248:251], v[128:131]
    ds_read_b128 v[224:227], v96 offset:8192
    v_mov_b32_dpp v27, v25 row_ror:8 row_mask:0xf bank_mask:0x3
    v_mfma_f32_16x16x32_bf16 v[140:143], v[20:23], v[20:23], v[140:143]
    ds_read_b128 v[228:231], v96 offset:9216
    v_mov_b32_dpp v24, v206 row_ror:8 row_mask:0xf bank_mask:0xc
    v_mfma_f32_16x16x32_bf16 v[132:135], v[20:23], v[252:255], v[132:135]
    s_waitcnt lgkmcnt(9)
    ds_read_b128 v[232:235], v96 offset:26624
    v_mov_b32_dpp v25, v207 row_ror:8 row_mask:0xf bank_mask:0xc
    s_nop 1
    v_mfma_f32_16x16x32_bf16 v[112:115], v[24:27], v[172:175], v[112:115]
    buffer_load_dwordx4 v[72:75], v90, s[60:63], s91 offen sc1
    s_add_u32 s91, s92, 2359296
    v_mov_b64 v[206:207], v[30:31]
    v_mfma_f32_16x16x32_bf16 v[116:119], v[24:27], v[176:179], v[116:119]
    buffer_load_dwordx4 v106, s[60:63], s78 offen offset:0 sc1 lds
    v_mov_b32_dpp v30, v28 row_ror:8 row_mask:0xf bank_mask:0x3
    v_mfma_f32_16x16x32_bf16 v[136:139], v[24:27], v[144:147], v[136:139]
    ds_read_b128 v[236:239], v96 offset:27648
    v_mov_b32_dpp v31, v29 row_ror:8 row_mask:0xf bank_mask:0x3
    v_mfma_f32_16x16x32_bf16 v[120:123], v[24:27], v[180:183], v[120:123]
    s_waitcnt lgkmcnt(8)
    ds_read_b128 v[240:243], v96 offset:28672
    v_mov_b32_dpp v28, v206 row_ror:8 row_mask:0xf bank_mask:0xc
    v_mfma_f32_16x16x32_bf16 v[124:127], v[24:27], v[184:187], v[124:127]
    ds_read_b128 v[244:247], v96 offset:29696
    v_mov_b32_dpp v29, v207 row_ror:8 row_mask:0xf bank_mask:0xc
    v_mfma_f32_16x16x32_bf16 v[128:131], v[24:27], v[188:191], v[128:131]
    buffer_load_dwordx4 v106, s[60:63], s78 offen offset:1024 sc1 lds
    v_mov_b64 v[206:207], v[34:35]
    v_mfma_f32_16x16x32_bf16 v[140:143], v[24:27], v[24:27], v[140:143]
    buffer_load_dwordx4 v[76:79], v90, s[60:63], s91 offen sc1
    s_add_u32 s91, s92, 2490368
    v_mov_b32_dpp v34, v32 row_ror:8 row_mask:0xf bank_mask:0x3
    v_mfma_f32_16x16x32_bf16 v[132:135], v[24:27], v[192:195], v[132:135]
    s_waitcnt lgkmcnt(7)
    ds_read_b128 v[248:251], v96 offset:30720
    v_mov_b32_dpp v35, v33 row_ror:8 row_mask:0xf bank_mask:0x3
    v_mfma_f32_16x16x32_bf16 v[112:115], v[28:31], v[208:211], v[112:115]
    ds_read_b128 v[252:255], v96 offset:31744
    buffer_load_dwordx4 v106, s[60:63], s78 offen offset:2048 sc1 lds
    buffer_load_dwordx4 v[80:83], v90, s[60:63], s91 offen sc1
    v_mov_b32_dpp v32, v206 row_ror:8 row_mask:0xf bank_mask:0xc
    v_mfma_f32_16x16x32_bf16 v[116:119], v[28:31], v[212:215], v[116:119]
    buffer_load_dwordx4 v106, s[60:63], s78 offen offset:3072 sc1 lds
    s_barrier
    ds_read_b128 v[172:175], v95 offset:24576
    v_mov_b32_dpp v33, v207 row_ror:8 row_mask:0xf bank_mask:0xc
    v_mfma_f32_16x16x32_bf16 v[136:139], v[28:31], v[144:147], v[136:139]
    s_waitcnt vmcnt(18)
    ds_read_b128 v[176:179], v95 offset:25600
    s_add_u32 m0, s71, 10240
    v_max3_u32 v102, v36, v37, v38
    v_mfma_f32_16x16x32_bf16 v[120:123], v[28:31], v[216:219], v[120:123]
    s_waitcnt lgkmcnt(8)
    ds_read_b128 v[180:183], v95 offset:26624
    v_max3_u32 v102, v102, v39, v40
    v_mfma_f32_16x16x32_bf16 v[124:127], v[28:31], v[220:223], v[124:127]
    ds_read_b128 v[184:187], v95 offset:27648
    v_max3_u32 v102, v102, v41, v42
    v_mfma_f32_16x16x32_bf16 v[128:131], v[28:31], v[224:227], v[128:131]
    ds_read_b128 v[188:191], v95 offset:28672
    s_add_u32 s78, s75, 1085440
    v_max3_u32 v102, v102, v43, v44
    v_mfma_f32_16x16x32_bf16 v[140:143], v[28:31], v[28:31], v[140:143]
    ds_read_b128 v[192:195], v95 offset:29696
    v_max3_u32 v102, v102, v45, v46
    v_max3_u32 v102, v102, v47, v48
    v_mfma_f32_16x16x32_bf16 v[132:135], v[28:31], v[228:231], v[132:135]
    s_waitcnt lgkmcnt(9)
    ds_read_b128 v[208:211], v95 offset:47104
    v_max3_u32 v102, v102, v49, v50
    v_mfma_f32_16x16x32_bf16 v[112:115], v[32:35], v[232:235], v[112:115]
    ds_read_b128 v[212:215], v95 offset:48128
    v_max_u32 v102, v102, v51
    v_mfma_f32_16x16x32_bf16 v[116:119], v[32:35], v[236:239], v[116:119]
    ds_read_b128 v[216:219], v95 offset:49152
    v_cmp_eq_u32 vcc, -1, v102
    v_mfma_f32_16x16x32_bf16 v[136:139], v[32:35], v[144:147], v[136:139]
    buffer_load_dwordx4 v106, s[60:63], s78 offen offset:0 sc1 lds
    s_cbranch_vccnz L_stub_h2
L_ok_h2:
    v_mfma_f32_16x16x32_bf16 v[120:123], v[32:35], v[240:243], v[120:123]
    s_waitcnt lgkmcnt(9)
    ds_read_b128 v[220:223], v95 offset:50176
    v_mov_b64 v[206:207], v[38:39]
    v_mfma_f32_16x16x32_bf16 v[124:127], v[32:35], v[244:247], v[124:127]
    ds_read_b128 v[224:227], v95 offset:51200
    v_mov_b32_dpp v38, v36 row_ror:8 row_mask:0xf bank_mask:0x3
    v_mfma_f32_16x16x32_bf16 v[128:131], v[32:35], v[248:251], v[128:131]
    buffer_load_dwordx4 v106, s[60:63], s78 offen offset:1024 sc1 lds
    v_mov_b32_dpp v39, v37 row_ror:8 row_mask:0xf bank_mask:0x3
    v_mfma_f32_16x16x32_bf16 v[140:143], v[32:35], v[32:35], v[140:143]
    ds_read_b128 v[228:231], v95 offset:52224
    v_mov_b32_dpp v36, v206 row_ror:8 row_mask:0xf bank_mask:0xc
    v_mfma_f32_16x16x32_bf16 v[132:135], v[32:35], v[252:255], v[132:135]
    s_waitcnt lgkmcnt(9)
    ds_read_b32 v84, v100 offset:384
    s_add_u32 m0, s95, 14336
    v_mov_b32_dpp v37, v207 row_ror:8 row_mask:0xf bank_mask:0xc
    s_nop 1
    v_mfma_f32_16x16x32_bf16 v[112:115], v[36:39], v[172:175], v[112:115]
    ds_read_b128 v[232:235], v96 offset:12288
    v_mov_b64 v[206:207], v[42:43]
    v_mfma_f32_16x16x32_bf16 v[116:119], v[36:39], v[176:179], v[116:119]
    ds_read_b128 v[236:239], v96 offset:13312
    v_mov_b32_dpp v42, v40 row_ror:8 row_mask:0xf bank_mask:0x3
    v_mfma_f32_16x16x32_bf16 v[136:139], v[36:39], v[144:147], v[136:139]
    ds_read_b128 v[240:243], v96 offset:14336
    s_add_u32 s78, s75, 0
    v_mfma_f32_16x16x32_bf16 v[120:123], v[36:39], v[180:183], v[120:123]
    s_waitcnt lgkmcnt(10)
    ds_read_b128 v[244:247], v96 offset:15360
    v_mov_b32_dpp v43, v41 row_ror:8 row_mask:0xf bank_mask:0x3
    v_mfma_f32_16x16x32_bf16 v[124:127], v[36:39], v[184:187], v[124:127]
    ds_read_b128 v[248:251], v96 offset:16384
    v_mov_b32_dpp v40, v206 row_ror:8 row_mask:0xf bank_mask:0xc
    v_mfma_f32_16x16x32_bf16 v[128:131], v[36:39], v[188:191], v[128:131]
    ds_read_b128 v[252:255], v96 offset:17408
    v_mov_b32_dpp v41, v207 row_ror:8 row_mask:0xf bank_mask:0xc
    v_mfma_f32_16x16x32_bf16 v[140:143], v[36:39], v[36:39], v[140:143]
    ds_read_b128 v[172:175], v96 offset:34816
    v_mov_b64 v[206:207], v[46:47]
    v_mfma_f32_16x16x32_bf16 v[132:135], v[36:39], v[192:195], v[132:135]
    s_waitcnt lgkmcnt(11)
    buffer_load_dwordx4 v106, s[60:63], s78 offen offset:0 sc1 lds
    v_mov_b32_dpp v46, v44 row_ror:8 row_mask:0xf bank_mask:0x3
    v_mfma_f32_16x16x32_bf16 v[112:115], v[40:43], v[208:211], v[112:115]
    ds_read_b128 v[176:179], v96 offset:35840
    v_mov_b32_dpp v47, v45 row_ror:8 row_mask:0xf bank_mask:0x3
    v_mfma_f32_16x16x32_bf16 v[116:119], v[40:43], v[212:215], v[116:119]
    ds_read_b32 v85, v100 offset:448
    v_mov_b32_dpp v44, v206 row_ror:8 row_mask:0xf bank_mask:0xc
    v_mfma_f32_16x16x32_bf16 v[136:139], v[40:43], v[144:147], v[136:139]
    ds_read_b128 v[180:183], v96 offset:36864
    v_mov_b32_dpp v45, v207 row_ror:8 row_mask:0xf bank_mask:0xc
    v_mfma_f32_16x16x32_bf16 v[120:123], v[40:43], v[216:219], v[120:123]
    s_waitcnt lgkmcnt(11)
    buffer_load_dwordx4 v106, s[60:63], s78 offen offset:1024 sc1 lds
    v_mov_b64 v[206:207], v[50:51]
    v_mfma_f32_16x16x32_bf16 v[124:127], v[40:43], v[220:223], v[124:127]
    ds_read_b128 v[184:187], v96 offset:37888
    v_mov_b32_dpp v50, v48 row_ror:8 row_mask:0xf bank_mask:0x3
    v_mfma_f32_16x16x32_bf16 v[128:131], v[40:43], v[224:227], v[128:131]
    ds_read_b128 v[188:191], v96 offset:38912
    v_mov_b32_dpp v51, v49 row_ror:8 row_mask:0xf bank_mask:0x3
    v_mfma_f32_16x16x32_bf16 v[140:143], v[40:43], v[40:43], v[140:143]
    buffer_load_dwordx4 v106, s[60:63], s78 offen offset:2048 sc1 lds
    v_mov_b32_dpp v48, v206 row_ror:8 row_mask:0xf bank_mask:0xc
    v_mfma_f32_16x16x32_bf16 v[132:135], v[40:43], v[228:231], v[132:135]
    s_waitcnt lgkmcnt(9)
    ds_read_b128 v[192:195], v96 offset:39936
    v_mov_b32_dpp v49, v207 row_ror:8 row_mask:0xf bank_mask:0xc
    v_mfma_f32_16x16x32_bf16 v[112:115], v[44:47], v[232:235], v[112:115]
    s_waitcnt vmcnt(13)
    buffer_load_dwordx4 v106, s[60:63], s78 offen offset:3072 sc1 lds
    s_barrier
    v_mfma_f32_16x16x32_bf16 v[116:119], v[44:47], v[236:239], v[116:119]
    ds_read_b128 v[208:211], v94 offset:0
    s_add_u32 m0, s95, 18432
    v_mfma_f32_16x16x32_bf16 v[136:139], v[44:47], v[144:147], v[136:139]
    ds_read_b128 v[212:215], v94 offset:1024
    v_max3_u32 v102, v52, v53, v54
    v_mfma_f32_16x16x32_bf16 v[120:123], v[44:47], v[240:243], v[120:123]
    s_waitcnt lgkmcnt(9)
    ds_read_b128 v[216:219], v94 offset:2048
    v_max3_u32 v102, v102, v55, v56
    v_mfma_f32_16x16x32_bf16 v[124:127], v[44:47], v[244:247], v[124:127]
    ds_read_b128 v[220:223], v94 offset:3072
    s_add_u32 s78, s75, 4096
    v_max3_u32 v102, v102, v57, v58
    v_mfma_f32_16x16x32_bf16 v[128:131], v[44:47], v[248:251], v[128:131]
    ds_read_b128 v[224:227], v94 offset:4096
    v_max3_u32 v102, v102, v59, v60
    v_mfma_f32_16x16x32_bf16 v[140:143], v[44:47], v[44:47], v[140:143]
    ds_read_b32 v86, v100 offset:512
    v_max3_u32 v102, v102, v61, v62
    v_max3_u32 v102, v102, v63, v64
    v_mfma_f32_16x16x32_bf16 v[132:135], v[44:47], v[252:255], v[132:135]
    s_waitcnt lgkmcnt(9)
    ds_read_b128 v[228:231], v94 offset:5120
    v_max3_u32 v102, v102, v65, v66
    v_mfma_f32_16x16x32_bf16 v[112:115], v[48:51], v[172:175], v[112:115]
    ds_read_b128 v[232:235], v94 offset:18432
    v_max_u32 v102, v102, v67
    v_mfma_f32_16x16x32_bf16 v[116:119], v[48:51], v[176:179], v[116:119]
    ds_read_b128 v[236:239], v94 offset:19456
    v_cmp_eq_u32 vcc, -1, v102
    v_mfma_f32_16x16x32_bf16 v[136:139], v[48:51], v[144:147], v[136:139]
    buffer_load_dwordx4 v106, s[60:63], s78 offen offset:0 sc1 lds
    s_cbranch_vccnz L_stub_h3
L_ok_h3:
    v_mfma_f32_16x16x32_bf16 v[120:123], v[48:51], v[180:183], v[120:123]
    s_waitcnt lgkmcnt(9)
    ds_read_b128 v[240:243], v94 offset:20480
    v_mov_b64 v[206:207], v[54:55]
    v_mfma_f32_16x16x32_bf16 v[124:127], v[48:51], v[184:187], v[124:127]
    ds_read_b128 v[244:247], v94 offset:21504
    v_mov_b32_dpp v54, v52 row_ror:8 row_mask:0xf bank_mask:0x3
    v_mfma_f32_16x16x32_bf16 v[128:131], v[48:51], v[188:191], v[128:131]
    buffer_load_dwordx4 v106, s[60:63], s78 offen offset:1024 sc1 lds
    v_mov_b32_dpp v55, v53 row_ror:8 row_mask:0xf bank_mask:0x3
    v_mfma_f32_16x16x32_bf16 v[140:143], v[48:51], v[48:51], v[140:143]
    ds_read_b128 v[248:251], v94 offset:22528
    s_add_u32 m0, s71, 12288
    v_mov_b32_dpp v52, v206 row_ror:8 row_mask:0xf bank_mask:0xc
    v_mfma_f32_16x16x32_bf16 v[132:135], v[48:51], v[192:195], v[132:135]
    s_waitcnt lgkmcnt(9)
    ds_read_b128 v[252:255], v94 offset:23552
    v_mov_b32_dpp v53, v207 row_ror:8 row_mask:0xf bank_mask:0xc
    s_nop 1
    v_mfma_f32_16x16x32_bf16 v[112:115], v[52:55], v[208:211], v[112:115]
    ds_read_b128 v[172:175], v94 offset:36864
    v_mov_b64 v[206:207], v[58:59]
    v_mfma_f32_16x16x32_bf16 v[116:119], v[52:55], v[212:215], v[116:119]
    ds_read_b128 v[176:179], v94 offset:37888
    s_add_u32 s78, s75, 24576
    v_mfma_f32_16x16x32_bf16 v[136:139], v[52:55], v[144:147], v[136:139]
    ds_read_b32 v87, v100 offset:576
    v_mov_b32_dpp v58, v56 row_ror:8 row_mask:0xf bank_mask:0x3
    v_mfma_f32_16x16x32_bf16 v[120:123], v[52:55], v[216:219], v[120:123]
    s_waitcnt lgkmcnt(9)
    ds_read_b128 v[180:183], v94 offset:38912
    v_mov_b32_dpp v59, v57 row_ror:8 row_mask:0xf bank_mask:0x3
    v_mfma_f32_16x16x32_bf16 v[124:127], v[52:55], v[220:223], v[124:127]
    ds_read_b128 v[184:187], v94 offset:39936
    v_mov_b32_dpp v56, v206 row_ror:8 row_mask:0xf bank_mask:0xc
    v_mfma_f32_16x16x32_bf16 v[128:131], v[52:55], v[224:227], v[128:131]
    ds_read_b128 v[188:191], v94 offset:40960
    v_mov_b32_dpp v57, v207 row_ror:8 row_mask:0xf bank_mask:0xc
    v_mfma_f32_16x16x32_bf16 v[140:143], v[52:55], v[52:55], v[140:143]
    ds_read_b128 v[192:195], v94 offset:41984
    v_mov_b64 v[206:207], v[62:63]
    v_mfma_f32_16x16x32_bf16 v[132:135], v[52:55], v[228:231], v[132:135]
    s_waitcnt lgkmcnt(10)
    buffer_load_dwordx4 v106, s[60:63], s78 offen offset:0 sc1 lds
    v_mov_b32_dpp v62, v60 row_ror:8 row_mask:0xf bank_mask:0x3
    v_mfma_f32_16x16x32_bf16 v[112:115], v[56:59], v[232:235], v[112:115]
    ds_read_b128 v[208:211], v94 offset:55296
    v_mov_b32_dpp v63, v61 row_ror:8 row_mask:0xf bank_mask:0x3
    v_mfma_f32_16x16x32_bf16 v[116:119], v[56:59], v[236:239], v[116:119]
    ds_read_b128 v[212:215], v94 offset:56320
    v_mov_b32_dpp v60, v206 row_ror:8 row_mask:0xf bank_mask:0xc
    v_mfma_f32_16x16x32_bf16 v[136:139], v[56:59], v[144:147], v[136:139]
    buffer_load_dwordx4 v106, s[60:63], s78 offen offset:1024 sc1 lds
    v_mov_b32_dpp v61, v207 row_ror:8 row_mask:0xf bank_mask:0xc
    v_mfma_f32_16x16x32_bf16 v[120:123], v[56:59], v[240:243], v[120:123]
    s_waitcnt lgkmcnt(9)
    ds_read_b128 v[216:219], v95 offset:0
    v_mov_b64 v[206:207], v[66:67]
    v_mfma_f32_16x16x32_bf16 v[124:127], v[56:59], v[244:247], v[124:127]
    ds_read_b128 v[220:223], v95 offset:1024
    v_mov_b32_dpp v66, v64 row_ror:8 row_mask:0xf bank_mask:0x3
    v_mfma_f32_16x16x32_bf16 v[128:131], v[56:59], v[248:251], v[128:131]
    ds_read_b32 v88, v100 offset:640
    v_mov_b32_dpp v67, v65 row_ror:8 row_mask:0xf bank_mask:0x3
    v_mfma_f32_16x16x32_bf16 v[140:143], v[56:59], v[56:59], v[140:143]
    buffer_load_dwordx4 v106, s[60:63], s78 offen offset:2048 sc1 lds
    v_mov_b32_dpp v64, v206 row_ror:8 row_mask:0xf bank_mask:0xc
    v_mfma_f32_16x16x32_bf16 v[132:135], v[56:59], v[252:255], v[132:135]
    s_waitcnt lgkmcnt(8)
    ds_read_b128 v[224:227], v95 offset:2048
    v_mov_b32_dpp v65, v207 row_ror:8 row_mask:0xf bank_mask:0xc
    v_mfma_f32_16x16x32_bf16 v[112:115], v[60:63], v[172:175], v[112:115]
    s_waitcnt vmcnt(12)
    ds_read_b128 v[228:231], v95 offset:3072
    v_max3_u32 v102, v68, v69, v70
    v_mfma_f32_16x16x32_bf16 v[116:119], v[60:63], v[176:179], v[116:119]
    s_waitcnt vmcnt(9)
    buffer_load_dwordx4 v106, s[60:63], s78 offen offset:3072 sc1 lds
    s_barrier
    ds_read_b128 v[232:235], v94 offset:6144
    v_mfma_f32_16x16x32_bf16 v[136:139], v[60:63], v[144:147], v[136:139]
    ds_read_b128 v[236:239], v94 offset:7168
    s_add_u32 m0, s71, 16384
    v_mfma_f32_16x16x32_bf16 v[120:123], v[60:63], v[180:183], v[120:123]
    s_waitcnt lgkmcnt(9)
    ds_read_b128 v[240:243], v94 offset:8192
    s_add_u32 s78, s75, 28672
    v_max3_u32 v102, v102, v71, v72
    v_mfma_f32_16x16x32_bf16 v[124:127], v[60:63], v[184:187], v[124:127]
    ds_read_b128 v[244:247], v94 offset:9216
    v_max3_u32 v102, v102, v73, v74
    v_mfma_f32_16x16x32_bf16 v[128:131], v[60:63], v[188:191], v[128:131]
    ds_read_b128 v[248:251], v94 offset:10240
    v_max3_u32 v102, v102, v75, v76
    v_mfma_f32_16x16x32_bf16 v[140:143], v[60:63], v[60:63], v[140:143]
    ds_read_b128 v[252:255], v94 offset:11264
    v_max3_u32 v102, v102, v77, v78
    v_max3_u32 v102, v102, v79, v80
    v_mfma_f32_16x16x32_bf16 v[132:135], v[60:63], v[192:195], v[132:135]
    s_waitcnt lgkmcnt(10)
    ds_read_b128 v[172:175], v94 offset:24576
    v_max3_u32 v102, v102, v81, v82
    v_mfma_f32_16x16x32_bf16 v[112:115], v[64:67], v[208:211], v[112:115]
    ds_read_b32 v89, v100 offset:704
    v_max_u32 v102, v102, v83
    v_mfma_f32_16x16x32_bf16 v[116:119], v[64:67], v[212:215], v[116:119]
    buffer_load_dwordx4 v106, s[60:63], s78 offen offset:0 sc1 lds
    v_cmp_eq_u32 vcc, -1, v102
    v_mfma_f32_16x16x32_bf16 v[136:139], v[64:67], v[144:147], v[136:139]
    buffer_store_dwordx4 v[148:151], v99, s[60:63], s13 offen sc1
    v_mfma_f32_16x16x32_bf16 v[120:123], v[64:67], v[216:219], v[120:123]
    s_waitcnt lgkmcnt(8)
    ds_read_b128 v[176:179], v94 offset:25600
    s_cbranch_vccnz L_stub_h4
L_ok_h4:
    v_mfma_f32_16x16x32_bf16 v[124:127], v[64:67], v[220:223], v[124:127]
    ds_read_b128 v[180:183], v94 offset:26624
    v_mov_b64 v[206:207], v[70:71]
    v_mov_b32_dpp v70, v68 row_ror:8 row_mask:0xf bank_mask:0x3
    v_mfma_f32_16x16x32_bf16 v[128:131], v[64:67], v[224:227], v[128:131]
    ds_read_b128 v[184:187], v94 offset:27648
    buffer_load_dwordx4 v106, s[60:63], s78 offen offset:1024 sc1 lds
    v_mov_b32_dpp v71, v69 row_ror:8 row_mask:0xf bank_mask:0x3
    v_mfma_f32_16x16x32_bf16 v[140:143], v[64:67], v[64:67], v[140:143]
    ds_read_b128 v[188:191], v94 offset:28672
    s_add_u32 m0, s95, 0
    v_mov_b32_dpp v68, v206 row_ror:8 row_mask:0xf bank_mask:0xc
    v_mfma_f32_16x16x32_bf16 v[132:135], v[64:67], v[228:231], v[132:135]
    s_waitcnt lgkmcnt(9)
    ds_read_b128 v[192:195], v94 offset:29696
    v_mov_b32_dpp v69, v207 row_ror:8 row_mask:0xf bank_mask:0xc
    s_nop 1
    v_mfma_f32_16x16x32_bf16 v[112:115], v[68:71], v[232:235], v[112:115]
    buffer_store_dwordx4 v[148:151], v99, s[60:63], s21 offen sc1
    v_mov_b64 v[206:207], v[74:75]
    v_mov_b32_dpp v74, v72 row_ror:8 row_mask:0xf bank_mask:0x3
    v_mfma_f32_16x16x32_bf16 v[116:119], v[68:71], v[236:239], v[116:119]
    ds_read_b128 v[208:211], v94 offset:43008
    s_add_u32 s78, s75, 49152
    v_mov_b32_dpp v75, v73 row_ror:8 row_mask:0xf bank_mask:0x3
    v_mov_b32_dpp v72, v206 row_ror:8 row_mask:0xf bank_mask:0xc
    v_mfma_f32_16x16x32_bf16 v[136:139], v[68:71], v[144:147], v[136:139]
    ds_read_b128 v[212:215], v94 offset:44032
    v_mov_b32_dpp v73, v207 row_ror:8 row_mask:0xf bank_mask:0xc
    v_mov_b64 v[206:207], v[78:79]
    v_mfma_f32_16x16x32_bf16 v[120:123], v[68:71], v[240:243], v[120:123]
    s_waitcnt lgkmcnt(9)
    ds_read_b128 v[216:219], v94 offset:45056
    v_mov_b32_dpp v78, v76 row_ror:8 row_mask:0xf bank_mask:0x3
    v_mov_b32_dpp v79, v77 row_ror:8 row_mask:0xf bank_mask:0x3
    v_mfma_f32_16x16x32_bf16 v[124:127], v[68:71], v[244:247], v[124:127]
    ds_read_b128 v[220:223], v94 offset:46080
    v_mov_b32_dpp v76, v206 row_ror:8 row_mask:0xf bank_mask:0xc
    v_mov_b32_dpp v77, v207 row_ror:8 row_mask:0xf bank_mask:0xc
    v_mfma_f32_16x16x32_bf16 v[128:131], v[68:71], v[248:251], v[128:131]
    ds_read_b128 v[224:227], v94 offset:47104
    v_mov_b64 v[206:207], v[82:83]
    v_mov_b32_dpp v82, v80 row_ror:8 row_mask:0xf bank_mask:0x3
    v_mfma_f32_16x16x32_bf16 v[140:143], v[68:71], v[68:71], v[140:143]
    buffer_load_dwordx4 v106, s[60:63], s78 offen offset:0 sc1 lds
    v_mov_b32_dpp v83, v81 row_ror:8 row_mask:0xf bank_mask:0x3
    v_mov_b32_dpp v80, v206 row_ror:8 row_mask:0xf bank_mask:0xc
    v_mov_b32_dpp v81, v207 row_ror:8 row_mask:0xf bank_mask:0xc
    v_mfma_f32_16x16x32_bf16 v[132:135], v[68:71], v[252:255], v[132:135]
    buffer_store_dwordx4 v[148:151], v99, s[60:63], s22 offen sc1
    v_mfma_f32_16x16x32_bf16 v[136:139], v[72:75], v[144:147], v[136:139]
    ds_read_b128 v[228:231], v94 offset:48128
    v_mfma_f32_16x16x32_bf16 v[140:143], v[72:75], v[72:75], v[140:143]
    ds_read_b128 v[232:235], v95 offset:4096
    v_mfma_f32_16x16x32_bf16 v[136:139], v[76:79], v[144:147], v[136:139]
    buffer_load_dwordx4 v106, s[60:63], s78 offen offset:1024 sc1 lds
    v_mfma_f32_16x16x32_bf16 v[140:143], v[76:79], v[76:79], v[140:143]
    ds_read_b128 v[236:239], v95 offset:5120
    v_mfma_f32_16x16x32_bf16 v[136:139], v[80:83], v[144:147], v[136:139]
    buffer_load_dwordx4 v106, s[60:63], s78 offen offset:2048 sc1 lds
    v_mfma_f32_16x16x32_bf16 v[140:143], v[80:83], v[80:83], v[140:143]
    s_waitcnt lgkmcnt(11)
    buffer_load_dwordx4 v106, s[60:63], s78 offen offset:3072 sc1 lds
    v_mfma_f32_16x16x32_bf16 v[112:115], v[72:75], v[172:175], v[112:115]
    ds_read_b128 v[240:243], v95 offset:6144
    v_mfma_f32_16x16x32_bf16 v[116:119], v[72:75], v[176:179], v[116:119]
    ds_read_b128 v[244:247], v95 offset:7168
    s_add_u32 m0, s95, 4096
    v_mfma_f32_16x16x32_bf16 v[120:123], v[72:75], v[180:183], v[120:123]
    s_waitcnt lgkmcnt(10)
    ds_read_b128 v[248:251], v95 offset:8192
    v_mfma_f32_16x16x32_bf16 v[124:127], v[72:75], v[184:187], v[124:127]
    ds_read_b128 v[252:255], v95 offset:9216
    v_mfma_f32_16x16x32_bf16 v[128:131], v[72:75], v[188:191], v[128:131]
    s_add_u32 s78, s75, 53248
    v_cndmask_b32 v104, v136, v137, s[80:81]
    v_cndmask_b32 v105, v140, v141, s[80:81]
    v_mfma_f32_16x16x32_bf16 v[132:135], v[72:75], v[192:195], v[132:135]
    s_waitcnt lgkmcnt(9)
    v_cndmask_b32 v104, v104, v138, s[82:83]
    v_cndmask_b32 v105, v105, v142, s[82:83]
    v_mfma_f32_16x16x32_bf16 v[112:115], v[76:79], v[208:211], v[112:115]
    v_cndmask_b32 v104, v104, v139, s[84:85]
    v_cndmask_b32 v105, v105, v143, s[84:85]
    v_mfma_f32_16x16x32_bf16 v[116:119], v[76:79], v[212:215], v[116:119]
    buffer_load_dwordx4 v106, s[60:63], s78 offen offset:0 sc1 lds
    v_mul_f32 v104, 0xbacccccd, v104
    v_mfma_f32_16x16x32_bf16 v[120:123], v[76:79], v[216:219], v[120:123]
    s_waitcnt lgkmcnt(6)
    v_mul_f32 v105, 0x3acccccd, v105
    v_fma_f32 v105, -v104, v104, v105
    v_mfma_f32_16x16x32_bf16 v[124:127], v[76:79], v[220:223], v[124:127]
    v_max_f32 v105, 0, v105
    v_add_f32 v105, 0x3727c5ac, v105
    v_mfma_f32_16x16x32_bf16 v[128:131], v[76:79], v[224:227], v[128:131]
    buffer_load_dwordx4 v106, s[60:63], s78 offen offset:1024 sc1 lds
    v_mfma_f32_16x16x32_bf16 v[132:135], v[76:79], v[228:231], v[132:135]
    s_waitcnt lgkmcnt(3)
    v_rsq_f32 v105, v105
    v_mfma_f32_16x16x32_bf16 v[112:115], v[80:83], v[232:235], v[112:115]
    v_mul_f32 v200, 0xbacccccd, v136
    v_mul_f32 v201, 0xbacccccd, v137
    v_mfma_f32_16x16x32_bf16 v[116:119], v[80:83], v[236:239], v[116:119]
    v_mul_f32 v202, 0xbacccccd, v138
    v_mul_f32 v203, 0xbacccccd, v139
    v_mfma_f32_16x16x32_bf16 v[120:123], v[80:83], v[240:243], v[120:123]
    s_waitcnt lgkmcnt(0)
    ds_bpermute_b32 v196, v98, v105 offset:0
    v_mfma_f32_16x16x32_bf16 v[124:127], v[80:83], v[244:247], v[124:127]
    ds_bpermute_b32 v197, v98, v105 offset:4
    v_mfma_f32_16x16x32_bf16 v[128:131], v[80:83], v[248:251], v[128:131]
    ds_bpermute_b32 v198, v98, v105 offset:8
    v_mfma_f32_16x16x32_bf16 v[132:135], v[80:83], v[252:255], v[132:135]
    s_nop 0
    ds_bpermute_b32 v199, v98, v105 offset:12
    ds_bpermute_b32 v204, v97, v105
    ds_bpermute_b32 v205, v97, v104
    s_mov_b32 s84, 0xbdd2d3e8
    s_mov_b32 s85, 0xbdd2d3e8
    v_mov_b32 v102, 0xc0135761
    s_mov_b32 vcc_lo, 0xaaaaaaaa
    s_mov_b32 vcc_hi, 0xaaaaaaaa
    v_pk_fma_f32 v[112:113], v[200:201], v[84:85], v[112:113] op_sel:[0,0,0] op_sel_hi:[1,0,1]
    v_pk_fma_f32 v[114:115], v[202:203], v[84:85], v[114:115] op_sel:[0,0,0] op_sel_hi:[1,0,1]
    v_pk_fma_f32 v[116:117], v[200:201], v[84:85], v[116:117] op_sel:[0,1,0] op_sel_hi:[1,1,1]
    v_pk_fma_f32 v[118:119], v[202:203], v[84:85], v[118:119] op_sel:[0,1,0] op_sel_hi:[1,1,1]
    v_pk_fma_f32 v[120:121], v[200:201], v[86:87], v[120:121] op_sel:[0,0,0] op_sel_hi:[1,0,1]
    v_pk_fma_f32 v[122:123], v[202:203], v[86:87], v[122:123] op_sel:[0,0,0] op_sel_hi:[1,0,1]
    v_pk_fma_f32 v[124:125], v[200:201], v[86:87], v[124:125] op_sel:[0,1,0] op_sel_hi:[1,1,1]
    v_pk_fma_f32 v[126:127], v[202:203], v[86:87], v[126:127] op_sel:[0,1,0] op_sel_hi:[1,1,1]
    v_pk_fma_f32 v[128:129], v[200:201], v[88:89], v[128:129] op_sel:[0,0,0] op_sel_hi:[1,0,1]
    v_pk_fma_f32 v[130:131], v[202:203], v[88:89], v[130:131] op_sel:[0,0,0] op_sel_hi:[1,0,1]
    v_pk_fma_f32 v[132:133], v[200:201], v[88:89], v[132:133] op_sel:[0,1,0] op_sel_hi:[1,1,1]
    v_pk_fma_f32 v[134:135], v[202:203], v[88:89], v[134:135] op_sel:[0,1,0] op_sel_hi:[1,1,1]
    s_waitcnt lgkmcnt(0)
    s_nop 0
    v_pk_mul_f32 v[112:113], v[112:113], v[196:197]
    v_pk_mul_f32 v[114:115], v[114:115], v[198:199]
    v_pk_mul_f32 v[116:117], v[116:117], v[196:197]
    v_pk_mul_f32 v[118:119], v[118:119], v[198:199]
    v_pk_mul_f32 v[120:121], v[120:121], v[196:197]
    v_pk_mul_f32 v[122:123], v[122:123], v[198:199]
    v_pk_mul_f32 v[124:125], v[124:125], v[196:197]
    v_pk_mul_f32 v[126:127], v[126:127], v[198:199]
    v_pk_mul_f32 v[128:129], v[128:129], v[196:197]
    v_pk_mul_f32 v[130:131], v[130:131], v[198:199]
    v_pk_mul_f32 v[132:133], v[132:133], v[196:197]
    v_pk_mul_f32 v[134:135], v[134:135], v[198:199]
    v_pk_mul_f32 v[208:209], v[112:113], v[112:113]
    s_add_u32 m0, s95, 8192
    s_add_u32 s78, s75, 73728
    buffer_load_dwordx4 v106, s[60:63], s78 offen offset:0 sc1 lds
    buffer_load_dwordx4 v106, s[60:63], s78 offen offset:1024 sc1 lds
    v_pk_mul_f32 v[210:211], v[114:115], v[114:115]
    v_pk_mul_f32 v[212:213], v[116:117], v[116:117]
    v_pk_mul_f32 v[214:215], v[118:119], v[118:119]
    v_pk_mul_f32 v[216:217], v[120:121], v[120:121]
    v_pk_mul_f32 v[218:219], v[122:123], v[122:123]
    v_pk_mul_f32 v[220:221], v[124:125], v[124:125]
    v_pk_mul_f32 v[222:223], v[126:127], v[126:127]
    v_pk_mul_f32 v[224:225], v[128:129], v[128:129]
    v_pk_mul_f32 v[226:227], v[130:131], v[130:131]
    v_pk_mul_f32 v[228:229], v[132:133], v[132:133]
    v_pk_mul_f32 v[230:231], v[134:135], v[134:135]
    v_pk_fma_f32 v[208:209], v[208:209], s[84:85], v[102:103] op_sel_hi:[1,1,0]
    v_pk_fma_f32 v[210:211], v[210:211], s[84:85], v[102:103] op_sel_hi:[1,1,0]
    v_pk_fma_f32 v[212:213], v[212:213], s[84:85], v[102:103] op_sel_hi:[1,1,0]
    v_pk_fma_f32 v[214:215], v[214:215], s[84:85], v[102:103] op_sel_hi:[1,1,0]
    v_pk_fma_f32 v[216:217], v[216:217], s[84:85], v[102:103] op_sel_hi:[1,1,0]
    v_pk_fma_f32 v[218:219], v[218:219], s[84:85], v[102:103] op_sel_hi:[1,1,0]
    v_pk_fma_f32 v[220:221], v[220:221], s[84:85], v[102:103] op_sel_hi:[1,1,0]
    v_pk_fma_f32 v[222:223], v[222:223], s[84:85], v[102:103] op_sel_hi:[1,1,0]
    v_pk_fma_f32 v[224:225], v[224:225], s[84:85], v[102:103] op_sel_hi:[1,1,0]
    v_pk_fma_f32 v[226:227], v[226:227], s[84:85], v[102:103] op_sel_hi:[1,1,0]
    v_pk_fma_f32 v[228:229], v[228:229], s[84:85], v[102:103] op_sel_hi:[1,1,0]
    v_pk_fma_f32 v[230:231], v[230:231], s[84:85], v[102:103] op_sel_hi:[1,1,0]
    v_pk_mul_f32 v[208:209], v[208:209], v[112:113]
    v_pk_mul_f32 v[210:211], v[210:211], v[114:115]
    v_pk_mul_f32 v[212:213], v[212:213], v[116:117]
    v_pk_mul_f32 v[214:215], v[214:215], v[118:119]
    v_pk_mul_f32 v[216:217], v[216:217], v[120:121]
    v_pk_mul_f32 v[218:219], v[218:219], v[122:123]
    v_pk_mul_f32 v[220:221], v[220:221], v[124:125]
    buffer_load_dwordx4 v106, s[60:63], s78 offen offset:2048 sc1 lds
    buffer_load_dwordx4 v106, s[60:63], s78 offen offset:3072 sc1 lds
    v_pk_mul_f32 v[222:223], v[222:223], v[126:127]
    v_pk_mul_f32 v[224:225], v[224:225], v[128:129]
    v_pk_mul_f32 v[226:227], v[226:227], v[130:131]
    v_pk_mul_f32 v[228:229], v[228:229], v[132:133]
    v_pk_mul_f32 v[230:231], v[230:231], v[134:135]
    v_exp_f32 v208, v208
    v_exp_f32 v209, v209
    v_exp_f32 v210, v210
    v_exp_f32 v211, v211
    v_exp_f32 v212, v212
    v_exp_f32 v213, v213
    v_exp_f32 v214, v214
    v_exp_f32 v215, v215
    v_exp_f32 v216, v216
    v_exp_f32 v217, v217
    v_exp_f32 v218, v218
    v_exp_f32 v219, v219
    v_exp_f32 v220, v220
    v_exp_f32 v221, v221
    v_exp_f32 v222, v222
    v_exp_f32 v223, v223
    v_exp_f32 v224, v224
    v_exp_f32 v225, v225
    v_exp_f32 v226, v226
    v_exp_f32 v227, v227
    v_exp_f32 v228, v228
    v_exp_f32 v229, v229
    v_exp_f32 v230, v230
    v_exp_f32 v231, v231
    v_pk_add_f32 v[208:209], v[208:209], 1.0 op_sel_hi:[1,0]
    s_add_u32 m0, s95, 12288
    s_add_u32 s78, s75, 77824
    buffer_load_dwordx4 v106, s[60:63], s78 offen offset:0 sc1 lds
    buffer_load_dwordx4 v106, s[60:63], s78 offen offset:1024 sc1 lds
    v_pk_add_f32 v[210:211], v[210:211], 1.0 op_sel_hi:[1,0]
    v_pk_add_f32 v[212:213], v[212:213], 1.0 op_sel_hi:[1,0]
    v_pk_add_f32 v[214:215], v[214:215], 1.0 op_sel_hi:[1,0]
    v_pk_add_f32 v[216:217], v[216:217], 1.0 op_sel_hi:[1,0]
    v_pk_add_f32 v[218:219], v[218:219], 1.0 op_sel_hi:[1,0]
    v_pk_add_f32 v[220:221], v[220:221], 1.0 op_sel_hi:[1,0]
    v_pk_add_f32 v[222:223], v[222:223], 1.0 op_sel_hi:[1,0]
    v_pk_add_f32 v[224:225], v[224:225], 1.0 op_sel_hi:[1,0]
    v_pk_add_f32 v[226:227], v[226:227], 1.0 op_sel_hi:[1,0]
    v_pk_add_f32 v[228:229], v[228:229], 1.0 op_sel_hi:[1,0]
    v_pk_add_f32 v[230:231], v[230:231], 1.0 op_sel_hi:[1,0]
    v_rcp_f32 v208, v208
    v_rcp_f32 v209, v209
    v_rcp_f32 v210, v210
    v_rcp_f32 v211, v211
    v_rcp_f32 v212, v212
    v_rcp_f32 v213, v213
    v_rcp_f32 v214, v214
    v_rcp_f32 v215, v215
    v_rcp_f32 v216, v216
    v_rcp_f32 v217, v217
    v_rcp_f32 v218, v218
    v_rcp_f32 v219, v219
    v_rcp_f32 v220, v220
    v_rcp_f32 v221, v221
    v_rcp_f32 v222, v222
    v_rcp_f32 v223, v223
    v_rcp_f32 v224, v224
    v_rcp_f32 v225, v225
    v_rcp_f32 v226, v226
    v_rcp_f32 v227, v227
    v_rcp_f32 v228, v228
    v_rcp_f32 v229, v229
    v_rcp_f32 v230, v230
    v_rcp_f32 v231, v231
    v_pk_mul_f32 v[112:113], v[112:113], v[208:209]
    v_pk_mul_f32 v[114:115], v[114:115], v[210:211]
    v_pk_mul_f32 v[116:117], v[116:117], v[212:213]
    v_pk_mul_f32 v[118:119], v[118:119], v[214:215]
    v_pk_mul_f32 v[120:121], v[120:121], v[216:217]
    v_pk_mul_f32 v[122:123], v[122:123], v[218:219]
    v_pk_mul_f32 v[124:125], v[124:125], v[220:221]
    v_pk_mul_f32 v[126:127], v[126:127], v[222:223]
    v_pk_mul_f32 v[128:129], v[128:129], v[224:225]
    v_pk_mul_f32 v[130:131], v[130:131], v[226:227]
    v_pk_mul_f32 v[132:133], v[132:133], v[228:229]
    v_pk_mul_f32 v[134:135], v[134:135], v[230:231]
    v_pk_add_f32 v[136:137], v[112:113], v[116:117]
    v_pk_mul_f32 v[140:141], v[112:113], v[112:113]
    v_pk_add_f32 v[138:139], v[114:115], v[118:119]
    v_pk_mul_f32 v[142:143], v[114:115], v[114:115]
    v_pk_fma_f32 v[140:141], v[116:117], v[116:117], v[140:141]
    v_pk_fma_f32 v[142:143], v[118:119], v[118:119], v[142:143]
    v_pk_add_f32 v[136:137], v[136:137], v[120:121]
    v_pk_fma_f32 v[140:141], v[120:121], v[120:121], v[140:141]
    v_pk_add_f32 v[138:139], v[138:139], v[122:123]
    v_pk_fma_f32 v[142:143], v[122:123], v[122:123], v[142:143]
    v_pk_add_f32 v[136:137], v[136:137], v[124:125]
    v_pk_fma_f32 v[140:141], v[124:125], v[124:125], v[140:141]
    v_pk_add_f32 v[138:139], v[138:139], v[126:127]
    v_pk_fma_f32 v[142:143], v[126:127], v[126:127], v[142:143]
    v_pk_add_f32 v[136:137], v[136:137], v[128:129]
    v_pk_fma_f32 v[140:141], v[128:129], v[128:129], v[140:141]
    v_pk_add_f32 v[138:139], v[138:139], v[130:131]
    v_pk_fma_f32 v[142:143], v[130:131], v[130:131], v[142:143]
    v_pk_add_f32 v[136:137], v[136:137], v[132:133]
    v_pk_fma_f32 v[140:141], v[132:133], v[132:133], v[140:141]
    v_pk_add_f32 v[138:139], v[138:139], v[134:135]
    v_pk_fma_f32 v[142:143], v[134:135], v[134:135], v[142:143]
    v_cndmask_b32 v252, v140, v136, vcc
    v_cndmask_b32 v253, v141, v137, vcc
    v_cndmask_b32 v254, v142, v138, vcc
    v_cndmask_b32 v255, v143, v139, vcc
    v_cndmask_b32 v144, v136, v140, vcc
    v_cndmask_b32 v145, v137, v141, vcc
    v_cndmask_b32 v146, v138, v142, vcc
    v_cndmask_b32 v147, v139, v143, vcc
    v_add_f32_dpp v144, v252, v144 quad_perm:[1,0,3,2] row_mask:0xf bank_mask:0xf
    v_add_f32_dpp v145, v253, v145 quad_perm:[1,0,3,2] row_mask:0xf bank_mask:0xf
    v_add_f32_dpp v146, v254, v146 quad_perm:[1,0,3,2] row_mask:0xf bank_mask:0xf
    v_add_f32_dpp v147, v255, v147 quad_perm:[1,0,3,2] row_mask:0xf bank_mask:0xf
    v_add_f32_dpp v144, v144, v144 row_ror:2 row_mask:0xf bank_mask:0xf
    v_add_f32_dpp v145, v145, v145 row_ror:2 row_mask:0xf bank_mask:0xf
    v_add_f32_dpp v146, v146, v146 row_ror:2 row_mask:0xf bank_mask:0xf
    v_add_f32_dpp v147, v147, v147 row_ror:2 row_mask:0xf bank_mask:0xf
    v_add_f32_dpp v144, v144, v144 row_ror:4 row_mask:0xf bank_mask:0xf
    v_add_f32_dpp v145, v145, v145 row_ror:4 row_mask:0xf bank_mask:0xf
    v_add_f32_dpp v146, v146, v146 row_ror:4 row_mask:0xf bank_mask:0xf
    v_add_f32_dpp v147, v147, v147 row_ror:4 row_mask:0xf bank_mask:0xf
    v_add_f32_dpp v144, v144, v144 row_ror:8 row_mask:0xf bank_mask:0xf
    v_add_f32_dpp v145, v145, v145 row_ror:8 row_mask:0xf bank_mask:0xf
    v_add_f32_dpp v146, v146, v146 row_ror:8 row_mask:0xf bank_mask:0xf
    v_add_f32_dpp v147, v147, v147 row_ror:8 row_mask:0xf bank_mask:0xf
    s_mov_b32 exec_lo, 0x00030003
    s_waitcnt vmcnt(11)
    s_waitcnt vmcnt(6)
    s_mov_b32 exec_hi, 0x00030003
    buffer_store_dwordx4 v[144:147], v93, s[60:63], s12 offen sc1
    s_mov_b64 exec, -1
    s_barrier
    ds_read_b128 v[208:211], v95 offset:30720
    ds_read_b128 v[212:215], v95 offset:31744
    ds_read_b128 v[216:219], v95 offset:32768
    ds_read_b128 v[220:223], v95 offset:33792
    ds_read_b128 v[224:227], v95 offset:34816
    ds_read_b128 v[228:231], v95 offset:35840
    ds_read_b128 v[232:235], v95 offset:53248
    ds_read_b128 v[236:239], v95 offset:54272
    ds_read_b128 v[240:243], v95 offset:55296
    ds_read_b128 v[244:247], v95 offset:56320
    ds_read_b128 v[248:251], v96 offset:0
    ds_read_b128 v[252:255], v96 offset:1024
    ds_read_b128 v[172:175], v96 offset:18432
    ds_read_b128 v[176:179], v96 offset:19456
    v_mov_b32 v103, 0x3aaaaaab
    s_waitcnt lgkmcnt(11)
    v_mfma_f32_16x16x32_bf16 v[148:151], v[208:211], v[4:7], 0
    ds_read_b128 v[180:183], v96 offset:20480
    s_add_u32 m0, s71, 0
    v_mfma_f32_16x16x32_bf16 v[152:155], v[212:215], v[4:7], 0
    ds_read_b128 v[184:187], v96 offset:21504
    v_mfma_f32_16x16x32_bf16 v[156:159], v[216:219], v[4:7], 0
    s_waitcnt lgkmcnt(10)
    ds_read_b128 v[188:191], v96 offset:22528
    s_add_u32 s78, s75, 98304
    v_mfma_f32_16x16x32_bf16 v[160:163], v[220:223], v[4:7], 0
    ds_read_b128 v[192:195], v96 offset:23552
    v_mfma_f32_16x16x32_bf16 v[164:167], v[224:227], v[4:7], 0
    ds_read_b128 v[208:211], v96 offset:40960
    v_mfma_f32_16x16x32_bf16 v[168:171], v[228:231], v[4:7], 0
    s_waitcnt lgkmcnt(10)
    buffer_load_dwordx4 v106, s[60:63], s78 offen offset:0 sc1 lds
    v_mfma_f32_16x16x32_bf16 v[148:151], v[232:235], v[8:11], v[148:151]
    ds_read_b128 v[212:215], v96 offset:41984
    v_mfma_f32_16x16x32_bf16 v[152:155], v[236:239], v[8:11], v[152:155]
    ds_read_b128 v[216:219], v96 offset:43008
    v_mfma_f32_16x16x32_bf16 v[156:159], v[240:243], v[8:11], v[156:159]
    s_waitcnt lgkmcnt(9)
    buffer_load_dwordx4 v106, s[60:63], s78 offen offset:1024 sc1 lds
    v_mfma_f32_16x16x32_bf16 v[160:163], v[244:247], v[8:11], v[160:163]
    ds_read_b128 v[220:223], v96 offset:44032
    v_mfma_f32_16x16x32_bf16 v[164:167], v[248:251], v[8:11], v[164:167]
    ds_read_b128 v[224:227], v96 offset:45056
    s_lshl_b32 s72, s64, 15
    v_mfma_f32_16x16x32_bf16 v[168:171], v[252:255], v[8:11], v[168:171]
    s_waitcnt lgkmcnt(8)
    ds_read_b128 v[228:231], v96 offset:46080
    s_add_u32 s94, s94, s72
    v_mfma_f32_16x16x32_bf16 v[148:151], v[172:175], v[12:15], v[148:151]
    buffer_load_dwordx4 v106, s[60:63], s78 offen offset:2048 sc1 lds
    v_mfma_f32_16x16x32_bf16 v[152:155], v[176:179], v[12:15], v[152:155]
    ds_read_b128 v[232:235], v94 offset:12288
    v_lshlrev_b32 v100, 16, v92
    v_mfma_f32_16x16x32_bf16 v[156:159], v[180:183], v[12:15], v[156:159]
    s_waitcnt lgkmcnt(7)
    ds_read_b128 v[236:239], v94 offset:13312
    v_mfma_f32_16x16x32_bf16 v[160:163], v[184:187], v[12:15], v[160:163]
    buffer_load_dwordx4 v106, s[60:63], s78 offen offset:3072 sc1 lds
    s_add_u32 m0, s71, 4096
    v_mfma_f32_16x16x32_bf16 v[164:167], v[188:191], v[12:15], v[164:167]
    ds_read_b128 v[240:243], v94 offset:14336
    s_add_u32 s12, s12, 4291821568
    v_mfma_f32_16x16x32_bf16 v[168:171], v[192:195], v[12:15], v[168:171]
    s_waitcnt lgkmcnt(6)
    ds_read_b128 v[244:247], v94 offset:15360
    s_add_u32 s78, s75, 102400
    v_mfma_f32_16x16x32_bf16 v[148:151], v[208:211], v[16:19], v[148:151]
    ds_read_b128 v[248:251], v94 offset:16384
    v_lshrrev_b32 v110, 8, v107
    v_mfma_f32_16x16x32_bf16 v[152:155], v[212:215], v[16:19], v[152:155]
    ds_read_b128 v[252:255], v94 offset:17408
    s_add_u32 s72, s64, 1
    v_mfma_f32_16x16x32_bf16 v[156:159], v[216:219], v[16:19], v[156:159]
    s_waitcnt lgkmcnt(6)
    ds_read_b128 v[172:175], v94 offset:30720
    s_and_b32 s72, s72, 3
    v_mfma_f32_16x16x32_bf16 v[160:163], v[220:223], v[16:19], v[160:163]
    ds_read_b128 v[176:179], v94 offset:31744
    v_mfma_f32_16x16x32_bf16 v[164:167], v[224:227], v[16:19], v[164:167]
    ds_read_b128 v[180:183], v94 offset:32768
    buffer_load_dwordx4 v106, s[60:63], s78 offen offset:0 sc1 lds
    v_mfma_f32_16x16x32_bf16 v[168:171], v[228:231], v[16:19], v[168:171]
    s_waitcnt lgkmcnt(6)
    ds_read_b128 v[184:187], v94 offset:33792
    s_mul_i32 s72, s72, 18432
    v_mfma_f32_16x16x32_bf16 v[148:151], v[232:235], v[20:23], v[148:151]
    ds_read_b128 v[188:191], v94 offset:34816
    buffer_load_dwordx4 v106, s[60:63], s78 offen offset:1024 sc1 lds
    v_mfma_f32_16x16x32_bf16 v[152:155], v[236:239], v[20:23], v[152:155]
    ds_read_b128 v[192:195], v94 offset:35840
    s_add_u32 m0, s71, 6144
    v_mfma_f32_16x16x32_bf16 v[156:159], v[240:243], v[20:23], v[156:159]
    s_waitcnt lgkmcnt(6)
    ds_read_b128 v[208:211], v94 offset:49152
    s_add_u32 s72, s72, 5120
    v_mfma_f32_16x16x32_bf16 v[160:163], v[244:247], v[20:23], v[160:163]
    ds_read_b128 v[212:215], v94 offset:50176
    s_add_u32 s78, s15, 0
    v_mfma_f32_16x16x32_bf16 v[164:167], v[248:251], v[20:23], v[164:167]
    ds_read_b128 v[216:219], v94 offset:51200
    v_add_u32 v84, s72, v106
    v_mfma_f32_16x16x32_bf16 v[168:171], v[252:255], v[20:23], v[168:171]
    s_waitcnt lgkmcnt(6)
    ds_read_b128 v[220:223], v94 offset:52224
    s_add_u32 s72, s64, 2
    v_mfma_f32_16x16x32_bf16 v[148:151], v[172:175], v[24:27], v[148:151]
    ds_read_b128 v[224:227], v94 offset:53248
    s_and_b32 s72, s72, 3
    v_mfma_f32_16x16x32_bf16 v[152:155], v[176:179], v[24:27], v[152:155]
    ds_read_b128 v[228:231], v94 offset:54272
    buffer_load_dwordx4 v106, s[60:63], s78 offen offset:0 sc1 lds
    v_mfma_f32_16x16x32_bf16 v[156:159], v[180:183], v[24:27], v[156:159]
    s_waitcnt lgkmcnt(6)
    ds_read_b128 v[232:235], v95 offset:10240
    s_mul_i32 s72, s72, 22528
    v_mfma_f32_16x16x32_bf16 v[160:163], v[184:187], v[24:27], v[160:163]
    ds_read_b128 v[236:239], v95 offset:11264
    s_add_u32 s72, s72, 79872
    v_mfma_f32_16x16x32_bf16 v[164:167], v[188:191], v[24:27], v[164:167]
    ds_read_b128 v[240:243], v95 offset:12288
    buffer_load_dwordx4 v106, s[60:63], s78 offen offset:1024 sc1 lds
    v_mov_b32 v140, -1
    v_mfma_f32_16x16x32_bf16 v[168:171], v[192:195], v[24:27], v[168:171]
    s_waitcnt lgkmcnt(6)
    ds_read_b128 v[244:247], v95 offset:13312
    v_mov_b32 v141, -1
    v_mfma_f32_16x16x32_bf16 v[148:151], v[208:211], v[28:31], v[148:151]
    ds_read_b128 v[248:251], v95 offset:14336
    buffer_load_dwordx4 v106, s[60:63], s78 offen offset:2048 sc1 lds
    v_mfma_f32_16x16x32_bf16 v[152:155], v[212:215], v[28:31], v[152:155]
    ds_read_b128 v[252:255], v95 offset:15360
    v_add_u32 v85, s72, v106
    v_mfma_f32_16x16x32_bf16 v[156:159], v[216:219], v[28:31], v[156:159]
    s_waitcnt lgkmcnt(6)
    ds_read_b128 v[172:175], v95 offset:16384
    buffer_load_dwordx4 v106, s[60:63], s78 offen offset:3072 sc1 lds
    v_mfma_f32_16x16x32_bf16 v[160:163], v[220:223], v[28:31], v[160:163]
    ds_read_b128 v[176:179], v95 offset:17408
    s_add_u32 m0, s71, 10240
    v_mfma_f32_16x16x32_bf16 v[164:167], v[224:227], v[28:31], v[164:167]
    ds_read_b128 v[180:183], v95 offset:18432
    s_add_u32 s72, s64, 3
    v_mfma_f32_16x16x32_bf16 v[168:171], v[228:231], v[28:31], v[168:171]
    s_waitcnt lgkmcnt(6)
    ds_read_b128 v[184:187], v95 offset:19456
    s_add_u32 s78, s15, 4096
    v_mfma_f32_16x16x32_bf16 v[148:151], v[232:235], v[32:35], v[148:151]
    ds_read_b128 v[188:191], v95 offset:20480
    s_and_b32 s72, s72, 3
    v_mov_b32 v142, -1
    v_mfma_f32_16x16x32_bf16 v[152:155], v[236:239], v[32:35], v[152:155]
    ds_read_b128 v[192:195], v95 offset:21504
    s_mul_i32 s72, s72, 22528
    v_mfma_f32_16x16x32_bf16 v[156:159], v[240:243], v[32:35], v[156:159]
    s_waitcnt lgkmcnt(6)
    ds_read_b128 v[208:211], v95 offset:38912
    buffer_load_dwordx4 v106, s[60:63], s78 offen offset:0 sc1 lds
    v_mfma_f32_16x16x32_bf16 v[160:163], v[244:247], v[32:35], v[160:163]
    ds_read_b128 v[212:215], v95 offset:39936
    s_add_u32 s72, s72, 94208
    v_mfma_f32_16x16x32_bf16 v[164:167], v[248:251], v[32:35], v[164:167]
    ds_read_b128 v[216:219], v95 offset:40960
    v_mov_b32 v143, -1
    v_mfma_f32_16x16x32_bf16 v[168:171], v[252:255], v[32:35], v[168:171]
    s_waitcnt lgkmcnt(6)
    ds_read_b128 v[220:223], v95 offset:41984
    v_add_u32 v86, s72, v106
    v_mfma_f32_16x16x32_bf16 v[148:151], v[172:175], v[36:39], v[148:151]
    ds_read_b128 v[224:227], v95 offset:43008
    buffer_load_dwordx4 v[136:139], v91, s[60:63], s93 offen sc1
    v_mfma_f32_16x16x32_bf16 v[152:155], v[176:179], v[36:39], v[152:155]
    ds_read_b128 v[228:231], v95 offset:44032
    v_add_u32 v87, s71, v106
    v_mfma_f32_16x16x32_bf16 v[156:159], v[180:183], v[36:39], v[156:159]
    s_waitcnt lgkmcnt(6)
    ds_read_b128 v[232:235], v96 offset:4096
    v_add_u32 v88, s95, v106
    v_mfma_f32_16x16x32_bf16 v[160:163], v[184:187], v[36:39], v[160:163]
    ds_read_b128 v[236:239], v96 offset:5120
    buffer_store_dwordx4 v[140:143], v106, s[60:63], s14 offen sc1
    v_mfma_f32_16x16x32_bf16 v[164:167], v[188:191], v[36:39], v[164:167]
    ds_read_b128 v[240:243], v96 offset:6144
    s_lshl_b32 s72, s99, 12
    v_mfma_f32_16x16x32_bf16 v[168:171], v[192:195], v[36:39], v[168:171]
    s_waitcnt lgkmcnt(6)
    ds_read_b128 v[244:247], v96 offset:7168
    s_add_u32 s4, s72, s94
    v_mfma_f32_16x16x32_bf16 v[148:151], v[208:211], v[40:43], v[148:151]
    ds_read_b128 v[248:251], v96 offset:8192
    s_add_u32 s72, s72, 4096
    v_mfma_f32_16x16x32_bf16 v[152:155], v[212:215], v[40:43], v[152:155]
    ds_read_b128 v[252:255], v96 offset:9216
    buffer_store_dwordx4 v[140:143], v106, s[60:63], s16 offen sc1
    v_mfma_f32_16x16x32_bf16 v[156:159], v[216:219], v[40:43], v[156:159]
    s_waitcnt lgkmcnt(6)
    ds_read_b128 v[172:175], v96 offset:26624
    s_and_b32 s72, s72, 0x7fff
    v_mfma_f32_16x16x32_bf16 v[160:163], v[220:223], v[40:43], v[160:163]
    ds_read_b128 v[176:179], v96 offset:27648
    s_add_u32 s5, s72, s94
    v_mfma_f32_16x16x32_bf16 v[164:167], v[224:227], v[40:43], v[164:167]
    ds_read_b128 v[180:183], v96 offset:28672
    v_mfma_f32_16x16x32_bf16 v[168:171], v[228:231], v[40:43], v[168:171]
    s_waitcnt lgkmcnt(6)
    ds_read_b128 v[184:187], v96 offset:29696
    buffer_store_dwordx4 v[140:143], v106, s[60:63], s20 offen sc1
    v_mfma_f32_16x16x32_bf16 v[148:151], v[232:235], v[44:47], v[148:151]
    ds_read_b128 v[188:191], v96 offset:30720
    s_add_u32 s72, s72, 4096
    v_mfma_f32_16x16x32_bf16 v[152:155], v[236:239], v[44:47], v[152:155]
    ds_read_b128 v[192:195], v96 offset:31744
    s_and_b32 s72, s72, 0x7fff
    v_mfma_f32_16x16x32_bf16 v[156:159], v[240:243], v[44:47], v[156:159]
    s_waitcnt lgkmcnt(6)
    s_waitcnt vmcnt(16)
    s_barrier
    ds_read_b128 v[208:211], v95 offset:24576
    v_mfma_f32_16x16x32_bf16 v[160:163], v[244:247], v[44:47], v[160:163]
    ds_read_b128 v[212:215], v95 offset:25600
    s_add_u32 s6, s72, s94
    v_mfma_f32_16x16x32_bf16 v[164:167], v[248:251], v[44:47], v[164:167]
    ds_read_b128 v[216:219], v95 offset:26624
    s_add_u32 m0, s95, 14336
    v_mfma_f32_16x16x32_bf16 v[168:171], v[252:255], v[44:47], v[168:171]
    s_waitcnt lgkmcnt(6)
    ds_read_b128 v[220:223], v95 offset:27648
    s_add_u32 s72, s72, 4096
    v_mfma_f32_16x16x32_bf16 v[148:151], v[172:175], v[48:51], v[148:151]
    ds_read_b128 v[224:227], v95 offset:28672
    s_add_u32 s78, s15, 61440
    v_mfma_f32_16x16x32_bf16 v[152:155], v[176:179], v[48:51], v[152:155]
    ds_read_b128 v[228:231], v95 offset:29696
    s_and_b32 s72, s72, 0x7fff
    v_mfma_f32_16x16x32_bf16 v[156:159], v[180:183], v[48:51], v[156:159]
    s_waitcnt lgkmcnt(6)
    ds_read_b128 v[232:235], v95 offset:47104
    s_add_u32 s7, s72, s94
    v_mfma_f32_16x16x32_bf16 v[160:163], v[184:187], v[48:51], v[160:163]
    ds_read_b128 v[236:239], v95 offset:48128
    v_mfma_f32_16x16x32_bf16 v[164:167], v[188:191], v[48:51], v[164:167]
    ds_read_b128 v[240:243], v95 offset:49152
    s_add_u32 s72, s72, 4096
    v_mfma_f32_16x16x32_bf16 v[168:171], v[192:195], v[48:51], v[168:171]
    s_waitcnt lgkmcnt(6)
    ds_read_b128 v[244:247], v95 offset:50176
    s_and_b32 s72, s72, 0x7fff
    v_mfma_f32_16x16x32_bf16 v[148:151], v[208:211], v[52:55], v[148:151]
    ds_read_b128 v[248:251], v95 offset:51200
    buffer_load_dwordx4 v106, s[60:63], s78 offen offset:0 sc1 lds
    v_mfma_f32_16x16x32_bf16 v[152:155], v[212:215], v[52:55], v[152:155]
    ds_read_b128 v[252:255], v95 offset:52224
    s_add_u32 s8, s72, s94
    v_mfma_f32_16x16x32_bf16 v[156:159], v[216:219], v[52:55], v[156:159]
    s_waitcnt lgkmcnt(6)
    ds_read_b128 v[172:175], v96 offset:12288
    buffer_load_dwordx4 v106, s[60:63], s78 offen offset:1024 sc1 lds
    v_mfma_f32_16x16x32_bf16 v[160:163], v[220:223], v[52:55], v[160:163]
    ds_read_b128 v[176:179], v96 offset:13312
    s_add_u32 s72, s72, 4096
    v_mfma_f32_16x16x32_bf16 v[164:167], v[224:227], v[52:55], v[164:167]
    ds_read_b128 v[180:183], v96 offset:14336
    buffer_load_dwordx4 v106, s[60:63], s78 offen offset:2048 sc1 lds
    v_mfma_f32_16x16x32_bf16 v[168:171], v[228:231], v[52:55], v[168:171]
    s_waitcnt lgkmcnt(6)
    ds_read_b128 v[184:187], v96 offset:15360
    s_and_b32 s72, s72, 0x7fff
    v_mfma_f32_16x16x32_bf16 v[148:151], v[232:235], v[56:59], v[148:151]
    ds_read_b128 v[188:191], v96 offset:16384
    buffer_load_dwordx4 v106, s[60:63], s78 offen offset:3072 sc1 lds
    v_mfma_f32_16x16x32_bf16 v[152:155], v[236:239], v[56:59], v[152:155]
    ds_read_b128 v[192:195], v96 offset:17408
    s_add_u32 m0, s95, 18432
    v_mfma_f32_16x16x32_bf16 v[156:159], v[240:243], v[56:59], v[156:159]
    s_waitcnt lgkmcnt(6)
    ds_read_b128 v[208:211], v96 offset:34816
    s_add_u32 s78, s15, 65536
    v_mfma_f32_16x16x32_bf16 v[160:163], v[244:247], v[56:59], v[160:163]
    ds_read_b128 v[212:215], v96 offset:35840
    s_add_u32 s9, s72, s94
    v_mfma_f32_16x16x32_bf16 v[164:167], v[248:251], v[56:59], v[164:167]
    ds_read_b128 v[216:219], v96 offset:36864
    s_add_u32 s72, s72, 4096
    v_mfma_f32_16x16x32_bf16 v[168:171], v[252:255], v[56:59], v[168:171]
    s_waitcnt lgkmcnt(6)
    ds_read_b128 v[220:223], v96 offset:37888
    s_and_b32 s72, s72, 0x7fff
    v_mfma_f32_16x16x32_bf16 v[148:151], v[172:175], v[60:63], v[148:151]
    ds_read_b128 v[224:227], v96 offset:38912
    buffer_load_dwordx4 v106, s[60:63], s78 offen offset:0 sc1 lds
    v_mfma_f32_16x16x32_bf16 v[152:155], v[176:179], v[60:63], v[152:155]
    ds_read_b128 v[228:231], v96 offset:39936
    s_add_u32 s10, s72, s94
    v_mfma_f32_16x16x32_bf16 v[156:159], v[180:183], v[60:63], v[156:159]
    s_waitcnt lgkmcnt(6)
    s_waitcnt vmcnt(14)
    s_barrier
    ds_read_b128 v[232:235], v94 offset:0
    v_mfma_f32_16x16x32_bf16 v[160:163], v[184:187], v[60:63], v[160:163]
    ds_read_b128 v[236:239], v94 offset:1024
    s_add_u32 s72, s72, 4096
    v_mfma_f32_16x16x32_bf16 v[164:167], v[188:191], v[60:63], v[164:167]
    ds_read_b128 v[240:243], v94 offset:2048
    s_and_b32 s72, s72, 0x7fff
    v_mfma_f32_16x16x32_bf16 v[168:171], v[192:195], v[60:63], v[168:171]
    s_waitcnt lgkmcnt(6)
    ds_read_b128 v[244:247], v94 offset:3072
    v_mfma_f32_16x16x32_bf16 v[148:151], v[208:211], v[64:67], v[148:151]
    ds_read_b128 v[248:251], v94 offset:4096
    s_add_u32 s11, s72, s94
    v_mfma_f32_16x16x32_bf16 v[152:155], v[212:215], v[64:67], v[152:155]
    ds_read_b128 v[252:255], v94 offset:5120
    v_mfma_f32_16x16x32_bf16 v[156:159], v[216:219], v[64:67], v[156:159]
    s_waitcnt lgkmcnt(6)
    ds_read_b128 v[172:175], v94 offset:18432
    v_mfma_f32_16x16x32_bf16 v[160:163], v[220:223], v[64:67], v[160:163]
    ds_read_b128 v[176:179], v94 offset:19456
    v_mfma_f32_16x16x32_bf16 v[164:167], v[224:227], v[64:67], v[164:167]
    ds_read_b128 v[180:183], v94 offset:20480
    v_mfma_f32_16x16x32_bf16 v[168:171], v[228:231], v[64:67], v[168:171]
    s_waitcnt vmcnt(8)
    v_max3_u32 v104, v136, v137, v138
    v_max_u32 v104, v104, v139
    v_cmp_eq_u32 vcc, -1, v104
    s_cbranch_vccnz L_stub_zs
L_ok_zs:
    v_add_f32_dpp v136, v136, v136 row_ror:2 row_mask:0xf bank_mask:0xf
    v_add_f32_dpp v137, v137, v137 row_ror:2 row_mask:0xf bank_mask:0xf
    v_add_f32_dpp v138, v138, v138 row_ror:2 row_mask:0xf bank_mask:0xf
    v_add_f32_dpp v139, v139, v139 row_ror:2 row_mask:0xf bank_mask:0xf
    v_add_f32_dpp v136, v136, v136 row_ror:4 row_mask:0xf bank_mask:0xf
    v_add_f32_dpp v137, v137, v137 row_ror:4 row_mask:0xf bank_mask:0xf
    v_add_f32_dpp v138, v138, v138 row_ror:4 row_mask:0xf bank_mask:0xf
    v_add_f32_dpp v139, v139, v139 row_ror:4 row_mask:0xf bank_mask:0xf
    v_add_f32_dpp v136, v136, v136 row_ror:8 row_mask:0xf bank_mask:0xf
    v_add_f32_dpp v137, v137, v137 row_ror:8 row_mask:0xf bank_mask:0xf
    v_add_f32_dpp v138, v138, v138 row_ror:8 row_mask:0xf bank_mask:0xf
    v_add_f32_dpp v139, v139, v139 row_ror:8 row_mask:0xf bank_mask:0xf
    v_mul_f32_dpp v200, v136, v103 quad_perm:[0,0,2,2] row_mask:0xf bank_mask:0xf
    v_mul_f32_dpp v201, v137, v103 quad_perm:[0,0,2,2] row_mask:0xf bank_mask:0xf
    v_mul_f32_dpp v202, v138, v103 quad_perm:[0,0,2,2] row_mask:0xf bank_mask:0xf
    v_mul_f32_dpp v203, v139, v103 quad_perm:[0,0,2,2] row_mask:0xf bank_mask:0xf
    v_mul_f32_dpp v196, v136, v103 quad_perm:[1,1,3,3] row_mask:0xf bank_mask:0xf
    v_mul_f32_dpp v197, v137, v103 quad_perm:[1,1,3,3] row_mask:0xf bank_mask:0xf
    v_mul_f32_dpp v198, v138, v103 quad_perm:[1,1,3,3] row_mask:0xf bank_mask:0xf
    v_mul_f32_dpp v199, v139, v103 quad_perm:[1,1,3,3] row_mask:0xf bank_mask:0xf
    v_pk_fma_f32 v[196:197], v[200:201], v[200:201], v[196:197] neg_lo:[1,0,0] neg_hi:[1,0,0]
    v_pk_fma_f32 v[198:199], v[202:203], v[202:203], v[198:199] neg_lo:[1,0,0] neg_hi:[1,0,0]
    v_max_f32 v196, 0, v196
    v_max_f32 v197, 0, v197
    v_max_f32 v198, 0, v198
    v_max_f32 v199, 0, v199
    v_add_f32 v196, 0x3727c5ac, v196
    v_add_f32 v197, 0x3727c5ac, v197
    v_add_f32 v198, 0x3727c5ac, v198
    v_add_f32 v199, 0x3727c5ac, v199
    v_rsq_f32 v196, v196
    v_rsq_f32 v197, v197
    v_rsq_f32 v198, v198
    v_rsq_f32 v199, v199
    v_pk_mul_f32 v[200:201], v[200:201], v[196:197] neg_lo:[1,0] neg_hi:[1,0]
    v_pk_mul_f32 v[202:203], v[202:203], v[198:199] neg_lo:[1,0] neg_hi:[1,0]
    v_pk_fma_f32 v[112:113], v[112:113], v[196:197], v[200:201]
    v_pk_fma_f32 v[114:115], v[114:115], v[198:199], v[202:203]
    v_pk_fma_f32 v[116:117], v[116:117], v[196:197], v[200:201]
    v_pk_fma_f32 v[118:119], v[118:119], v[198:199], v[202:203]
    v_pk_fma_f32 v[120:121], v[120:121], v[196:197], v[200:201]
    v_pk_fma_f32 v[122:123], v[122:123], v[198:199], v[202:203]
    v_pk_fma_f32 v[124:125], v[124:125], v[196:197], v[200:201]
    v_pk_fma_f32 v[126:127], v[126:127], v[198:199], v[202:203]
    v_pk_fma_f32 v[128:129], v[128:129], v[196:197], v[200:201]
    v_pk_fma_f32 v[130:131], v[130:131], v[198:199], v[202:203]
    v_pk_fma_f32 v[132:133], v[132:133], v[196:197], v[200:201]
    v_pk_fma_f32 v[134:135], v[134:135], v[198:199], v[202:203]
    v_permlane32_swap_b32 v112, v116
    v_permlane32_swap_b32 v113, v117
    v_permlane32_swap_b32 v114, v118
    v_permlane32_swap_b32 v115, v119
    v_cvt_pk_bf16_f32 v112, v112, v116
    v_cvt_pk_bf16_f32 v113, v113, v117
    v_cvt_pk_bf16_f32 v114, v114, v118
    v_cvt_pk_bf16_f32 v115, v115, v119
    buffer_store_dwordx4 v[112:115], v99, s[60:63], s13 offen sc1
    v_permlane32_swap_b32 v120, v124
    v_permlane32_swap_b32 v121, v125
    v_permlane32_swap_b32 v122, v126
    v_permlane32_swap_b32 v123, v127
    v_cvt_pk_bf16_f32 v120, v120, v124
    v_cvt_pk_bf16_f32 v121, v121, v125
    v_cvt_pk_bf16_f32 v122, v122, v126
    v_cvt_pk_bf16_f32 v123, v123, v127
    buffer_store_dwordx4 v[120:123], v99, s[60:63], s21 offen sc1
    v_permlane32_swap_b32 v128, v132
    v_permlane32_swap_b32 v129, v133
    v_permlane32_swap_b32 v130, v134
    v_permlane32_swap_b32 v131, v135
    v_cvt_pk_bf16_f32 v128, v128, v132
    v_cvt_pk_bf16_f32 v129, v129, v133
    v_cvt_pk_bf16_f32 v130, v130, v134
    v_cvt_pk_bf16_f32 v131, v131, v135
    buffer_store_dwordx4 v[128:131], v99, s[60:63], s22 offen sc1
    s_waitcnt vmcnt(8)
    buffer_store_dword v2, v110, s[60:63], s12 offen sc1
    s_waitcnt lgkmcnt(6)
    ds_read_b128 v[184:187], v94 offset:21504
    v_mfma_f32_16x16x32_bf16 v[148:151], v[232:235], v[68:71], v[148:151]
    ds_read_b128 v[188:191], v94 offset:22528
    s_add_u32 m0, s71, 12288
    v_mfma_f32_16x16x32_bf16 v[152:155], v[236:239], v[68:71], v[152:155]
    ds_read_b128 v[192:195], v94 offset:23552
    v_mfma_f32_16x16x32_bf16 v[156:159], v[240:243], v[68:71], v[156:159]
    s_waitcnt lgkmcnt(6)
    ds_read_b128 v[208:211], v94 offset:36864
    buffer_load_dwordx2 v[108:109], v107, s[60:63], s23 offen sc1
    v_mfma_f32_16x16x32_bf16 v[160:163], v[244:247], v[68:71], v[160:163]
    ds_read_b128 v[212:215], v94 offset:37888
    s_add_u32 s78, s15, 5120
    v_mfma_f32_16x16x32_bf16 v[164:167], v[248:251], v[68:71], v[164:167]
    ds_read_b128 v[216:219], v94 offset:38912
    v_mfma_f32_16x16x32_bf16 v[168:171], v[252:255], v[68:71], v[168:171]
    s_waitcnt lgkmcnt(6)
    ds_read_b128 v[220:223], v94 offset:39936
    v_mfma_f32_16x16x32_bf16 v[148:151], v[172:175], v[72:75], v[148:151]
    ds_read_b128 v[224:227], v94 offset:40960
    v_mfma_f32_16x16x32_bf16 v[152:155], v[176:179], v[72:75], v[152:155]
    ds_read_b128 v[228:231], v94 offset:41984
    v_mfma_f32_16x16x32_bf16 v[156:159], v[180:183], v[72:75], v[156:159]
    s_waitcnt lgkmcnt(6)
    ds_read_b128 v[232:235], v94 offset:55296
    buffer_load_dwordx4 v106, s[60:63], s78 offen offset:0 sc1 lds
    v_mfma_f32_16x16x32_bf16 v[160:163], v[184:187], v[72:75], v[160:163]
    ds_read_b128 v[236:239], v94 offset:56320
    v_mfma_f32_16x16x32_bf16 v[164:167], v[188:191], v[72:75], v[164:167]
    ds_read_b128 v[240:243], v95 offset:0
    v_mfma_f32_16x16x32_bf16 v[168:171], v[192:195], v[72:75], v[168:171]
    s_waitcnt lgkmcnt(6)
    ds_read_b128 v[244:247], v95 offset:1024
    buffer_load_dwordx4 v106, s[60:63], s78 offen offset:1024 sc1 lds
    v_mfma_f32_16x16x32_bf16 v[148:151], v[208:211], v[76:79], v[148:151]
    ds_read_b128 v[248:251], v95 offset:2048
    v_mfma_f32_16x16x32_bf16 v[152:155], v[212:215], v[76:79], v[152:155]
    ds_read_b128 v[252:255], v95 offset:3072
    buffer_load_dwordx4 v106, s[60:63], s78 offen offset:2048 sc1 lds
    v_mfma_f32_16x16x32_bf16 v[156:159], v[216:219], v[76:79], v[156:159]
    s_waitcnt lgkmcnt(6)
    buffer_load_dwordx4 v106, s[60:63], s78 offen offset:3072 sc1 lds
    s_add_u32 m0, s71, 16384
    v_mfma_f32_16x16x32_bf16 v[160:163], v[220:223], v[76:79], v[160:163]
    v_mfma_f32_16x16x32_bf16 v[164:167], v[224:227], v[76:79], v[164:167]
    v_mfma_f32_16x16x32_bf16 v[168:171], v[228:231], v[76:79], v[168:171]
    s_waitcnt lgkmcnt(3)
    s_add_u32 s78, s15, 9216
    v_mfma_f32_16x16x32_bf16 v[148:151], v[232:235], v[80:83], v[148:151]
    v_mfma_f32_16x16x32_bf16 v[152:155], v[236:239], v[80:83], v[152:155]
    buffer_load_dwordx4 v106, s[60:63], s78 offen offset:0 sc1 lds
    v_mfma_f32_16x16x32_bf16 v[156:159], v[240:243], v[80:83], v[156:159]
    s_waitcnt lgkmcnt(0)
    v_mfma_f32_16x16x32_bf16 v[160:163], v[244:247], v[80:83], v[160:163]
    v_mfma_f32_16x16x32_bf16 v[164:167], v[248:251], v[80:83], v[164:167]
    v_mfma_f32_16x16x32_bf16 v[168:171], v[252:255], v[80:83], v[168:171]
    s_nop 0
    ds_read_b128 v[172:175], v101 offset:0
    ds_read_b128 v[176:179], v101 offset:64
    ds_read_b128 v[180:183], v101 offset:128
    ds_read_b128 v[184:187], v101 offset:192
    ds_read_b128 v[188:191], v101 offset:256
    ds_read_b128 v[192:195], v101 offset:320
    s_mul_i32 s3, s68, 10
    s_set_gpr_idx_on s3, gpr_idx(SRC0)
    s_nop 0
    v_mov_b32 v240, v4
    v_mov_b32 v241, v5
    v_mov_b32 v242, v6
    v_mov_b32 v243, v7
    v_mov_b32 v244, v8
    v_mov_b32 v245, v9
    v_mov_b32 v246, v10
    v_mov_b32 v247, v11
    v_mov_b32 v248, v12
    v_mov_b32 v249, v13
    s_set_gpr_idx_off
    s_waitcnt lgkmcnt(0)
    s_barrier
    v_pk_fma_f32 v[148:149], v[172:173], v[204:205], v[148:149] op_sel:[0,1,0] op_sel_hi:[1,1,1]
    s_add_u32 m0, s95, 0
    s_nop 0
    v_pk_fma_f32 v[150:151], v[174:175], v[204:205], v[150:151] op_sel:[0,1,0] op_sel_hi:[1,1,1]
    v_pk_fma_f32 v[152:153], v[176:177], v[204:205], v[152:153] op_sel:[0,1,0] op_sel_hi:[1,1,1]
    v_pk_fma_f32 v[154:155], v[178:179], v[204:205], v[154:155] op_sel:[0,1,0] op_sel_hi:[1,1,1]
    v_pk_fma_f32 v[156:157], v[180:181], v[204:205], v[156:157] op_sel:[0,1,0] op_sel_hi:[1,1,1]
    v_pk_fma_f32 v[158:159], v[182:183], v[204:205], v[158:159] op_sel:[0,1,0] op_sel_hi:[1,1,1]
    v_pk_fma_f32 v[160:161], v[184:185], v[204:205], v[160:161] op_sel:[0,1,0] op_sel_hi:[1,1,1]
    v_pk_fma_f32 v[162:163], v[186:187], v[204:205], v[162:163] op_sel:[0,1,0] op_sel_hi:[1,1,1]
    v_pk_mul_f32 v[148:149], v[148:149], v[204:205] op_sel_hi:[1,0]
    v_pk_mul_f32 v[150:151], v[150:151], v[204:205] op_sel_hi:[1,0]
    s_add_u32 s78, s15, 66560
    v_pk_mul_f32 v[152:153], v[152:153], v[204:205] op_sel_hi:[1,0]
    v_pk_mul_f32 v[154:155], v[154:155], v[204:205] op_sel_hi:[1,0]
    v_pk_mul_f32 v[156:157], v[156:157], v[204:205] op_sel_hi:[1,0]
    v_pk_mul_f32 v[158:159], v[158:159], v[204:205] op_sel_hi:[1,0]
    v_pk_mul_f32 v[160:161], v[160:161], v[204:205] op_sel_hi:[1,0]
    v_pk_mul_f32 v[162:163], v[162:163], v[204:205] op_sel_hi:[1,0]
    v_pk_mul_f32 v[112:113], v[148:149], v[148:149]
    v_pk_mul_f32 v[114:115], v[150:151], v[150:151]
    v_pk_mul_f32 v[116:117], v[152:153], v[152:153]
    v_pk_mul_f32 v[118:119], v[154:155], v[154:155]
    buffer_load_dwordx4 v106, s[60:63], s78 offen offset:0 sc1 lds
    v_pk_mul_f32 v[120:121], v[156:157], v[156:157]
    v_pk_mul_f32 v[122:123], v[158:159], v[158:159]
    v_pk_mul_f32 v[124:125], v[160:161], v[160:161]
    v_pk_mul_f32 v[126:127], v[162:163], v[162:163]
    v_pk_fma_f32 v[112:113], v[112:113], s[84:85], v[102:103] op_sel_hi:[1,1,0]
    v_pk_fma_f32 v[114:115], v[114:115], s[84:85], v[102:103] op_sel_hi:[1,1,0]
    v_pk_fma_f32 v[116:117], v[116:117], s[84:85], v[102:103] op_sel_hi:[1,1,0]
    v_pk_fma_f32 v[118:119], v[118:119], s[84:85], v[102:103] op_sel_hi:[1,1,0]
    v_pk_fma_f32 v[120:121], v[120:121], s[84:85], v[102:103] op_sel_hi:[1,1,0]
    v_pk_fma_f32 v[122:123], v[122:123], s[84:85], v[102:103] op_sel_hi:[1,1,0]
    buffer_load_dwordx4 v106, s[60:63], s78 offen offset:1024 sc1 lds
    v_pk_fma_f32 v[124:125], v[124:125], s[84:85], v[102:103] op_sel_hi:[1,1,0]
    v_pk_fma_f32 v[126:127], v[126:127], s[84:85], v[102:103] op_sel_hi:[1,1,0]
    v_pk_mul_f32 v[112:113], v[112:113], v[148:149]
    v_pk_mul_f32 v[114:115], v[114:115], v[150:151]
    v_pk_mul_f32 v[116:117], v[116:117], v[152:153]
    v_pk_mul_f32 v[118:119], v[118:119], v[154:155]
    v_pk_mul_f32 v[120:121], v[120:121], v[156:157]
    v_pk_mul_f32 v[122:123], v[122:123], v[158:159]
    v_pk_mul_f32 v[124:125], v[124:125], v[160:161]
    v_pk_mul_f32 v[126:127], v[126:127], v[162:163]
    buffer_load_dwordx4 v106, s[60:63], s78 offen offset:2048 sc1 lds
    v_exp_f32 v112, v112
    v_exp_f32 v113, v113
    v_exp_f32 v114, v114
    v_exp_f32 v115, v115
    v_exp_f32 v116, v116
    v_exp_f32 v117, v117
    v_exp_f32 v118, v118
    v_exp_f32 v119, v119
    v_exp_f32 v120, v120
    buffer_load_dwordx4 v106, s[60:63], s78 offen offset:3072 sc1 lds
    v_exp_f32 v121, v121
    v_exp_f32 v122, v122
    v_exp_f32 v123, v123
    v_exp_f32 v124, v124
    v_exp_f32 v125, v125
    v_exp_f32 v126, v126
    v_exp_f32 v127, v127
    v_pk_add_f32 v[112:113], v[112:113], 1.0 op_sel_hi:[1,0]
    v_pk_add_f32 v[114:115], v[114:115], 1.0 op_sel_hi:[1,0]
    v_pk_add_f32 v[116:117], v[116:117], 1.0 op_sel_hi:[1,0]
    s_add_u32 m0, s95, 4096
    v_pk_add_f32 v[118:119], v[118:119], 1.0 op_sel_hi:[1,0]
    v_pk_add_f32 v[120:121], v[120:121], 1.0 op_sel_hi:[1,0]
    v_pk_add_f32 v[122:123], v[122:123], 1.0 op_sel_hi:[1,0]
    v_pk_add_f32 v[124:125], v[124:125], 1.0 op_sel_hi:[1,0]
    v_pk_add_f32 v[126:127], v[126:127], 1.0 op_sel_hi:[1,0]
    v_rcp_f32 v112, v112
    v_rcp_f32 v113, v113
    v_rcp_f32 v114, v114
    v_rcp_f32 v115, v115
    v_rcp_f32 v116, v116
    s_add_u32 s78, s15, 70656
    v_rcp_f32 v117, v117
    v_rcp_f32 v118, v118
    v_rcp_f32 v119, v119
    v_rcp_f32 v120, v120
    v_rcp_f32 v121, v121
    v_rcp_f32 v122, v122
    v_rcp_f32 v123, v123
    v_rcp_f32 v124, v124
    v_rcp_f32 v125, v125
    v_rcp_f32 v126, v126
    buffer_load_dwordx4 v106, s[60:63], s78 offen offset:0 sc1 lds
    v_rcp_f32 v127, v127
    v_pk_mul_f32 v[148:149], v[148:149], v[112:113]
    v_pk_mul_f32 v[150:151], v[150:151], v[114:115]
    v_pk_mul_f32 v[152:153], v[152:153], v[116:117]
    v_pk_mul_f32 v[154:155], v[154:155], v[118:119]
    v_pk_mul_f32 v[156:157], v[156:157], v[120:121]
    v_pk_mul_f32 v[158:159], v[158:159], v[122:123]
    v_pk_mul_f32 v[160:161], v[160:161], v[124:125]
    v_pk_mul_f32 v[162:163], v[162:163], v[126:127]
    s_waitcnt vmcnt(10)
    v_max_u32 v104, v108, v109
    v_cmp_eq_u32 vcc, -1, v104
    s_cbranch_vccnz L_stub_zc
L_ok_zc:
    s_getpc_b64 s[38:39]
    s_lshl_b32 s3, s66, 2
    s_add_u32 s3, s3, s64
    s_lshl_b32 s3, s3, 7
    v_mov_b32 v250, s3
    global_load_dword v250, v250, s[38:39]
    v_pk_fma_f32 v[164:165], v[188:189], v[204:205], v[164:165] op_sel:[0,1,0] op_sel_hi:[1,1,1]
    s_add_u32 s91, s4, 0
    v_pk_fma_f32 v[166:167], v[190:191], v[204:205], v[166:167] op_sel:[0,1,0] op_sel_hi:[1,1,1]
    v_pk_fma_f32 v[168:169], v[192:193], v[204:205], v[168:169] op_sel:[0,1,0] op_sel_hi:[1,1,1]
    buffer_load_dwordx4 v[4:7], v106, s[60:63], s91 offen offset:0 sc1
    v_pk_fma_f32 v[170:171], v[194:195], v[204:205], v[170:171] op_sel:[0,1,0] op_sel_hi:[1,1,1]
    v_pk_mul_f32 v[164:165], v[164:165], v[204:205] op_sel_hi:[1,0]
    buffer_load_dwordx4 v[8:11], v106, s[60:63], s91 offen offset:1024 sc1
    v_pk_mul_f32 v[166:167], v[166:167], v[204:205] op_sel_hi:[1,0]
    v_pk_mul_f32 v[168:169], v[168:169], v[204:205] op_sel_hi:[1,0]
    buffer_load_dwordx4 v[12:15], v106, s[60:63], s91 offen offset:2048 sc1
    v_pk_mul_f32 v[170:171], v[170:171], v[204:205] op_sel_hi:[1,0]
    v_pk_mul_f32 v[128:129], v[164:165], v[164:165]
    buffer_load_dwordx4 v[16:19], v106, s[60:63], s91 offen offset:3072 sc1
    v_pk_mul_f32 v[130:131], v[166:167], v[166:167]
    v_pk_mul_f32 v[132:133], v[168:169], v[168:169]
    v_pk_mul_f32 v[134:135], v[170:171], v[170:171]
    s_add_u32 s91, s5, 0
    s_nop 0
    v_pk_fma_f32 v[128:129], v[128:129], s[84:85], v[102:103] op_sel_hi:[1,1,0]
    v_pk_fma_f32 v[130:131], v[130:131], s[84:85], v[102:103] op_sel_hi:[1,1,0]
    buffer_load_dwordx4 v[20:23], v106, s[60:63], s91 offen offset:0 sc1
    v_pk_fma_f32 v[132:133], v[132:133], s[84:85], v[102:103] op_sel_hi:[1,1,0]
    v_pk_fma_f32 v[134:135], v[134:135], s[84:85], v[102:103] op_sel_hi:[1,1,0]
    buffer_load_dwordx4 v[24:27], v106, s[60:63], s91 offen offset:1024 sc1
    v_pk_mul_f32 v[128:129], v[128:129], v[164:165]
    v_pk_mul_f32 v[130:131], v[130:131], v[166:167]
    buffer_load_dwordx4 v[28:31], v106, s[60:63], s91 offen offset:2048 sc1
    v_pk_mul_f32 v[132:133], v[132:133], v[168:169]
    v_pk_mul_f32 v[134:135], v[134:135], v[170:171]
    buffer_load_dwordx4 v[32:35], v106, s[60:63], s91 offen offset:3072 sc1
    v_exp_f32 v128, v128
    v_exp_f32 v129, v129
    v_exp_f32 v130, v130
    s_add_u32 s91, s6, 0
    v_exp_f32 v131, v131
    v_exp_f32 v132, v132
    buffer_load_dwordx4 v[36:39], v106, s[60:63], s91 offen offset:0 sc1
    v_exp_f32 v133, v133
    v_exp_f32 v134, v134
    buffer_load_dwordx4 v[40:43], v106, s[60:63], s91 offen offset:1024 sc1
    v_exp_f32_e64 v135, v135
    v_pk_add_f32 v[128:129], v[128:129], 1.0 op_sel_hi:[1,0]
    buffer_load_dwordx4 v[44:47], v106, s[60:63], s91 offen offset:2048 sc1
    v_pk_add_f32 v[130:131], v[130:131], 1.0 op_sel_hi:[1,0]
    v_pk_add_f32 v[132:133], v[132:133], 1.0 op_sel_hi:[1,0]
    buffer_load_dwordx4 v[48:51], v106, s[60:63], s91 offen offset:3072 sc1
    v_pk_add_f32 v[134:135], v[134:135], 1.0 op_sel_hi:[1,0]
    v_rcp_f32 v128, v128
    v_rcp_f32 v129, v129
    s_add_u32 s91, s7, 0
    v_rcp_f32 v130, v130
    v_rcp_f32 v131, v131
    buffer_load_dwordx4 v[52:55], v106, s[60:63], s91 offen offset:0 sc1
    v_rcp_f32 v132, v132
    v_rcp_f32 v133, v133
    buffer_load_dwordx4 v[56:59], v106, s[60:63], s91 offen offset:1024 sc1
    v_rcp_f32 v134, v134
    v_rcp_f32_e64 v135, v135
    buffer_load_dwordx4 v[60:63], v106, s[60:63], s91 offen offset:2048 sc1
    v_pk_mul_f32 v[164:165], v[164:165], v[128:129]
    v_pk_mul_f32 v[166:167], v[166:167], v[130:131]
    buffer_load_dwordx4 v[64:67], v106, s[60:63], s91 offen offset:3072 sc1
    v_pk_mul_f32 v[168:169], v[168:169], v[132:133]
    v_pk_mul_f32 v[170:171], v[170:171], v[134:135]
    s_waitcnt vmcnt(12)
    s_nop 0
    v_max3_u32 v104, v4, v5, v6
    v_max3_u32 v104, v104, v7, v8
    v_max3_u32 v104, v104, v9, v10
    v_max3_u32 v104, v104, v11, v12
    v_max3_u32 v104, v104, v13, v14
    v_max3_u32 v104, v104, v15, v16
    v_max3_u32 v104, v104, v17, v18
    v_max_u32 v104, v104, v19
    v_cmp_eq_u32 vcc, -1, v104
    s_cbranch_vccnz L_stub_z0
L_ok_z0:
    v_mfma_f32_16x16x32_bf16 v[176:179], v[4:7], a[0:3], 0
    s_add_u32 s91, s8, 0
    buffer_load_dwordx4 v[68:71], v106, s[60:63], s91 offen offset:0 sc1
    v_mfma_f32_16x16x32_bf16 v[184:187], v[4:7], a[64:67], 0
    v_mfma_f32_16x16x32_bf16 v[192:195], v[4:7], a[128:131], 0
    v_mfma_f32_16x16x32_bf16 v[200:203], v[4:7], a[192:195], 0
    v_mfma_f32_16x16x32_bf16 v[180:183], v[8:11], a[0:3], 0
    s_waitcnt vmcnt(12)
    v_max3_u32 v104, v20, v21, v22
    v_mfma_f32_16x16x32_bf16 v[188:191], v[8:11], a[64:67], 0
    s_waitcnt vmcnt(11)
    buffer_load_dwordx4 v[72:75], v106, s[60:63], s91 offen offset:1024 sc1
    v_max3_u32 v104, v104, v23, v24
    v_mfma_f32_16x16x32_bf16 v[196:199], v[8:11], a[128:131], 0
    v_max3_u32 v104, v104, v25, v26
    v_mfma_f32_16x16x32_bf16 v[204:207], v[8:11], a[192:195], 0
    s_waitcnt vmcnt(11)
    v_max3_u32 v104, v104, v27, v28
    v_mfma_f32_16x16x32_bf16 v[176:179], v[12:15], a[4:7], v[176:179]
    v_max3_u32 v104, v104, v29, v30
    v_mfma_f32_16x16x32_bf16 v[184:187], v[12:15], a[68:71], v[184:187]
    s_waitcnt vmcnt(10)
    buffer_load_dwordx4 v[76:79], v106, s[60:63], s91 offen offset:2048 sc1
    v_max3_u32 v104, v104, v31, v32
    v_mfma_f32_16x16x32_bf16 v[192:195], v[12:15], a[132:135], v[192:195]
    v_max3_u32 v104, v104, v33, v34
    v_mfma_f32_16x16x32_bf16 v[200:203], v[12:15], a[196:199], v[200:203]
    v_max_u32 v104, v104, v35
    v_mfma_f32_16x16x32_bf16 v[180:183], v[16:19], a[4:7], v[180:183]
    v_mfma_f32_16x16x32_bf16 v[188:191], v[16:19], a[68:71], v[188:191]
    buffer_load_dwordx4 v[80:83], v106, s[60:63], s91 offen offset:3072 sc1
    v_cmp_eq_u32 vcc, -1, v104
    v_mfma_f32_16x16x32_bf16 v[196:199], v[16:19], a[132:135], v[196:199]
    v_mfma_f32_16x16x32_bf16 v[204:207], v[16:19], a[196:199], v[204:207]
    s_cbranch_vccnz L_stub_z1
L_ok_z1:
    v_mfma_f32_16x16x32_bf16 v[176:179], v[20:23], a[8:11], v[176:179]
    s_lshl_b32 s72, s69, 2
    v_mfma_f32_16x16x32_bf16 v[184:187], v[20:23], a[72:75], v[184:187]
    s_add_u32 s91, s9, 0
    buffer_load_dwordx4 v[4:7], v106, s[60:63], s91 offen offset:0 sc1
    v_mfma_f32_16x16x32_bf16 v[192:195], v[20:23], a[136:139], v[192:195]
    v_mfma_f32_16x16x32_bf16 v[200:203], v[20:23], a[200:203], v[200:203]
    v_mfma_f32_16x16x32_bf16 v[180:183], v[24:27], a[8:11], v[180:183]
    s_waitcnt vmcnt(12)
    s_add_u32 s74, s72, s64
    v_max3_u32 v104, v36, v37, v38
    v_mfma_f32_16x16x32_bf16 v[188:191], v[24:27], a[72:75], v[188:191]
    s_waitcnt vmcnt(11)
    buffer_load_dwordx4 v[8:11], v106, s[60:63], s91 offen offset:1024 sc1
    v_max3_u32 v104, v104, v39, v40
    v_mfma_f32_16x16x32_bf16 v[196:199], v[24:27], a[136:139], v[196:199]
    v_max3_u32 v104, v104, v41, v42
    v_mfma_f32_16x16x32_bf16 v[204:207], v[24:27], a[200:203], v[204:207]
    s_waitcnt vmcnt(11)
    v_max3_u32 v104, v104, v43, v44
    v_mfma_f32_16x16x32_bf16 v[176:179], v[28:31], a[12:15], v[176:179]
    s_mul_i32 s17, s74, 24576
    v_max3_u32 v104, v104, v45, v46
    v_mfma_f32_16x16x32_bf16 v[184:187], v[28:31], a[76:79], v[184:187]
    s_waitcnt vmcnt(10)
    buffer_load_dwordx4 v[12:15], v106, s[60:63], s91 offen offset:2048 sc1
    v_max3_u32 v104, v104, v47, v48
    v_mfma_f32_16x16x32_bf16 v[192:195], v[28:31], a[140:143], v[192:195]
    v_max3_u32 v104, v104, v49, v50
    v_mfma_f32_16x16x32_bf16 v[200:203], v[28:31], a[204:207], v[200:203]
    v_max_u32 v104, v104, v51
    v_mfma_f32_16x16x32_bf16 v[180:183], v[32:35], a[12:15], v[180:183]
    s_add_u32 s17, s17, 6946816
    v_mfma_f32_16x16x32_bf16 v[188:191], v[32:35], a[76:79], v[188:191]
    buffer_load_dwordx4 v[16:19], v106, s[60:63], s91 offen offset:3072 sc1
    v_cmp_eq_u32 vcc, -1, v104
    v_mfma_f32_16x16x32_bf16 v[196:199], v[32:35], a[140:143], v[196:199]
    v_mfma_f32_16x16x32_bf16 v[204:207], v[32:35], a[204:207], v[204:207]
    s_cbranch_vccnz L_stub_z2
L_ok_z2:
    v_mfma_f32_16x16x32_bf16 v[176:179], v[36:39], a[16:19], v[176:179]
    s_lshl_b32 s18, s74, 7
    v_mfma_f32_16x16x32_bf16 v[184:187], v[36:39], a[80:83], v[184:187]
    s_add_u32 s91, s10, 0
    buffer_load_dwordx4 v[20:23], v106, s[60:63], s91 offen offset:0 sc1
    v_mfma_f32_16x16x32_bf16 v[192:195], v[36:39], a[144:147], v[192:195]
    v_mfma_f32_16x16x32_bf16 v[200:203], v[36:39], a[208:211], v[200:203]
    v_mfma_f32_16x16x32_bf16 v[180:183], v[40:43], a[16:19], v[180:183]
    s_waitcnt vmcnt(12)
    s_mul_i32 s72, s70, 327680
    v_max3_u32 v104, v52, v53, v54
    v_mfma_f32_16x16x32_bf16 v[188:191], v[40:43], a[80:83], v[188:191]
    s_waitcnt vmcnt(11)
    buffer_load_dwordx4 v[24:27], v106, s[60:63], s91 offen offset:1024 sc1
    v_max3_u32 v104, v104, v55, v56
    v_mfma_f32_16x16x32_bf16 v[196:199], v[40:43], a[144:147], v[196:199]
    v_max3_u32 v104, v104, v57, v58
    v_mfma_f32_16x16x32_bf16 v[204:207], v[40:43], a[208:211], v[204:207]
    s_waitcnt vmcnt(11)
    v_max3_u32 v104, v104, v59, v60
    v_mfma_f32_16x16x32_bf16 v[176:179], v[44:47], a[20:23], v[176:179]
    s_add_u32 s18, s18, s72
    v_max3_u32 v104, v104, v61, v62
    v_mfma_f32_16x16x32_bf16 v[184:187], v[44:47], a[84:87], v[184:187]
    s_waitcnt vmcnt(10)
    buffer_load_dwordx4 v[28:31], v106, s[60:63], s91 offen offset:2048 sc1
    v_max3_u32 v104, v104, v63, v64
    v_mfma_f32_16x16x32_bf16 v[192:195], v[44:47], a[148:151], v[192:195]
    v_max3_u32 v104, v104, v65, v66
    v_mfma_f32_16x16x32_bf16 v[200:203], v[44:47], a[212:215], v[200:203]
    v_max_u32 v104, v104, v67
    v_mfma_f32_16x16x32_bf16 v[180:183], v[48:51], a[20:23], v[180:183]
    s_add_u32 s18, s18, 1048576
    v_mfma_f32_16x16x32_bf16 v[188:191], v[48:51], a[84:87], v[188:191]
    buffer_load_dwordx4 v[32:35], v106, s[60:63], s91 offen offset:3072 sc1
    v_cmp_eq_u32 vcc, -1, v104
    v_mfma_f32_16x16x32_bf16 v[196:199], v[48:51], a[148:151], v[196:199]
    v_mfma_f32_16x16x32_bf16 v[204:207], v[48:51], a[212:215], v[204:207]
    s_cbranch_vccnz L_stub_z3
L_ok_z3:
    v_mfma_f32_16x16x32_bf16 v[176:179], v[52:55], a[24:27], v[176:179]
    s_mul_i32 s72, s74, 20480
    v_mfma_f32_16x16x32_bf16 v[184:187], v[52:55], a[88:91], v[184:187]
    s_add_u32 s91, s11, 0
    buffer_load_dwordx4 v[36:39], v106, s[60:63], s91 offen offset:0 sc1
    v_mfma_f32_16x16x32_bf16 v[192:195], v[52:55], a[152:155], v[192:195]
    v_mfma_f32_16x16x32_bf16 v[200:203], v[52:55], a[216:219], v[200:203]
    v_mfma_f32_16x16x32_bf16 v[180:183], v[56:59], a[24:27], v[180:183]
    s_waitcnt vmcnt(12)
    s_mul_i32 s19, s70, 160
    v_max3_u32 v104, v68, v69, v70
    v_mfma_f32_16x16x32_bf16 v[188:191], v[56:59], a[88:91], v[188:191]
    s_waitcnt vmcnt(11)
    buffer_load_dwordx4 v[40:43], v106, s[60:63], s91 offen offset:1024 sc1
    v_max3_u32 v104, v104, v71, v72
    v_mfma_f32_16x16x32_bf16 v[196:199], v[56:59], a[152:155], v[196:199]
    v_max3_u32 v104, v104, v73, v74
    v_mfma_f32_16x16x32_bf16 v[204:207], v[56:59], a[216:219], v[204:207]
    s_waitcnt vmcnt(11)
    v_max3_u32 v104, v104, v75, v76
    v_mfma_f32_16x16x32_bf16 v[176:179], v[60:63], a[28:31], v[176:179]
    s_add_u32 s19, s19, s72
    v_max3_u32 v104, v104, v77, v78
    v_mfma_f32_16x16x32_bf16 v[184:187], v[60:63], a[92:95], v[184:187]
    s_waitcnt vmcnt(10)
    buffer_load_dwordx4 v[44:47], v106, s[60:63], s91 offen offset:2048 sc1
    v_max3_u32 v104, v104, v79, v80
    v_mfma_f32_16x16x32_bf16 v[192:195], v[60:63], a[156:159], v[192:195]
    v_max3_u32 v104, v104, v81, v82
    v_mfma_f32_16x16x32_bf16 v[200:203], v[60:63], a[220:223], v[200:203]
    v_max_u32 v104, v104, v83
    v_mfma_f32_16x16x32_bf16 v[180:183], v[64:67], a[28:31], v[180:183]
    s_lshl_b32 s23, s74, 10
    v_mfma_f32_16x16x32_bf16 v[188:191], v[64:67], a[92:95], v[188:191]
    buffer_load_dwordx4 v[48:51], v106, s[60:63], s91 offen offset:3072 sc1
    v_cmp_eq_u32 vcc, -1, v104
    v_mfma_f32_16x16x32_bf16 v[196:199], v[64:67], a[156:159], v[196:199]
    v_mfma_f32_16x16x32_bf16 v[204:207], v[64:67], a[220:223], v[204:207]
    s_cbranch_vccnz L_stub_z4
L_ok_z4:
    v_mfma_f32_16x16x32_bf16 v[176:179], v[68:71], a[32:35], v[176:179]
    s_add_u32 s23, s23, 524288
    v_mfma_f32_16x16x32_bf16 v[184:187], v[68:71], a[96:99], v[184:187]
    s_add_u32 s91, s4, 131072
    buffer_load_dwordx4 v[52:55], v106, s[60:63], s91 offen offset:0 sc1
    v_mfma_f32_16x16x32_bf16 v[192:195], v[68:71], a[160:163], v[192:195]
    v_mfma_f32_16x16x32_bf16 v[200:203], v[68:71], a[224:227], v[200:203]
    v_mfma_f32_16x16x32_bf16 v[180:183], v[72:75], a[32:35], v[180:183]
    s_waitcnt vmcnt(12)
    v_max3_u32 v104, v4, v5, v6
    v_and_b32 v107, 7, v1
    v_mfma_f32_16x16x32_bf16 v[188:191], v[72:75], a[96:99], v[188:191]
    s_waitcnt vmcnt(11)
    buffer_load_dwordx4 v[56:59], v106, s[60:63], s91 offen offset:1024 sc1
    v_max3_u32 v104, v104, v7, v8
    v_mfma_f32_16x16x32_bf16 v[196:199], v[72:75], a[160:163], v[196:199]
    v_max3_u32 v104, v104, v9, v10
    v_mfma_f32_16x16x32_bf16 v[204:207], v[72:75], a[224:227], v[204:207]
    s_waitcnt vmcnt(11)
    v_max3_u32 v104, v104, v11, v12
    v_mfma_f32_16x16x32_bf16 v[176:179], v[76:79], a[36:39], v[176:179]
    v_max3_u32 v104, v104, v13, v14
    v_lshlrev_b32 v107, 7, v107
    v_mfma_f32_16x16x32_bf16 v[184:187], v[76:79], a[100:103], v[184:187]
    s_waitcnt vmcnt(10)
    buffer_load_dwordx4 v[60:63], v106, s[60:63], s91 offen offset:2048 sc1
    v_max3_u32 v104, v104, v15, v16
    v_mfma_f32_16x16x32_bf16 v[192:195], v[76:79], a[164:167], v[192:195]
    v_max3_u32 v104, v104, v17, v18
    v_mfma_f32_16x16x32_bf16 v[200:203], v[76:79], a[228:231], v[200:203]
    v_max_u32 v104, v104, v19
    v_mfma_f32_16x16x32_bf16 v[180:183], v[80:83], a[36:39], v[180:183]
    v_lshrrev_b32 v250, 4, v1
    v_mfma_f32_16x16x32_bf16 v[188:191], v[80:83], a[100:103], v[188:191]
    buffer_load_dwordx4 v[64:67], v106, s[60:63], s91 offen offset:3072 sc1
    v_cmp_eq_u32 vcc, -1, v104
    v_mfma_f32_16x16x32_bf16 v[196:199], v[80:83], a[164:167], v[196:199]
    v_mfma_f32_16x16x32_bf16 v[204:207], v[80:83], a[228:231], v[204:207]
    s_cbranch_vccnz L_stub_z5
L_ok_z5:
    v_mfma_f32_16x16x32_bf16 v[176:179], v[4:7], a[40:43], v[176:179]
    v_lshlrev_b32 v250, 14, v250
    v_mfma_f32_16x16x32_bf16 v[184:187], v[4:7], a[104:107], v[184:187]
    s_add_u32 s91, s5, 131072
    buffer_load_dwordx4 v[68:71], v106, s[60:63], s91 offen offset:0 sc1
    v_mfma_f32_16x16x32_bf16 v[192:195], v[4:7], a[168:171], v[192:195]
    v_mfma_f32_16x16x32_bf16 v[200:203], v[4:7], a[232:235], v[200:203]
    v_mfma_f32_16x16x32_bf16 v[180:183], v[8:11], a[40:43], v[180:183]
    s_waitcnt vmcnt(12)
    v_max3_u32 v104, v20, v21, v22
    v_lshl_add_u32 v250, v111, 3, v250
    v_mfma_f32_16x16x32_bf16 v[188:191], v[8:11], a[104:107], v[188:191]
    s_waitcnt vmcnt(11)
    buffer_load_dwordx4 v[72:75], v106, s[60:63], s91 offen offset:1024 sc1
    v_max3_u32 v104, v104, v23, v24
    v_mfma_f32_16x16x32_bf16 v[196:199], v[8:11], a[168:171], v[196:199]
    v_max3_u32 v104, v104, v25, v26
    v_mfma_f32_16x16x32_bf16 v[204:207], v[8:11], a[232:235], v[204:207]
    s_waitcnt vmcnt(11)
    v_max3_u32 v104, v104, v27, v28
    v_mfma_f32_16x16x32_bf16 v[176:179], v[12:15], a[44:47], v[176:179]
    v_max3_u32 v104, v104, v29, v30
    v_mov_b32 v251, v94
    v_mfma_f32_16x16x32_bf16 v[184:187], v[12:15], a[108:111], v[184:187]
    s_waitcnt vmcnt(10)
    buffer_load_dwordx4 v[76:79], v106, s[60:63], s91 offen offset:2048 sc1
    v_max3_u32 v104, v104, v31, v32
    v_mfma_f32_16x16x32_bf16 v[192:195], v[12:15], a[172:175], v[192:195]
    v_max3_u32 v104, v104, v33, v34
    v_mfma_f32_16x16x32_bf16 v[200:203], v[12:15], a[236:239], v[200:203]
    v_max_u32 v104, v104, v35
    v_mfma_f32_16x16x32_bf16 v[180:183], v[16:19], a[44:47], v[180:183]
    v_mov_b32 v252, v95
    v_mfma_f32_16x16x32_bf16 v[188:191], v[16:19], a[108:111], v[188:191]
    buffer_load_dwordx4 v[80:83], v106, s[60:63], s91 offen offset:3072 sc1
    v_cmp_eq_u32 vcc, -1, v104
    v_mfma_f32_16x16x32_bf16 v[196:199], v[16:19], a[172:175], v[196:199]
    v_mfma_f32_16x16x32_bf16 v[204:207], v[16:19], a[236:239], v[204:207]
    s_cbranch_vccnz L_stub_z6
L_ok_z6:
    v_mfma_f32_16x16x32_bf16 v[176:179], v[20:23], a[48:51], v[176:179]
    v_mov_b32 v253, v96
    v_mfma_f32_16x16x32_bf16 v[184:187], v[20:23], a[112:115], v[184:187]
    s_add_u32 s91, s6, 131072
    buffer_load_dwordx4 v[4:7], v106, s[60:63], s91 offen offset:0 sc1
    v_mfma_f32_16x16x32_bf16 v[192:195], v[20:23], a[176:179], v[192:195]
    v_mfma_f32_16x16x32_bf16 v[200:203], v[20:23], a[240:243], v[200:203]
    v_mfma_f32_16x16x32_bf16 v[180:183], v[24:27], a[48:51], v[180:183]
    s_waitcnt vmcnt(12)
    v_max3_u32 v104, v36, v37, v38
    v_mfma_f32_16x16x32_bf16 v[188:191], v[24:27], a[112:115], v[188:191]
    s_waitcnt vmcnt(11)
    buffer_load_dwordx4 v[8:11], v106, s[60:63], s91 offen offset:1024 sc1
    v_max3_u32 v104, v104, v39, v40
    v_mfma_f32_16x16x32_bf16 v[196:199], v[24:27], a[176:179], v[196:199]
    v_max3_u32 v104, v104, v41, v42
    v_mfma_f32_16x16x32_bf16 v[204:207], v[24:27], a[240:243], v[204:207]
    s_waitcnt vmcnt(11)
    v_max3_u32 v104, v104, v43, v44
    v_mfma_f32_16x16x32_bf16 v[176:179], v[28:31], a[52:55], v[176:179]
    buffer_load_dword v108, v107, s[60:63], s23 offen sc1
    v_max3_u32 v104, v104, v45, v46
    v_mfma_f32_16x16x32_bf16 v[184:187], v[28:31], a[116:119], v[184:187]
    s_waitcnt vmcnt(11)
    buffer_load_dwordx4 v[12:15], v106, s[60:63], s91 offen offset:2048 sc1
    v_max3_u32 v104, v104, v47, v48
    v_mfma_f32_16x16x32_bf16 v[192:195], v[28:31], a[180:183], v[192:195]
    v_max3_u32 v104, v104, v49, v50
    v_mfma_f32_16x16x32_bf16 v[200:203], v[28:31], a[244:247], v[200:203]
    v_max_u32 v104, v104, v51
    v_mfma_f32_16x16x32_bf16 v[180:183], v[32:35], a[52:55], v[180:183]
    v_mfma_f32_16x16x32_bf16 v[188:191], v[32:35], a[116:119], v[188:191]
    buffer_load_dwordx4 v[16:19], v106, s[60:63], s91 offen offset:3072 sc1
    v_cmp_eq_u32 vcc, -1, v104
    v_mfma_f32_16x16x32_bf16 v[196:199], v[32:35], a[180:183], v[196:199]
    v_mfma_f32_16x16x32_bf16 v[204:207], v[32:35], a[244:247], v[204:207]
    s_cbranch_vccnz L_stub_z7
L_ok_z7:
    v_mfma_f32_16x16x32_bf16 v[176:179], v[36:39], a[56:59], v[176:179]
    v_mfma_f32_16x16x32_bf16 v[184:187], v[36:39], a[120:123], v[184:187]
    s_add_u32 s91, s7, 131072
    buffer_load_dwordx4 v[20:23], v106, s[60:63], s91 offen offset:0 sc1
    v_mfma_f32_16x16x32_bf16 v[192:195], v[36:39], a[184:187], v[192:195]
    v_mfma_f32_16x16x32_bf16 v[200:203], v[36:39], a[248:251], v[200:203]
    v_mfma_f32_16x16x32_bf16 v[180:183], v[40:43], a[56:59], v[180:183]
    s_waitcnt vmcnt(13)
    v_max3_u32 v104, v52, v53, v54
    v_mfma_f32_16x16x32_bf16 v[188:191], v[40:43], a[120:123], v[188:191]
    s_waitcnt vmcnt(12)
    buffer_load_dwordx4 v[24:27], v106, s[60:63], s91 offen offset:1024 sc1
    v_max3_u32 v104, v104, v55, v56
    v_mfma_f32_16x16x32_bf16 v[196:199], v[40:43], a[184:187], v[196:199]
    v_max3_u32 v104, v104, v57, v58
    v_mfma_f32_16x16x32_bf16 v[204:207], v[40:43], a[248:251], v[204:207]
    s_waitcnt vmcnt(12)
    v_max3_u32 v104, v104, v59, v60
    v_mfma_f32_16x16x32_bf16 v[176:179], v[44:47], a[60:63], v[176:179]
    v_max3_u32 v104, v104, v61, v62
    v_mfma_f32_16x16x32_bf16 v[184:187], v[44:47], a[124:127], v[184:187]
    s_waitcnt vmcnt(11)
    buffer_load_dwordx4 v[28:31], v106, s[60:63], s91 offen offset:2048 sc1
    v_max3_u32 v104, v104, v63, v64
    v_mfma_f32_16x16x32_bf16 v[192:195], v[44:47], a[188:191], v[192:195]
    v_max3_u32 v104, v104, v65, v66
    v_mfma_f32_16x16x32_bf16 v[200:203], v[44:47], a[252:255], v[200:203]
    v_max_u32 v104, v104, v67
    v_mfma_f32_16x16x32_bf16 v[180:183], v[48:51], a[60:63], v[180:183]
    v_mfma_f32_16x16x32_bf16 v[188:191], v[48:51], a[124:127], v[188:191]
    buffer_load_dwordx4 v[32:35], v106, s[60:63], s91 offen offset:3072 sc1
    v_cmp_eq_u32 vcc, -1, v104
    v_mfma_f32_16x16x32_bf16 v[196:199], v[48:51], a[188:191], v[196:199]
    v_mfma_f32_16x16x32_bf16 v[204:207], v[48:51], a[252:255], v[204:207]
    s_cbranch_vccnz L_stub_z8
L_ok_z8:
    v_mfma_f32_16x16x32_bf16 v[208:211], v[52:55], a[0:3], 0
    v_mfma_f32_16x16x32_bf16 v[216:219], v[52:55], a[64:67], 0
    s_add_u32 s91, s8, 131072
    buffer_load_dwordx4 v[36:39], v106, s[60:63], s91 offen offset:0 sc1
    v_mfma_f32_16x16x32_bf16 v[224:227], v[52:55], a[128:131], 0
    v_mfma_f32_16x16x32_bf16 v[232:235], v[52:55], a[192:195], 0
    v_mfma_f32_16x16x32_bf16 v[212:215], v[56:59], a[0:3], 0
    s_waitcnt vmcnt(13)
    v_max3_u32 v104, v68, v69, v70
    v_mfma_f32_16x16x32_bf16 v[220:223], v[56:59], a[64:67], 0
    s_waitcnt vmcnt(12)
    buffer_load_dwordx4 v[40:43], v106, s[60:63], s91 offen offset:1024 sc1
    v_max3_u32 v104, v104, v71, v72
    v_mfma_f32_16x16x32_bf16 v[228:231], v[56:59], a[128:131], 0
    v_max3_u32 v104, v104, v73, v74
    v_mfma_f32_16x16x32_bf16 v[236:239], v[56:59], a[192:195], 0
    s_waitcnt vmcnt(12)
    v_max3_u32 v104, v104, v75, v76
    v_mfma_f32_16x16x32_bf16 v[208:211], v[60:63], a[4:7], v[208:211]
    ds_write_b128 v84, v[184:187] offset:0
    v_max3_u32 v104, v104, v77, v78
    v_mfma_f32_16x16x32_bf16 v[216:219], v[60:63], a[68:71], v[216:219]
    s_waitcnt vmcnt(11)
    buffer_load_dwordx4 v[44:47], v106, s[60:63], s91 offen offset:2048 sc1
    v_max3_u32 v104, v104, v79, v80
    v_mfma_f32_16x16x32_bf16 v[224:227], v[60:63], a[132:135], v[224:227]
    v_max3_u32 v104, v104, v81, v82
    v_mfma_f32_16x16x32_bf16 v[232:235], v[60:63], a[196:199], v[232:235]
    ds_write_b128 v84, v[188:191] offset:6144
    v_max_u32 v104, v104, v83
    v_mfma_f32_16x16x32_bf16 v[212:215], v[64:67], a[4:7], v[212:215]
    v_mfma_f32_16x16x32_bf16 v[220:223], v[64:67], a[68:71], v[220:223]
    buffer_load_dwordx4 v[48:51], v106, s[60:63], s91 offen offset:3072 sc1
    v_cmp_eq_u32 vcc, -1, v104
    v_mfma_f32_16x16x32_bf16 v[228:231], v[64:67], a[132:135], v[228:231]
    ds_write_b128 v85, v[192:195] offset:0
    v_mfma_f32_16x16x32_bf16 v[236:239], v[64:67], a[196:199], v[236:239]
    s_cbranch_vccnz L_stub_z9
L_ok_z9:
    v_mfma_f32_16x16x32_bf16 v[208:211], v[68:71], a[8:11], v[208:211]
    v_mfma_f32_16x16x32_bf16 v[216:219], v[68:71], a[72:75], v[216:219]
    ds_write_b128 v85, v[196:199] offset:1024
    s_add_u32 s91, s9, 131072
    buffer_load_dwordx4 v[52:55], v106, s[60:63], s91 offen offset:0 sc1
    v_mfma_f32_16x16x32_bf16 v[224:227], v[68:71], a[136:139], v[224:227]
    v_mfma_f32_16x16x32_bf16 v[232:235], v[68:71], a[200:203], v[232:235]
    v_mfma_f32_16x16x32_bf16 v[212:215], v[72:75], a[8:11], v[212:215]
    s_waitcnt vmcnt(13)
    ds_write_b128 v86, v[200:203] offset:0
    v_max3_u32 v104, v4, v5, v6
    v_mfma_f32_16x16x32_bf16 v[220:223], v[72:75], a[72:75], v[220:223]
    s_waitcnt vmcnt(12)
    buffer_load_dwordx4 v[56:59], v106, s[60:63], s91 offen offset:1024 sc1
    v_max3_u32 v104, v104, v7, v8
    v_mfma_f32_16x16x32_bf16 v[228:231], v[72:75], a[136:139], v[228:231]
    ds_write_b128 v86, v[204:207] offset:1024
    v_max3_u32 v104, v104, v9, v10
    v_mfma_f32_16x16x32_bf16 v[236:239], v[72:75], a[200:203], v[236:239]
    s_waitcnt vmcnt(11)
    v_max3_u32 v104, v104, v11, v12
    v_mfma_f32_16x16x32_bf16 v[208:211], v[76:79], a[12:15], v[208:211]
    v_max3_u32 v104, v104, v13, v14
    v_mfma_f32_16x16x32_bf16 v[216:219], v[76:79], a[76:79], v[216:219]
    s_waitcnt vmcnt(10)
    buffer_load_dwordx4 v[60:63], v106, s[60:63], s91 offen offset:2048 sc1
    v_max3_u32 v104, v104, v15, v16
    v_mfma_f32_16x16x32_bf16 v[224:227], v[76:79], a[140:143], v[224:227]
    s_waitcnt lgkmcnt(0)
    v_max3_u32 v104, v104, v17, v18
    v_mfma_f32_16x16x32_bf16 v[232:235], v[76:79], a[204:207], v[232:235]
    s_barrier
    v_max_u32 v104, v104, v19
    v_mfma_f32_16x16x32_bf16 v[212:215], v[80:83], a[12:15], v[212:215]
    v_mfma_f32_16x16x32_bf16 v[220:223], v[80:83], a[76:79], v[220:223]
    buffer_load_dwordx4 v[64:67], v106, s[60:63], s91 offen offset:3072 sc1
    v_cmp_eq_u32 vcc, -1, v104
    v_mfma_f32_16x16x32_bf16 v[228:231], v[80:83], a[140:143], v[228:231]
    ds_read_b128 v[112:115], v87 offset:5120
    v_mfma_f32_16x16x32_bf16 v[236:239], v[80:83], a[204:207], v[236:239]
    ds_read_b128 v[116:119], v87 offset:11264
    s_cbranch_vccnz L_stub_z10
L_ok_z10:
    v_mfma_f32_16x16x32_bf16 v[208:211], v[4:7], a[16:19], v[208:211]
    ds_read_b128 v[120:123], v88 offset:6144
    v_mfma_f32_16x16x32_bf16 v[216:219], v[4:7], a[80:83], v[216:219]
    ds_read_b128 v[124:127], v88 offset:7168
    v_mfma_f32_16x16x32_bf16 v[224:227], v[4:7], a[144:147], v[224:227]
    s_add_u32 s91, s10, 131072
    buffer_load_dwordx4 v[68:71], v106, s[60:63], s91 offen offset:0 sc1
    v_mfma_f32_16x16x32_bf16 v[232:235], v[4:7], a[208:211], v[232:235]
    ds_read_b128 v[128:131], v88 offset:20480
    v_mfma_f32_16x16x32_bf16 v[212:215], v[8:11], a[16:19], v[212:215]
    s_waitcnt vmcnt(12)
    ds_read_b128 v[132:135], v88 offset:21504
    v_max3_u32 v104, v20, v21, v22
    v_mfma_f32_16x16x32_bf16 v[220:223], v[8:11], a[80:83], v[220:223]
    s_waitcnt vmcnt(11)
    v_max3_u32 v104, v104, v23, v24
    v_mfma_f32_16x16x32_bf16 v[228:231], v[8:11], a[144:147], v[228:231]
    buffer_load_dwordx4 v[72:75], v106, s[60:63], s91 offen offset:1024 sc1
    v_max3_u32 v104, v104, v25, v26
    v_mfma_f32_16x16x32_bf16 v[236:239], v[8:11], a[208:211], v[236:239]
    s_waitcnt vmcnt(11)
    v_max3_u32 v104, v104, v27, v28
    v_mfma_f32_16x16x32_bf16 v[208:211], v[12:15], a[20:23], v[208:211]
    v_max3_u32 v104, v104, v29, v30
    v_mfma_f32_16x16x32_bf16 v[216:219], v[12:15], a[84:87], v[216:219]
    s_waitcnt vmcnt(10)
    v_max3_u32 v104, v104, v31, v32
    v_mfma_f32_16x16x32_bf16 v[224:227], v[12:15], a[148:151], v[224:227]
    s_waitcnt lgkmcnt(0)
    buffer_load_dwordx4 v[76:79], v106, s[60:63], s91 offen offset:2048 sc1
    v_max3_u32 v104, v104, v33, v34
    v_mfma_f32_16x16x32_bf16 v[232:235], v[12:15], a[212:215], v[232:235]
    v_max_u32 v104, v104, v35
    v_add_f32 v176, v176, v100
    v_mfma_f32_16x16x32_bf16 v[212:215], v[16:19], a[20:23], v[212:215]
    v_add_f32 v177, v177, v100
    v_mfma_f32_16x16x32_bf16 v[220:223], v[16:19], a[84:87], v[220:223]
    v_cmp_eq_u32 vcc, -1, v104
    v_add_f32 v178, v178, v100
    v_mfma_f32_16x16x32_bf16 v[228:231], v[16:19], a[148:151], v[228:231]
    buffer_load_dwordx4 v[80:83], v106, s[60:63], s91 offen offset:3072 sc1
    v_add_f32 v179, v179, v100
    v_mfma_f32_16x16x32_bf16 v[236:239], v[16:19], a[212:215], v[236:239]
    s_cbranch_vccnz L_stub_z11
L_ok_z11:
    v_add_f32 v180, v180, v100
    v_mfma_f32_16x16x32_bf16 v[208:211], v[20:23], a[24:27], v[208:211]
    v_add_f32 v181, v181, v100
    v_mfma_f32_16x16x32_bf16 v[216:219], v[20:23], a[88:91], v[216:219]
    v_add_f32 v182, v182, v100
    v_mfma_f32_16x16x32_bf16 v[224:227], v[20:23], a[152:155], v[224:227]
    s_add_u32 s91, s11, 131072
    buffer_load_dwordx4 v[4:7], v106, s[60:63], s91 offen offset:0 sc1
    v_mfma_f32_16x16x32_bf16 v[232:235], v[20:23], a[216:219], v[232:235]
    v_add_f32 v183, v183, v100
    v_add_f32 v176, v176, v112
    v_mfma_f32_16x16x32_bf16 v[212:215], v[24:27], a[24:27], v[212:215]
    s_waitcnt vmcnt(12)
    v_max3_u32 v104, v36, v37, v38
    v_add_f32 v177, v177, v113
    v_mfma_f32_16x16x32_bf16 v[220:223], v[24:27], a[88:91], v[220:223]
    s_waitcnt vmcnt(11)
    v_max3_u32 v104, v104, v39, v40
    v_add_f32 v178, v178, v114
    v_mfma_f32_16x16x32_bf16 v[228:231], v[24:27], a[152:155], v[228:231]
    buffer_load_dwordx4 v[8:11], v106, s[60:63], s91 offen offset:1024 sc1
    v_max3_u32 v104, v104, v41, v42
    v_mfma_f32_16x16x32_bf16 v[236:239], v[24:27], a[216:219], v[236:239]
    s_waitcnt vmcnt(11)
    v_add_f32 v179, v179, v115
    v_max3_u32 v104, v104, v43, v44
    v_mfma_f32_16x16x32_bf16 v[208:211], v[28:31], a[28:31], v[208:211]
    v_add_f32 v180, v180, v116
    v_max3_u32 v104, v104, v45, v46
    v_mfma_f32_16x16x32_bf16 v[216:219], v[28:31], a[92:95], v[216:219]
    s_waitcnt vmcnt(10)
    v_add_f32 v181, v181, v117
    v_max3_u32 v104, v104, v47, v48
    v_mfma_f32_16x16x32_bf16 v[224:227], v[28:31], a[156:159], v[224:227]
    buffer_load_dwordx4 v[12:15], v106, s[60:63], s91 offen offset:2048 sc1
    v_max3_u32 v104, v104, v49, v50
    v_mfma_f32_16x16x32_bf16 v[232:235], v[28:31], a[220:223], v[232:235]
    v_add_f32 v182, v182, v118
    v_max_u32 v104, v104, v51
    v_mfma_f32_16x16x32_bf16 v[212:215], v[32:35], a[28:31], v[212:215]
    v_add_f32 v183, v183, v119
    v_add_f32 v176, v176, v120
    v_mfma_f32_16x16x32_bf16 v[220:223], v[32:35], a[92:95], v[220:223]
    v_cmp_eq_u32 vcc, -1, v104
    v_add_f32 v177, v177, v121
    v_mfma_f32_16x16x32_bf16 v[228:231], v[32:35], a[156:159], v[228:231]
    buffer_load_dwordx4 v[16:19], v106, s[60:63], s91 offen offset:3072 sc1
    v_add_f32 v178, v178, v122
    v_mfma_f32_16x16x32_bf16 v[236:239], v[32:35], a[220:223], v[236:239]
    s_cbranch_vccnz L_stub_z12
L_ok_z12:
    v_add_f32 v179, v179, v123
    v_mfma_f32_16x16x32_bf16 v[208:211], v[36:39], a[32:35], v[208:211]
    v_add_f32 v180, v180, v124
    v_mfma_f32_16x16x32_bf16 v[216:219], v[36:39], a[96:99], v[216:219]
    v_add_f32 v181, v181, v125
    v_mfma_f32_16x16x32_bf16 v[224:227], v[36:39], a[160:163], v[224:227]
    s_add_u32 s91, s4, 262144
    buffer_load_dwordx4 v[20:23], v106, s[60:63], s91 offen offset:0 sc1
    v_mfma_f32_16x16x32_bf16 v[232:235], v[36:39], a[224:227], v[232:235]
    v_add_f32 v182, v182, v126
    v_add_f32 v183, v183, v127
    v_mfma_f32_16x16x32_bf16 v[212:215], v[40:43], a[32:35], v[212:215]
    s_waitcnt vmcnt(12)
    v_max3_u32 v104, v52, v53, v54
    v_add_f32 v176, v176, v128
    v_mfma_f32_16x16x32_bf16 v[220:223], v[40:43], a[96:99], v[220:223]
    s_waitcnt vmcnt(11)
    v_max3_u32 v104, v104, v55, v56
    v_add_f32 v177, v177, v129
    v_mfma_f32_16x16x32_bf16 v[228:231], v[40:43], a[160:163], v[228:231]
    buffer_load_dwordx4 v[24:27], v106, s[60:63], s91 offen offset:1024 sc1
    v_max3_u32 v104, v104, v57, v58
    v_mfma_f32_16x16x32_bf16 v[236:239], v[40:43], a[224:227], v[236:239]
    s_waitcnt vmcnt(11)
    v_add_f32 v178, v178, v130
    v_max3_u32 v104, v104, v59, v60
    v_mfma_f32_16x16x32_bf16 v[208:211], v[44:47], a[36:39], v[208:211]
    v_add_f32 v179, v179, v131
    v_max3_u32 v104, v104, v61, v62
    v_mfma_f32_16x16x32_bf16 v[216:219], v[44:47], a[100:103], v[216:219]
    s_waitcnt vmcnt(10)
    v_add_f32 v180, v180, v132
    v_max3_u32 v104, v104, v63, v64
    v_mfma_f32_16x16x32_bf16 v[224:227], v[44:47], a[164:167], v[224:227]
    buffer_load_dwordx4 v[28:31], v106, s[60:63], s91 offen offset:2048 sc1
    v_max3_u32 v104, v104, v65, v66
    v_mfma_f32_16x16x32_bf16 v[232:235], v[44:47], a[228:231], v[232:235]
    v_add_f32 v181, v181, v133
    v_max_u32 v104, v104, v67
    v_mfma_f32_16x16x32_bf16 v[212:215], v[48:51], a[36:39], v[212:215]
    v_add_f32 v182, v182, v134
    v_add_f32 v183, v183, v135
    v_mfma_f32_16x16x32_bf16 v[220:223], v[48:51], a[100:103], v[220:223]
    v_cmp_eq_u32 vcc, -1, v104
    v_mul_f32 v176, v176, v148
    v_mfma_f32_16x16x32_bf16 v[228:231], v[48:51], a[164:167], v[228:231]
    buffer_load_dwordx4 v[32:35], v106, s[60:63], s91 offen offset:3072 sc1
    v_mul_f32 v177, v177, v149
    v_mfma_f32_16x16x32_bf16 v[236:239], v[48:51], a[228:231], v[236:239]
    s_cbranch_vccnz L_stub_z13
L_ok_z13:
    v_mul_f32 v178, v178, v150
    v_mfma_f32_16x16x32_bf16 v[208:211], v[52:55], a[40:43], v[208:211]
    v_mul_f32 v179, v179, v151
    v_mfma_f32_16x16x32_bf16 v[216:219], v[52:55], a[104:107], v[216:219]
    v_mul_f32 v180, v180, v152
    v_mfma_f32_16x16x32_bf16 v[224:227], v[52:55], a[168:171], v[224:227]
    s_add_u32 s91, s5, 262144
    buffer_load_dwordx4 v[36:39], v106, s[60:63], s91 offen offset:0 sc1
    v_mfma_f32_16x16x32_bf16 v[232:235], v[52:55], a[232:235], v[232:235]
    v_mul_f32 v181, v181, v153
    v_mul_f32 v182, v182, v154
    v_mfma_f32_16x16x32_bf16 v[212:215], v[56:59], a[40:43], v[212:215]
    s_waitcnt vmcnt(12)
    v_max3_u32 v104, v68, v69, v70
    v_mul_f32 v183, v183, v155
    v_mfma_f32_16x16x32_bf16 v[220:223], v[56:59], a[104:107], v[220:223]
    s_waitcnt vmcnt(11)
    v_max3_u32 v104, v104, v71, v72
    v_cvt_pk_bf16_f32 v136, v176, v177
    v_mfma_f32_16x16x32_bf16 v[228:231], v[56:59], a[168:171], v[228:231]
    buffer_load_dwordx4 v[40:43], v106, s[60:63], s91 offen offset:1024 sc1
    v_max3_u32 v104, v104, v73, v74
    v_mfma_f32_16x16x32_bf16 v[236:239], v[56:59], a[232:235], v[236:239]
    s_waitcnt vmcnt(11)
    v_cvt_pk_bf16_f32 v137, v178, v179
    v_max3_u32 v104, v104, v75, v76
    v_mfma_f32_16x16x32_bf16 v[208:211], v[60:63], a[44:47], v[208:211]
    v_cvt_pk_bf16_f32 v138, v180, v181
    v_max3_u32 v104, v104, v77, v78
    v_mfma_f32_16x16x32_bf16 v[216:219], v[60:63], a[108:111], v[216:219]
    s_waitcnt vmcnt(10)
    v_cvt_pk_bf16_f32 v139, v182, v183
    v_max3_u32 v104, v104, v79, v80
    v_mfma_f32_16x16x32_bf16 v[224:227], v[60:63], a[172:175], v[224:227]
    buffer_load_dwordx4 v[44:47], v106, s[60:63], s91 offen offset:2048 sc1
    v_max3_u32 v104, v104, v81, v82
    v_mfma_f32_16x16x32_bf16 v[232:235], v[60:63], a[236:239], v[232:235]
    v_max_u32 v104, v104, v83
    v_mfma_f32_16x16x32_bf16 v[212:215], v[64:67], a[44:47], v[212:215]
    v_mfma_f32_16x16x32_bf16 v[220:223], v[64:67], a[108:111], v[220:223]
    v_cmp_eq_u32 vcc, -1, v104
    v_mfma_f32_16x16x32_bf16 v[228:231], v[64:67], a[172:175], v[228:231]
    buffer_load_dwordx4 v[48:51], v106, s[60:63], s91 offen offset:3072 sc1
    v_mfma_f32_16x16x32_bf16 v[236:239], v[64:67], a[236:239], v[236:239]
    s_cbranch_vccnz L_stub_z14
L_ok_z14:
    v_mfma_f32_16x16x32_bf16 v[208:211], v[68:71], a[48:51], v[208:211]
    s_barrier
    v_xor_b32 v110, v108, v2
    v_mfma_f32_16x16x32_bf16 v[216:219], v[68:71], a[112:115], v[216:219]
    v_cmp_ne_u32 vcc, 0, v110
    v_mfma_f32_16x16x32_bf16 v[224:227], v[68:71], a[176:179], v[224:227]
    s_add_u32 s91, s6, 262144
    buffer_load_dwordx4 v[52:55], v106, s[60:63], s91 offen offset:0 sc1
    v_mfma_f32_16x16x32_bf16 v[232:235], v[68:71], a[240:243], v[232:235]
    s_cbranch_vccnz L_stub_pf
L_ok_pf:
    v_mfma_f32_16x16x32_bf16 v[212:215], v[72:75], a[48:51], v[212:215]
    s_waitcnt vmcnt(12)
    v_max3_u32 v104, v4, v5, v6
    v_mfma_f32_16x16x32_bf16 v[220:223], v[72:75], a[112:115], v[220:223]
    s_waitcnt vmcnt(11)
    v_max3_u32 v104, v104, v7, v8
    v_mfma_f32_16x16x32_bf16 v[228:231], v[72:75], a[176:179], v[228:231]
    buffer_load_dwordx4 v[56:59], v106, s[60:63], s91 offen offset:1024 sc1
    v_max3_u32 v104, v104, v9, v10
    v_mfma_f32_16x16x32_bf16 v[236:239], v[72:75], a[240:243], v[236:239]
    s_waitcnt vmcnt(11)
    v_max3_u32 v104, v104, v11, v12
    v_mfma_f32_16x16x32_bf16 v[208:211], v[76:79], a[52:55], v[208:211]
    v_max3_u32 v104, v104, v13, v14
    v_mfma_f32_16x16x32_bf16 v[216:219], v[76:79], a[116:119], v[216:219]
    s_waitcnt vmcnt(10)
    v_max3_u32 v104, v104, v15, v16
    v_mfma_f32_16x16x32_bf16 v[224:227], v[76:79], a[180:183], v[224:227]
    buffer_load_dwordx4 v[60:63], v106, s[60:63], s91 offen offset:2048 sc1
    v_max3_u32 v104, v104, v17, v18
    v_mfma_f32_16x16x32_bf16 v[232:235], v[76:79], a[244:247], v[232:235]
    v_max_u32 v104, v104, v19
    v_mfma_f32_16x16x32_bf16 v[212:215], v[80:83], a[52:55], v[212:215]
    v_mfma_f32_16x16x32_bf16 v[220:223], v[80:83], a[116:119], v[220:223]
    v_cmp_eq_u32 vcc, -1, v104
    v_mfma_f32_16x16x32_bf16 v[228:231], v[80:83], a[180:183], v[228:231]
    buffer_load_dwordx4 v[64:67], v106, s[60:63], s91 offen offset:3072 sc1
    v_mfma_f32_16x16x32_bf16 v[236:239], v[80:83], a[244:247], v[236:239]
    s_cbranch_vccnz L_stub_z15
L_ok_z15:
    v_mfma_f32_16x16x32_bf16 v[208:211], v[4:7], a[56:59], v[208:211]
    v_mfma_f32_16x16x32_bf16 v[216:219], v[4:7], a[120:123], v[216:219]
    v_mfma_f32_16x16x32_bf16 v[224:227], v[4:7], a[184:187], v[224:227]
    s_add_u32 s91, s7, 262144
    buffer_load_dwordx4 v[68:71], v106, s[60:63], s91 offen offset:0 sc1
    v_mfma_f32_16x16x32_bf16 v[232:235], v[4:7], a[248:251], v[232:235]
    v_mfma_f32_16x16x32_bf16 v[212:215], v[8:11], a[56:59], v[212:215]
    s_waitcnt vmcnt(12)
    v_max3_u32 v104, v20, v21, v22
    v_mfma_f32_16x16x32_bf16 v[220:223], v[8:11], a[120:123], v[220:223]
    s_waitcnt vmcnt(11)
    v_max3_u32 v104, v104, v23, v24
    v_mfma_f32_16x16x32_bf16 v[228:231], v[8:11], a[184:187], v[228:231]
    buffer_load_dwordx4 v[72:75], v106, s[60:63], s91 offen offset:1024 sc1
    v_max3_u32 v104, v104, v25, v26
    v_mfma_f32_16x16x32_bf16 v[236:239], v[8:11], a[248:251], v[236:239]
    s_waitcnt vmcnt(11)
    v_max3_u32 v104, v104, v27, v28
    v_mfma_f32_16x16x32_bf16 v[208:211], v[12:15], a[60:63], v[208:211]
    v_max3_u32 v104, v104, v29, v30
    v_mfma_f32_16x16x32_bf16 v[216:219], v[12:15], a[124:127], v[216:219]
    s_waitcnt vmcnt(10)
    v_max3_u32 v104, v104, v31, v32
    v_mfma_f32_16x16x32_bf16 v[224:227], v[12:15], a[188:191], v[224:227]
    buffer_load_dwordx4 v[76:79], v106, s[60:63], s91 offen offset:2048 sc1
    v_max3_u32 v104, v104, v33, v34
    v_mfma_f32_16x16x32_bf16 v[232:235], v[12:15], a[252:255], v[232:235]
    v_max_u32 v104, v104, v35
    v_mfma_f32_16x16x32_bf16 v[212:215], v[16:19], a[60:63], v[212:215]
    v_mfma_f32_16x16x32_bf16 v[220:223], v[16:19], a[124:127], v[220:223]
    v_cmp_eq_u32 vcc, -1, v104
    v_mfma_f32_16x16x32_bf16 v[228:231], v[16:19], a[188:191], v[228:231]
    buffer_store_dwordx4 v[136:139], v106, s[60:63], s14 offen sc1
    buffer_load_dwordx4 v[80:83], v106, s[60:63], s91 offen offset:3072 sc1
    v_mfma_f32_16x16x32_bf16 v[236:239], v[16:19], a[252:255], v[236:239]
    s_cbranch_vccnz L_stub_z16
L_ok_z16:
    v_mfma_f32_16x16x32_bf16 v[176:179], v[20:23], a[0:3], 0
    v_mfma_f32_16x16x32_bf16 v[184:187], v[20:23], a[64:67], 0
    v_mfma_f32_16x16x32_bf16 v[192:195], v[20:23], a[128:131], 0
    s_add_u32 s91, s8, 262144
    buffer_load_dwordx4 v[4:7], v106, s[60:63], s91 offen offset:0 sc1
    v_mfma_f32_16x16x32_bf16 v[200:203], v[20:23], a[192:195], 0
    v_mfma_f32_16x16x32_bf16 v[180:183], v[24:27], a[0:3], 0
    s_waitcnt vmcnt(13)
    v_max3_u32 v104, v36, v37, v38
    v_mfma_f32_16x16x32_bf16 v[188:191], v[24:27], a[64:67], 0
    s_waitcnt vmcnt(12)
    v_max3_u32 v104, v104, v39, v40
    v_mfma_f32_16x16x32_bf16 v[196:199], v[24:27], a[128:131], 0
    buffer_load_dwordx4 v[8:11], v106, s[60:63], s91 offen offset:1024 sc1
    v_max3_u32 v104, v104, v41, v42
    v_mfma_f32_16x16x32_bf16 v[204:207], v[24:27], a[192:195], 0
    s_waitcnt vmcnt(12)
    v_max3_u32 v104, v104, v43, v44
    v_mfma_f32_16x16x32_bf16 v[176:179], v[28:31], a[4:7], v[176:179]
    ds_write_b128 v84, v[216:219] offset:0
    v_max3_u32 v104, v104, v45, v46
    v_mfma_f32_16x16x32_bf16 v[184:187], v[28:31], a[68:71], v[184:187]
    s_waitcnt vmcnt(11)
    v_max3_u32 v104, v104, v47, v48
    v_mfma_f32_16x16x32_bf16 v[192:195], v[28:31], a[132:135], v[192:195]
    buffer_load_dwordx4 v[12:15], v106, s[60:63], s91 offen offset:2048 sc1
    v_max3_u32 v104, v104, v49, v50
    v_mfma_f32_16x16x32_bf16 v[200:203], v[28:31], a[196:199], v[200:203]
    ds_write_b128 v84, v[220:223] offset:6144
    v_max_u32 v104, v104, v51
    v_mfma_f32_16x16x32_bf16 v[180:183], v[32:35], a[4:7], v[180:183]
    v_mfma_f32_16x16x32_bf16 v[188:191], v[32:35], a[68:71], v[188:191]
    v_cmp_eq_u32 vcc, -1, v104
    v_mfma_f32_16x16x32_bf16 v[196:199], v[32:35], a[132:135], v[196:199]
    ds_write_b128 v85, v[224:227] offset:0
    buffer_load_dwordx4 v[16:19], v106, s[60:63], s91 offen offset:3072 sc1
    v_mfma_f32_16x16x32_bf16 v[204:207], v[32:35], a[196:199], v[204:207]
    s_cbranch_vccnz L_stub_z17
L_ok_z17:
    v_mfma_f32_16x16x32_bf16 v[176:179], v[36:39], a[8:11], v[176:179]
    v_mfma_f32_16x16x32_bf16 v[184:187], v[36:39], a[72:75], v[184:187]
    ds_write_b128 v85, v[228:231] offset:1024
    v_mfma_f32_16x16x32_bf16 v[192:195], v[36:39], a[136:139], v[192:195]
    s_add_u32 s91, s9, 262144
    buffer_load_dwordx4 v[20:23], v106, s[60:63], s91 offen offset:0 sc1
    v_mfma_f32_16x16x32_bf16 v[200:203], v[36:39], a[200:203], v[200:203]
    v_mfma_f32_16x16x32_bf16 v[180:183], v[40:43], a[8:11], v[180:183]
    s_waitcnt vmcnt(13)
    ds_write_b128 v86, v[232:235] offset:0
    v_max3_u32 v104, v52, v53, v54
    v_mfma_f32_16x16x32_bf16 v[188:191], v[40:43], a[72:75], v[188:191]
    s_waitcnt vmcnt(12)
    v_max3_u32 v104, v104, v55, v56
    v_mfma_f32_16x16x32_bf16 v[196:199], v[40:43], a[136:139], v[196:199]
    ds_write_b128 v86, v[236:239] offset:1024
    buffer_load_dwordx4 v[24:27], v106, s[60:63], s91 offen offset:1024 sc1
    v_max3_u32 v104, v104, v57, v58
    v_mfma_f32_16x16x32_bf16 v[204:207], v[40:43], a[200:203], v[204:207]
    s_waitcnt vmcnt(12)
    v_max3_u32 v104, v104, v59, v60
    v_mfma_f32_16x16x32_bf16 v[176:179], v[44:47], a[12:15], v[176:179]
    v_max3_u32 v104, v104, v61, v62
    v_mfma_f32_16x16x32_bf16 v[184:187], v[44:47], a[76:79], v[184:187]
    s_waitcnt vmcnt(11)
    v_max3_u32 v104, v104, v63, v64
    v_mfma_f32_16x16x32_bf16 v[192:195], v[44:47], a[140:143], v[192:195]
    s_waitcnt lgkmcnt(0)
    buffer_load_dwordx4 v[28:31], v106, s[60:63], s91 offen offset:2048 sc1
    v_max3_u32 v104, v104, v65, v66
    v_mfma_f32_16x16x32_bf16 v[200:203], v[44:47], a[204:207], v[200:203]
    s_barrier
    v_max_u32 v104, v104, v67
    v_mfma_f32_16x16x32_bf16 v[180:183], v[48:51], a[12:15], v[180:183]
    v_mfma_f32_16x16x32_bf16 v[188:191], v[48:51], a[76:79], v[188:191]
    ds_read_b128 v[112:115], v87 offset:5120
    v_cmp_eq_u32 vcc, -1, v104
    v_mfma_f32_16x16x32_bf16 v[196:199], v[48:51], a[140:143], v[196:199]
    buffer_load_dwordx4 v[32:35], v106, s[60:63], s91 offen offset:3072 sc1
    v_mfma_f32_16x16x32_bf16 v[204:207], v[48:51], a[204:207], v[204:207]
    ds_read_b128 v[116:119], v87 offset:11264
    s_cbranch_vccnz L_stub_z18
L_ok_z18:
    v_mfma_f32_16x16x32_bf16 v[176:179], v[52:55], a[16:19], v[176:179]
    ds_read_b128 v[120:123], v88 offset:6144
    v_mfma_f32_16x16x32_bf16 v[184:187], v[52:55], a[80:83], v[184:187]
    ds_read_b128 v[124:127], v88 offset:7168
    v_mfma_f32_16x16x32_bf16 v[192:195], v[52:55], a[144:147], v[192:195]
    s_add_u32 s91, s10, 262144
    buffer_load_dwordx4 v[36:39], v106, s[60:63], s91 offen offset:0 sc1
    v_mfma_f32_16x16x32_bf16 v[200:203], v[52:55], a[208:211], v[200:203]
    ds_read_b128 v[128:131], v88 offset:20480
    v_mfma_f32_16x16x32_bf16 v[180:183], v[56:59], a[16:19], v[180:183]
    s_waitcnt vmcnt(13)
    ds_read_b128 v[132:135], v88 offset:21504
    v_max3_u32 v104, v68, v69, v70
    v_mfma_f32_16x16x32_bf16 v[188:191], v[56:59], a[80:83], v[188:191]
    s_waitcnt vmcnt(12)
    v_max3_u32 v104, v104, v71, v72
    v_mfma_f32_16x16x32_bf16 v[196:199], v[56:59], a[144:147], v[196:199]
    buffer_load_dwordx4 v[40:43], v106, s[60:63], s91 offen offset:1024 sc1
    v_max3_u32 v104, v104, v73, v74
    v_mfma_f32_16x16x32_bf16 v[204:207], v[56:59], a[208:211], v[204:207]
    s_waitcnt vmcnt(12)
    v_max3_u32 v104, v104, v75, v76
    v_mfma_f32_16x16x32_bf16 v[176:179], v[60:63], a[20:23], v[176:179]
    v_max3_u32 v104, v104, v77, v78
    v_mfma_f32_16x16x32_bf16 v[184:187], v[60:63], a[84:87], v[184:187]
    s_waitcnt vmcnt(10)
    v_max3_u32 v104, v104, v79, v80
    v_mfma_f32_16x16x32_bf16 v[192:195], v[60:63], a[148:151], v[192:195]
    s_waitcnt lgkmcnt(0)
    buffer_load_dwordx4 v[44:47], v106, s[60:63], s91 offen offset:2048 sc1
    v_max3_u32 v104, v104, v81, v82
    v_mfma_f32_16x16x32_bf16 v[200:203], v[60:63], a[212:215], v[200:203]
    v_add_f32 v208, v208, v100
    v_max_u32 v104, v104, v83
    v_mfma_f32_16x16x32_bf16 v[180:183], v[64:67], a[20:23], v[180:183]
    v_add_f32 v209, v209, v100
    v_add_f32 v210, v210, v100
    v_mfma_f32_16x16x32_bf16 v[188:191], v[64:67], a[84:87], v[188:191]
    v_add_f32 v211, v211, v100
    v_cmp_eq_u32 vcc, -1, v104
    v_mfma_f32_16x16x32_bf16 v[196:199], v[64:67], a[148:151], v[196:199]
    buffer_load_dwordx4 v[48:51], v106, s[60:63], s91 offen offset:3072 sc1
    v_add_f32 v212, v212, v100
    v_mfma_f32_16x16x32_bf16 v[204:207], v[64:67], a[212:215], v[204:207]
    s_cbranch_vccnz L_stub_z19
L_ok_z19:
    v_add_f32 v213, v213, v100
    v_add_f32 v214, v214, v100
    v_mfma_f32_16x16x32_bf16 v[176:179], v[68:71], a[24:27], v[176:179]
    v_add_f32 v215, v215, v100
    v_add_f32 v208, v208, v112
    v_mfma_f32_16x16x32_bf16 v[184:187], v[68:71], a[88:91], v[184:187]
    v_add_f32 v209, v209, v113
    v_add_f32 v210, v210, v114
    v_mfma_f32_16x16x32_bf16 v[192:195], v[68:71], a[152:155], v[192:195]
    s_add_u32 s91, s11, 262144
    buffer_load_dwordx4 v[52:55], v106, s[60:63], s91 offen offset:0 sc1
    v_mfma_f32_16x16x32_bf16 v[200:203], v[68:71], a[216:219], v[200:203]
    v_add_f32 v211, v211, v115
    v_add_f32 v212, v212, v116
    v_mfma_f32_16x16x32_bf16 v[180:183], v[72:75], a[24:27], v[180:183]
    s_waitcnt vmcnt(12)
    v_add_f32 v213, v213, v117
    v_max3_u32 v104, v4, v5, v6
    v_mfma_f32_16x16x32_bf16 v[188:191], v[72:75], a[88:91], v[188:191]
    s_waitcnt vmcnt(11)
    v_add_f32 v214, v214, v118
    v_max3_u32 v104, v104, v7, v8
    v_mfma_f32_16x16x32_bf16 v[196:199], v[72:75], a[152:155], v[196:199]
    buffer_load_dwordx4 v[56:59], v106, s[60:63], s91 offen offset:1024 sc1
    v_add_f32 v215, v215, v119
    v_max3_u32 v104, v104, v9, v10
    v_mfma_f32_16x16x32_bf16 v[204:207], v[72:75], a[216:219], v[204:207]
    s_waitcnt vmcnt(11)
    v_add_f32 v208, v208, v120
    v_add_f32 v209, v209, v121
    v_max3_u32 v104, v104, v11, v12
    v_mfma_f32_16x16x32_bf16 v[176:179], v[76:79], a[28:31], v[176:179]
    v_add_f32 v210, v210, v122
    v_max3_u32 v104, v104, v13, v14
    v_mfma_f32_16x16x32_bf16 v[184:187], v[76:79], a[92:95], v[184:187]
    s_waitcnt vmcnt(10)
    v_add_f32 v211, v211, v123
    v_add_f32 v212, v212, v124
    v_max3_u32 v104, v104, v15, v16
    v_mfma_f32_16x16x32_bf16 v[192:195], v[76:79], a[156:159], v[192:195]
    buffer_load_dwordx4 v[60:63], v106, s[60:63], s91 offen offset:2048 sc1
    v_add_f32 v213, v213, v125
    v_max3_u32 v104, v104, v17, v18
    v_mfma_f32_16x16x32_bf16 v[200:203], v[76:79], a[220:223], v[200:203]
    v_add_f32 v214, v214, v126
    v_max_u32 v104, v104, v19
    v_mfma_f32_16x16x32_bf16 v[180:183], v[80:83], a[28:31], v[180:183]
    v_add_f32 v215, v215, v127
    v_add_f32 v208, v208, v128
    v_mfma_f32_16x16x32_bf16 v[188:191], v[80:83], a[92:95], v[188:191]
    v_add_f32 v209, v209, v129
    v_cmp_eq_u32 vcc, -1, v104
    v_mfma_f32_16x16x32_bf16 v[196:199], v[80:83], a[156:159], v[196:199]
    buffer_load_dwordx4 v[64:67], v106, s[60:63], s91 offen offset:3072 sc1
    v_add_f32 v210, v210, v130
    v_mfma_f32_16x16x32_bf16 v[204:207], v[80:83], a[220:223], v[204:207]
    s_cbranch_vccnz L_stub_z20
L_ok_z20:
    v_add_f32 v211, v211, v131
    v_add_f32 v212, v212, v132
    v_mfma_f32_16x16x32_bf16 v[176:179], v[4:7], a[32:35], v[176:179]
    v_add_f32 v213, v213, v133
    v_add_f32 v214, v214, v134
    v_mfma_f32_16x16x32_bf16 v[184:187], v[4:7], a[96:99], v[184:187]
    s_add_u32 m0, s95, 8192
    v_add_f32 v215, v215, v135
    v_mul_f32 v208, v208, v156
    v_mfma_f32_16x16x32_bf16 v[192:195], v[4:7], a[160:163], v[192:195]
    v_mul_f32 v209, v209, v157
    v_mul_f32 v210, v210, v158
    v_mfma_f32_16x16x32_bf16 v[200:203], v[4:7], a[224:227], v[200:203]
    v_mul_f32 v211, v211, v159
    v_mfma_f32_16x16x32_bf16 v[180:183], v[8:11], a[32:35], v[180:183]
    s_waitcnt vmcnt(11)
    s_add_u32 s78, s15, 10240
    v_max3_u32 v104, v20, v21, v22
    v_mul_f32 v212, v212, v160
    v_mfma_f32_16x16x32_bf16 v[188:191], v[8:11], a[96:99], v[188:191]
    s_waitcnt vmcnt(10)
    v_max3_u32 v104, v104, v23, v24
    v_mul_f32 v213, v213, v161
    v_mfma_f32_16x16x32_bf16 v[196:199], v[8:11], a[160:163], v[196:199]
    v_mul_f32 v214, v214, v162
    v_max3_u32 v104, v104, v25, v26
    v_mfma_f32_16x16x32_bf16 v[204:207], v[8:11], a[224:227], v[204:207]
    s_waitcnt vmcnt(9)
    buffer_load_dwordx4 v106, s[60:63], s78 offen offset:0 sc1 lds
    v_mul_f32 v215, v215, v163
    v_max3_u32 v104, v104, v27, v28
    v_mfma_f32_16x16x32_bf16 v[176:179], v[12:15], a[36:39], v[176:179]
    v_cvt_pk_bf16_f32 v140, v208, v209
    v_cvt_pk_bf16_f32 v141, v210, v211
    v_max3_u32 v104, v104, v29, v30
    v_mfma_f32_16x16x32_bf16 v[184:187], v[12:15], a[100:103], v[184:187]
    s_waitcnt vmcnt(9)
    v_cvt_pk_bf16_f32 v142, v212, v213
    v_max3_u32 v104, v104, v31, v32
    v_mfma_f32_16x16x32_bf16 v[192:195], v[12:15], a[164:167], v[192:195]
    v_cvt_pk_bf16_f32 v143, v214, v215
    v_max3_u32 v104, v104, v33, v34
    v_mfma_f32_16x16x32_bf16 v[200:203], v[12:15], a[228:231], v[200:203]
    buffer_load_dwordx4 v106, s[60:63], s78 offen offset:1024 sc1 lds
    v_max_u32 v104, v104, v35
    v_mfma_f32_16x16x32_bf16 v[180:183], v[16:19], a[36:39], v[180:183]
    v_mfma_f32_16x16x32_bf16 v[188:191], v[16:19], a[100:103], v[188:191]
    v_cmp_eq_u32 vcc, -1, v104
    v_mfma_f32_16x16x32_bf16 v[196:199], v[16:19], a[164:167], v[196:199]
    buffer_load_dwordx4 v106, s[60:63], s78 offen offset:2048 sc1 lds
    v_lshlrev_b32 v208, 16, v240
    v_mfma_f32_16x16x32_bf16 v[204:207], v[16:19], a[228:231], v[204:207]
    s_cbranch_vccnz L_stub_z21
L_ok_z21:
    v_and_b32 v209, 0xffff0000, v240
    v_mfma_f32_16x16x32_bf16 v[176:179], v[20:23], a[40:43], v[176:179]
    buffer_store_dwordx4 v[140:143], v106, s[60:63], s16 offen sc1
    v_mfma_f32_16x16x32_bf16 v[184:187], v[20:23], a[104:107], v[184:187]
    v_lshlrev_b32 v210, 16, v241
    v_mfma_f32_16x16x32_bf16 v[192:195], v[20:23], a[168:171], v[192:195]
    buffer_load_dwordx4 v106, s[60:63], s78 offen offset:3072 sc1 lds
    v_mfma_f32_16x16x32_bf16 v[200:203], v[20:23], a[232:235], v[200:203]
    v_and_b32 v211, 0xffff0000, v241
    v_mfma_f32_16x16x32_bf16 v[180:183], v[24:27], a[40:43], v[180:183]
    s_waitcnt vmcnt(12)
    v_max3_u32 v104, v36, v37, v38
    v_mfma_f32_16x16x32_bf16 v[188:191], v[24:27], a[104:107], v[188:191]
    s_waitcnt vmcnt(11)
    s_add_u32 m0, s95, 12288
    v_max3_u32 v104, v104, v39, v40
    v_lshlrev_b32 v212, 16, v242
    v_mfma_f32_16x16x32_bf16 v[196:199], v[24:27], a[168:171], v[196:199]
    v_max3_u32 v104, v104, v41, v42
    v_mfma_f32_16x16x32_bf16 v[204:207], v[24:27], a[232:235], v[204:207]
    s_waitcnt vmcnt(10)
    v_max3_u32 v104, v104, v43, v44
    v_and_b32 v213, 0xffff0000, v242
    v_mfma_f32_16x16x32_bf16 v[176:179], v[28:31], a[44:47], v[176:179]
    v_max3_u32 v104, v104, v45, v46
    v_lshlrev_b32 v214, 16, v243
    v_mfma_f32_16x16x32_bf16 v[184:187], v[28:31], a[108:111], v[184:187]
    s_waitcnt vmcnt(9)
    s_add_u32 s78, s15, 14336
    v_max3_u32 v104, v104, v47, v48
    v_mfma_f32_16x16x32_bf16 v[192:195], v[28:31], a[172:175], v[192:195]
    v_max3_u32 v104, v104, v49, v50
    v_and_b32 v215, 0xffff0000, v243
    v_mfma_f32_16x16x32_bf16 v[200:203], v[28:31], a[236:239], v[200:203]
    v_max_u32 v104, v104, v51
    v_mfma_f32_16x16x32_bf16 v[180:183], v[32:35], a[44:47], v[180:183]
    buffer_load_dwordx4 v106, s[60:63], s78 offen offset:0 sc1 lds
    v_lshlrev_b32 v216, 16, v244
    v_mfma_f32_16x16x32_bf16 v[188:191], v[32:35], a[108:111], v[188:191]
    v_cmp_eq_u32 vcc, -1, v104
    v_mfma_f32_16x16x32_bf16 v[196:199], v[32:35], a[172:175], v[196:199]
    v_and_b32 v217, 0xffff0000, v244
    v_mfma_f32_16x16x32_bf16 v[204:207], v[32:35], a[236:239], v[204:207]
    s_cbranch_vccnz L_stub_z22
L_ok_z22:
    v_mfma_f32_16x16x32_bf16 v[184:187], v[36:39], a[112:115], v[184:187]
    s_barrier
    s_add_u32 s3, s17, 0
    v_lshlrev_b32 v218, 16, v245
    v_mfma_f32_16x16x32_bf16 v[192:195], v[36:39], a[176:179], v[192:195]
    s_waitcnt vmcnt(9)
    v_max3_u32 v104, v52, v53, v54
    v_and_b32 v219, 0xffff0000, v245
    v_mfma_f32_16x16x32_bf16 v[200:203], v[36:39], a[240:243], v[200:203]
    s_waitcnt vmcnt(8)
    v_max3_u32 v104, v104, v55, v56
    v_mfma_f32_16x16x32_bf16 v[188:191], v[40:43], a[112:115], v[188:191]
    buffer_load_dwordx4 v[68:71], v106, s[60:63], s3 offen offset:0 sc1
    v_max3_u32 v104, v104, v57, v58
    v_mfma_f32_16x16x32_bf16 v[196:199], v[40:43], a[176:179], v[196:199]
    s_waitcnt vmcnt(8)
    v_lshlrev_b32 v220, 16, v246
    v_max3_u32 v104, v104, v59, v60
    v_mfma_f32_16x16x32_bf16 v[204:207], v[40:43], a[240:243], v[204:207]
    v_max3_u32 v104, v104, v61, v62
    v_and_b32 v221, 0xffff0000, v246
    v_mfma_f32_16x16x32_bf16 v[184:187], v[44:47], a[116:119], v[184:187]
    s_waitcnt vmcnt(7)
    v_max3_u32 v104, v104, v63, v64
    v_mfma_f32_16x16x32_bf16 v[192:195], v[44:47], a[180:183], v[192:195]
    buffer_load_dwordx4 v[72:75], v106, s[60:63], s3 offen offset:1024 sc1
    v_max3_u32 v104, v104, v65, v66
    v_mfma_f32_16x16x32_bf16 v[200:203], v[44:47], a[244:247], v[200:203]
    v_lshlrev_b32 v222, 16, v247
    v_max_u32 v104, v104, v67
    v_mfma_f32_16x16x32_bf16 v[188:191], v[48:51], a[116:119], v[188:191]
    v_cmp_eq_u32 vcc, -1, v104
    v_and_b32 v223, 0xffff0000, v247
    v_mfma_f32_16x16x32_bf16 v[196:199], v[48:51], a[180:183], v[196:199]
    buffer_load_dwordx4 v[76:79], v106, s[60:63], s3 offen offset:2048 sc1
    v_lshlrev_b32 v224, 16, v248
    v_mfma_f32_16x16x32_bf16 v[204:207], v[48:51], a[244:247], v[204:207]
    s_cbranch_vccnz L_stub_z23
L_ok_z23:
    v_mfma_f32_16x16x32_bf16 v[184:187], v[52:55], a[120:123], v[184:187]
    v_and_b32 v225, 0xffff0000, v248
    v_mfma_f32_16x16x32_bf16 v[184:187], v[60:63], a[124:127], v[184:187]
    v_mfma_f32_16x16x32_bf16 v[188:191], v[56:59], a[120:123], v[188:191]
    buffer_load_dwordx4 v[80:83], v106, s[60:63], s3 offen offset:3072 sc1
    v_lshlrev_b32 v226, 16, v249
    v_mfma_f32_16x16x32_bf16 v[188:191], v[64:67], a[124:127], v[188:191]
    v_mfma_f32_16x16x32_bf16 v[192:195], v[52:55], a[184:187], v[192:195]
    v_and_b32 v227, 0xffff0000, v249
    v_mfma_f32_16x16x32_bf16 v[192:195], v[60:63], a[188:191], v[192:195]
    v_mfma_f32_16x16x32_bf16 v[196:199], v[56:59], a[184:187], v[196:199]
    v_mfma_f32_16x16x32_bf16 v[196:199], v[64:67], a[188:191], v[196:199]
    v_mfma_f32_16x16x32_bf16 v[200:203], v[52:55], a[248:251], v[200:203]
    ds_write_b128 v84, v[184:187] offset:0
    v_mfma_f32_16x16x32_bf16 v[200:203], v[60:63], a[252:255], v[200:203]
    v_mfma_f32_16x16x32_bf16 v[204:207], v[56:59], a[248:251], v[204:207]
    ds_write_b128 v84, v[188:191] offset:6144
    v_mfma_f32_16x16x32_bf16 v[204:207], v[64:67], a[252:255], v[204:207]
    v_mfma_f32_16x16x32_bf16 v[176:179], v[36:39], a[48:51], v[176:179]
    v_mfma_f32_16x16x32_bf16 v[176:179], v[44:47], a[52:55], v[176:179]
    ds_write_b128 v85, v[192:195] offset:0
    v_mfma_f32_16x16x32_bf16 v[176:179], v[52:55], a[56:59], v[176:179]
    v_mfma_f32_16x16x32_bf16 v[176:179], v[60:63], a[60:63], v[176:179]
    ds_write_b128 v85, v[196:199] offset:1024
    v_mfma_f32_16x16x32_bf16 v[180:183], v[40:43], a[48:51], v[180:183]
    v_mfma_f32_16x16x32_bf16 v[180:183], v[48:51], a[52:55], v[180:183]
    ds_write_b128 v86, v[200:203] offset:0
    v_mfma_f32_16x16x32_bf16 v[180:183], v[56:59], a[56:59], v[180:183]
    v_mfma_f32_16x16x32_bf16 v[180:183], v[64:67], a[60:63], v[180:183]
    ds_write_b128 v86, v[204:207] offset:1024
    s_waitcnt lgkmcnt(0)
    s_barrier
    s_nop 0
    ds_read_b128 v[112:115], v87 offset:5120
    ds_read_b128 v[116:119], v87 offset:11264
    ds_read_b128 v[120:123], v88 offset:6144
    ds_read_b128 v[124:127], v88 offset:7168
    ds_read_b128 v[128:131], v88 offset:20480
    ds_read_b128 v[132:135], v88 offset:21504
    ds_read_b128 a[0:3], v251 offset:6144
    s_add_u32 s3, s17, 4096
    ds_read_b128 a[4:7], v251 offset:7168
    buffer_load_dwordx4 v[4:7], v106, s[60:63], s3 offen offset:0 sc1
    ds_read_b128 a[8:11], v251 offset:8192
    ds_read_b128 a[12:15], v251 offset:9216
    buffer_load_dwordx4 v[8:11], v106, s[60:63], s3 offen offset:1024 sc1
    ds_read_b128 a[16:19], v251 offset:10240
    buffer_load_dwordx4 v[12:15], v106, s[60:63], s3 offen offset:2048 sc1
    ds_read_b128 a[20:23], v251 offset:24576
    ds_read_b128 a[24:27], v251 offset:25600
    buffer_load_dwordx4 v[16:19], v106, s[60:63], s3 offen offset:3072 sc1
    ds_read_b128 a[28:31], v251 offset:26624
    v_pk_add_f32 v[176:177], v[176:177], v[100:101] op_sel_hi:[1,0]
    v_pk_add_f32 v[178:179], v[178:179], v[100:101] op_sel_hi:[1,0]
    v_pk_add_f32 v[180:181], v[180:181], v[100:101] op_sel_hi:[1,0]
    v_pk_add_f32 v[182:183], v[182:183], v[100:101] op_sel_hi:[1,0]
    s_waitcnt lgkmcnt(13)
    v_pk_add_f32 v[176:177], v[176:177], v[112:113]
    v_pk_add_f32 v[178:179], v[178:179], v[114:115]
    s_waitcnt lgkmcnt(12)
    v_pk_add_f32 v[180:181], v[180:181], v[116:117]
    v_pk_add_f32 v[182:183], v[182:183], v[118:119]
    s_waitcnt lgkmcnt(11)
    v_pk_add_f32 v[176:177], v[176:177], v[120:121]
    v_pk_add_f32 v[178:179], v[178:179], v[122:123]
    s_waitcnt lgkmcnt(10)
    v_pk_add_f32 v[180:181], v[180:181], v[124:125]
    v_pk_add_f32 v[182:183], v[182:183], v[126:127]
    s_waitcnt lgkmcnt(9)
    v_pk_add_f32 v[176:177], v[176:177], v[128:129]
    v_pk_add_f32 v[178:179], v[178:179], v[130:131]
    s_waitcnt lgkmcnt(8)
    v_pk_add_f32 v[180:181], v[180:181], v[132:133]
    v_pk_add_f32 v[182:183], v[182:183], v[134:135]
    v_pk_mul_f32 v[176:177], v[176:177], v[164:165]
    v_pk_mul_f32 v[178:179], v[178:179], v[166:167]
    v_pk_mul_f32 v[180:181], v[180:181], v[168:169]
    v_pk_mul_f32 v[182:183], v[182:183], v[170:171]
    v_cvt_pk_bf16_f32 v144, v176, v177
    v_cvt_pk_bf16_f32 v145, v178, v179
    v_cvt_pk_bf16_f32 v146, v180, v181
    v_cvt_pk_bf16_f32 v147, v182, v183
    buffer_store_dwordx4 v[144:147], v106, s[60:63], s20 offen sc1
    ds_read_b128 a[32:35], v251 offset:27648
    ds_read_b128 a[36:39], v251 offset:28672
    ds_read_b128 a[40:43], v251 offset:43008
    ds_read_b128 a[44:47], v251 offset:44032
    ds_read_b128 a[48:51], v251 offset:45056
    ds_read_b128 a[52:55], v251 offset:46080
    s_waitcnt vmcnt(5)
    s_nop 0
    v_max3_u32 v110, v68, v69, v70
    v_max3_u32 v110, v110, v71, v72
    v_max3_u32 v110, v110, v73, v74
    v_max3_u32 v110, v110, v75, v76
    v_max3_u32 v110, v110, v77, v78
    v_max3_u32 v110, v110, v79, v80
    v_max3_u32 v110, v110, v81, v82
    v_max_u32 v110, v110, v83
    v_cmp_eq_u32 vcc, -1, v110
    s_cbranch_vccnz L_stub_p0
L_ok_p0:
    s_waitcnt lgkmcnt(11)
    v_mfma_f32_16x16x32_bf16 v[208:211], a[0:3], v[68:71], v[208:211]
    ds_read_b128 a[56:59], v251 offset:47104
    s_add_u32 s91, s17, 8192
    v_mfma_f32_16x16x32_bf16 v[212:215], a[4:7], v[68:71], v[212:215]
    ds_read_b128 a[60:63], v252 offset:4096
    v_mfma_f32_16x16x32_bf16 v[216:219], a[8:11], v[68:71], v[216:219]
    s_waitcnt lgkmcnt(11)
    ds_read_b128 a[64:67], v252 offset:5120
    buffer_load_dwordx4 v[20:23], v106, s[60:63], s91 offen offset:0 sc1
    v_mfma_f32_16x16x32_bf16 v[220:223], a[12:15], v[68:71], v[220:223]
    ds_read_b128 a[68:71], v252 offset:6144
    v_mfma_f32_16x16x32_bf16 v[224:227], a[16:19], v[68:71], v[224:227]
    s_waitcnt lgkmcnt(10)
    ds_read_b128 a[72:75], v252 offset:7168
    v_mfma_f32_16x16x32_bf16 v[208:211], a[20:23], v[72:75], v[208:211]
    ds_read_b128 a[76:79], v252 offset:8192
    buffer_load_dwordx4 v[24:27], v106, s[60:63], s91 offen offset:1024 sc1
    v_mfma_f32_16x16x32_bf16 v[212:215], a[24:27], v[72:75], v[212:215]
    ds_read_b128 a[80:83], v252 offset:30720
    v_mfma_f32_16x16x32_bf16 v[216:219], a[28:31], v[72:75], v[216:219]
    s_waitcnt lgkmcnt(11)
    ds_read_b128 a[84:87], v252 offset:31744
    v_mfma_f32_16x16x32_bf16 v[220:223], a[32:35], v[72:75], v[220:223]
    ds_read_b128 a[88:91], v252 offset:32768
    buffer_load_dwordx4 v[28:31], v106, s[60:63], s91 offen offset:2048 sc1
    v_mfma_f32_16x16x32_bf16 v[224:227], a[36:39], v[72:75], v[224:227]
    s_waitcnt lgkmcnt(10)
    ds_read_b128 a[92:95], v252 offset:33792
    v_mfma_f32_16x16x32_bf16 v[208:211], a[40:43], v[76:79], v[208:211]
    s_waitcnt vmcnt(4)
    ds_read_b128 a[96:99], v252 offset:34816
    v_max3_u32 v110, v4, v5, v6
    v_mfma_f32_16x16x32_bf16 v[212:215], a[44:47], v[76:79], v[212:215]
    ds_read_b128 a[100:103], v252 offset:53248
    buffer_load_dwordx4 v[32:35], v106, s[60:63], s91 offen offset:3072 sc1
    v_max3_u32 v110, v110, v7, v8
    v_mfma_f32_16x16x32_bf16 v[216:219], a[48:51], v[76:79], v[216:219]
    s_waitcnt lgkmcnt(11)
    ds_read_b128 a[104:107], v252 offset:54272
    v_max3_u32 v110, v110, v9, v10
    v_max3_u32 v110, v110, v11, v12
    v_mfma_f32_16x16x32_bf16 v[220:223], a[52:55], v[76:79], v[220:223]
    ds_read_b128 a[108:111], v252 offset:55296
    v_max3_u32 v110, v110, v13, v14
    v_mfma_f32_16x16x32_bf16 v[224:227], a[56:59], v[76:79], v[224:227]
    s_waitcnt lgkmcnt(10)
    ds_read_b128 a[112:115], v252 offset:56320
    s_add_u32 s91, s17, 12288
    v_max3_u32 v110, v110, v15, v16
    v_max3_u32 v110, v110, v17, v18
    v_mfma_f32_16x16x32_bf16 v[208:211], a[60:63], v[80:83], v[208:211]
    ds_read_b128 a[116:119], v253 offset:0
    v_max_u32 v110, v110, v19
    v_mfma_f32_16x16x32_bf16 v[212:215], a[64:67], v[80:83], v[212:215]
    ds_read_b128 a[120:123], v253 offset:18432
    buffer_load_dwordx4 v[36:39], v106, s[60:63], s91 offen offset:0 sc1
    v_cmp_eq_u32 vcc, -1, v110
    v_mfma_f32_16x16x32_bf16 v[216:219], a[68:71], v[80:83], v[216:219]
    s_waitcnt lgkmcnt(11)
    ds_read_b128 a[124:127], v253 offset:19456
    s_add_u32 m0, s71, 0
    v_mfma_f32_16x16x32_bf16 v[220:223], a[72:75], v[80:83], v[220:223]
    ds_read_b128 a[128:131], v253 offset:20480
    v_mfma_f32_16x16x32_bf16 v[224:227], a[76:79], v[80:83], v[224:227]
    s_waitcnt lgkmcnt(10)
    ds_read_b128 a[132:135], v253 offset:21504
    buffer_load_dwordx4 v[40:43], v106, s[60:63], s91 offen offset:1024 sc1
    s_cbranch_vccnz L_stub_p1
L_ok_p1:
    v_mfma_f32_16x16x32_bf16 v[208:211], a[80:83], v[4:7], v[208:211]
    ds_read_b128 a[136:139], v253 offset:22528
    s_add_u32 s78, s15, 71680
    v_mfma_f32_16x16x32_bf16 v[212:215], a[84:87], v[4:7], v[212:215]
    ds_read_b128 a[140:143], v253 offset:40960
    v_mfma_f32_16x16x32_bf16 v[216:219], a[88:91], v[4:7], v[216:219]
    s_waitcnt lgkmcnt(11)
    ds_read_b128 a[144:147], v253 offset:41984
    buffer_load_dwordx4 v[44:47], v106, s[60:63], s91 offen offset:2048 sc1
    v_mfma_f32_16x16x32_bf16 v[220:223], a[92:95], v[4:7], v[220:223]
    buffer_load_dwordx4 v106, s[60:63], s78 offen offset:0 sc1 lds
    s_or_b32 s73, s2, s64
    v_mfma_f32_16x16x32_bf16 v[224:227], a[96:99], v[4:7], v[224:227]
    s_waitcnt lgkmcnt(9)
    ds_read_b128 a[148:151], v253 offset:43008
    s_min_u32 s73, s73, 1
    v_mfma_f32_16x16x32_bf16 v[208:211], a[100:103], v[8:11], v[208:211]
    ds_read_b128 a[152:155], v253 offset:44032
    buffer_load_dwordx4 v[48:51], v106, s[60:63], s91 offen offset:3072 sc1
    v_mfma_f32_16x16x32_bf16 v[212:215], a[104:107], v[8:11], v[212:215]
    ds_read_b128 a[156:159], v253 offset:45056
    s_mul_i32 s73, s73, -16
    v_mfma_f32_16x16x32_bf16 v[216:219], a[108:111], v[8:11], v[216:219]
    s_waitcnt lgkmcnt(10)
    buffer_load_dwordx4 v106, s[60:63], s78 offen offset:1024 sc1 lds
    v_mfma_f32_16x16x32_bf16 v[220:223], a[112:115], v[8:11], v[220:223]
    ds_read_b128 a[160:163], v251 offset:12288
    v_mov_b32 v163, s73
    v_mfma_f32_16x16x32_bf16 v[224:227], a[116:119], v[8:11], v[224:227]
    s_waitcnt lgkmcnt(8)
    ds_read_b128 a[164:167], v251 offset:13312
    v_mfma_f32_16x16x32_bf16 v[208:211], a[120:123], v[12:15], v[208:211]
    ds_read_b128 a[168:171], v251 offset:14336
    s_add_u32 s91, s17, 16384
    s_waitcnt vmcnt(6)
    v_max3_u32 v110, v20, v21, v22
    v_mfma_f32_16x16x32_bf16 v[212:215], a[124:127], v[12:15], v[212:215]
    buffer_load_dwordx4 v106, s[60:63], s78 offen offset:2048 sc1 lds
    v_max3_u32 v110, v110, v23, v24
    v_mfma_f32_16x16x32_bf16 v[216:219], a[128:131], v[12:15], v[216:219]
    s_waitcnt lgkmcnt(8)
    ds_read_b128 a[172:175], v251 offset:15360
    buffer_load_dwordx4 v[52:55], v106, s[60:63], s91 offen offset:0 sc1
    v_max3_u32 v110, v110, v25, v26
    v_max3_u32 v110, v110, v27, v28
    v_mfma_f32_16x16x32_bf16 v[220:223], a[132:135], v[12:15], v[220:223]
    ds_read_b128 a[176:179], v251 offset:16384
    v_max3_u32 v110, v110, v29, v30
    v_mfma_f32_16x16x32_bf16 v[224:227], a[136:139], v[12:15], v[224:227]
    s_waitcnt lgkmcnt(7)
    ds_read_b128 a[180:183], v251 offset:30720
    v_max3_u32 v110, v110, v31, v32
    v_max3_u32 v110, v110, v33, v34
    v_mfma_f32_16x16x32_bf16 v[208:211], a[140:143], v[16:19], v[208:211]
    buffer_load_dwordx4 v106, s[60:63], s78 offen offset:3072 sc1 lds
    buffer_load_dwordx4 v[56:59], v106, s[60:63], s91 offen offset:1024 sc1
    v_max_u32 v110, v110, v35
    v_mfma_f32_16x16x32_bf16 v[212:215], a[144:147], v[16:19], v[212:215]
    ds_read_b128 a[184:187], v251 offset:31744
    s_add_u32 m0, s71, 4096
    v_cmp_eq_u32 vcc, -1, v110
    v_mfma_f32_16x16x32_bf16 v[216:219], a[148:151], v[16:19], v[216:219]
    s_waitcnt lgkmcnt(7)
    ds_read_b128 a[188:191], v251 offset:32768
    s_add_u32 s78, s15, 75776
    v_mfma_f32_16x16x32_bf16 v[220:223], a[152:155], v[16:19], v[220:223]
    ds_read_b128 a[192:195], v251 offset:33792
    buffer_load_dwordx4 v[60:63], v106, s[60:63], s91 offen offset:2048 sc1
    v_mfma_f32_16x16x32_bf16 v[224:227], a[156:159], v[16:19], v[224:227]
    s_waitcnt lgkmcnt(6)
    ds_read_b128 a[196:199], v251 offset:34816
    s_cbranch_vccnz L_stub_p2
L_ok_p2:
    v_mfma_f32_16x16x32_bf16 v[208:211], a[160:163], v[20:23], v[208:211]
    ds_read_b128 a[200:203], v251 offset:49152
    s_add_u32 s72, s95, 19456
    v_mfma_f32_16x16x32_bf16 v[212:215], a[164:167], v[20:23], v[212:215]
    ds_read_b128 a[204:207], v251 offset:50176
    buffer_load_dwordx4 v[64:67], v106, s[60:63], s91 offen offset:3072 sc1
    v_mfma_f32_16x16x32_bf16 v[216:219], a[168:171], v[20:23], v[216:219]
    s_waitcnt lgkmcnt(7)
    ds_read_b128 a[208:211], v251 offset:51200
    v_mul_u32_u24 v160, 176, v111
    v_mfma_f32_16x16x32_bf16 v[220:223], a[172:175], v[20:23], v[220:223]
    ds_read_b128 a[212:215], v251 offset:52224
    v_lshrrev_b32 v161, 4, v1
    v_mfma_f32_16x16x32_bf16 v[224:227], a[176:179], v[20:23], v[224:227]
    s_waitcnt lgkmcnt(6)
    ds_read_b128 a[216:219], v251 offset:53248
    buffer_load_dwordx4 v106, s[60:63], s78 offen offset:0 sc1 lds
    s_add_u32 s91, s17, 20480
    v_mfma_f32_16x16x32_bf16 v[208:211], a[180:183], v[24:27], v[208:211]
    ds_read_b128 a[220:223], v252 offset:10240
    v_lshl_add_u32 v160, v161, 3, v160
    v_mfma_f32_16x16x32_bf16 v[212:215], a[184:187], v[24:27], v[212:215]
    ds_read_b128 a[224:227], v252 offset:11264
    buffer_load_dwordx4 v[84:87], v106, s[60:63], s91 offen offset:0 sc1
    v_mfma_f32_16x16x32_bf16 v[216:219], a[188:191], v[24:27], v[216:219]
    s_waitcnt lgkmcnt(7)
    ds_read_b128 a[228:231], v252 offset:12288
    v_add_u32 v255, s72, v160
    v_mfma_f32_16x16x32_bf16 v[220:223], a[192:195], v[24:27], v[220:223]
    ds_read_b128 a[232:235], v252 offset:13312
    v_mfma_f32_16x16x32_bf16 v[224:227], a[196:199], v[24:27], v[224:227]
    s_waitcnt lgkmcnt(6)
    ds_read_b128 a[236:239], v252 offset:14336
    buffer_load_dwordx4 v[88:91], v106, s[60:63], s91 offen offset:1024 sc1
    v_mfma_f32_16x16x32_bf16 v[208:211], a[200:203], v[28:31], v[208:211]
    s_waitcnt vmcnt(10)
    ds_read_b128 a[240:243], v252 offset:16384
    v_add_u32 v160, 0, v1
    v_max3_u32 v110, v36, v37, v38
    v_mfma_f32_16x16x32_bf16 v[212:215], a[204:207], v[28:31], v[212:215]
    ds_read_b128 a[244:247], v252 offset:17408
    v_max3_u32 v110, v110, v39, v40
    v_mfma_f32_16x16x32_bf16 v[216:219], a[208:211], v[28:31], v[216:219]
    s_waitcnt lgkmcnt(7)
    ds_read_b128 a[248:251], v252 offset:18432
    buffer_load_dwordx4 v[92:95], v106, s[60:63], s91 offen offset:2048 sc1
    v_max3_u32 v110, v110, v41, v42
    v_max3_u32 v110, v110, v43, v44
    v_mfma_f32_16x16x32_bf16 v[220:223], a[212:215], v[28:31], v[220:223]
    ds_read_b128 a[252:255], v252 offset:19456
    v_min_u32 v160, 159, v160
    v_max3_u32 v110, v110, v45, v46
    v_mfma_f32_16x16x32_bf16 v[224:227], a[216:219], v[28:31], v[224:227]
    s_waitcnt lgkmcnt(6)
    ds_read_b128 a[0:3], v252 offset:20480
    v_mul_u32_u24 v161, 6554, v160
    v_max3_u32 v110, v110, v47, v48
    v_max3_u32 v110, v110, v49, v50
    v_mfma_f32_16x16x32_bf16 v[208:211], a[220:223], v[32:35], v[208:211]
    ds_read_b128 a[4:7], v252 offset:38912
    buffer_load_dwordx4 v[96:99], v106, s[60:63], s91 offen offset:3072 sc1
    v_max_u32 v110, v110, v51
    v_mfma_f32_16x16x32_bf16 v[212:215], a[224:227], v[32:35], v[212:215]
    ds_read_b128 a[8:11], v252 offset:39936
    v_lshrrev_b32 v161, 16, v161
    v_cmp_eq_u32 vcc, -1, v110
    v_mfma_f32_16x16x32_bf16 v[216:219], a[228:231], v[32:35], v[216:219]
    s_waitcnt lgkmcnt(7)
    ds_read_b128 a[12:15], v252 offset:40960
    v_add_u32 v162, v160, v161
    v_mfma_f32_16x16x32_bf16 v[220:223], a[232:235], v[32:35], v[220:223]
    ds_read_b128 a[16:19], v252 offset:41984
    v_mfma_f32_16x16x32_bf16 v[224:227], a[236:239], v[32:35], v[224:227]
    s_waitcnt lgkmcnt(6)
    ds_read_b128 a[20:23], v252 offset:43008
    s_cbranch_vccnz L_stub_p3
L_ok_p3:
    v_mfma_f32_16x16x32_bf16 v[208:211], a[240:243], v[36:39], v[208:211]
    ds_read_b128 a[24:27], v253 offset:4096
    v_lshl_add_u32 v152, v162, 4, s72
    v_mfma_f32_16x16x32_bf16 v[212:215], a[244:247], v[36:39], v[212:215]
    ds_read_b128 a[28:31], v253 offset:5120
    v_mul_u32_u24 v161, 1120, v161
    v_mfma_f32_16x16x32_bf16 v[216:219], a[248:251], v[36:39], v[216:219]
    s_waitcnt lgkmcnt(7)
    ds_read_b128 a[32:35], v253 offset:6144
    v_mfma_f32_16x16x32_bf16 v[220:223], a[252:255], v[36:39], v[220:223]
    ds_read_b128 a[36:39], v253 offset:7168
    v_lshl_add_u32 v156, v160, 4, v161
    v_mfma_f32_16x16x32_bf16 v[224:227], a[0:3], v[36:39], v[224:227]
    s_waitcnt lgkmcnt(6)
    ds_read_b128 a[40:43], v253 offset:8192
    v_mfma_f32_16x16x32_bf16 v[208:211], a[4:7], v[40:43], v[208:211]
    ds_read_b128 a[44:47], v253 offset:26624
    v_add_u32 v160, 64, v1
    v_mfma_f32_16x16x32_bf16 v[212:215], a[8:11], v[40:43], v[212:215]
    ds_read_b128 a[48:51], v253 offset:27648
    v_mfma_f32_16x16x32_bf16 v[216:219], a[12:15], v[40:43], v[216:219]
    s_waitcnt lgkmcnt(7)
    ds_read_b128 a[52:55], v253 offset:28672
    v_min_u32 v160, 159, v160
    v_mfma_f32_16x16x32_bf16 v[220:223], a[16:19], v[40:43], v[220:223]
    ds_read_b128 a[56:59], v253 offset:29696
    v_mul_u32_u24 v161, 6554, v160
    v_mfma_f32_16x16x32_bf16 v[224:227], a[20:23], v[40:43], v[224:227]
    s_waitcnt lgkmcnt(6)
    ds_read_b128 a[60:63], v253 offset:30720
    v_mfma_f32_16x16x32_bf16 v[208:211], a[24:27], v[44:47], v[208:211]
    s_waitcnt vmcnt(5)
    s_barrier
    ds_read_b128 a[64:67], v252 offset:24576
    v_max3_u32 v110, v52, v53, v54
    v_mfma_f32_16x16x32_bf16 v[212:215], a[28:31], v[44:47], v[212:215]
    ds_read_b128 a[68:71], v252 offset:25600
    v_lshrrev_b32 v161, 16, v161
    v_max3_u32 v110, v110, v55, v56
    v_mfma_f32_16x16x32_bf16 v[216:219], a[32:35], v[44:47], v[216:219]
    s_waitcnt lgkmcnt(7)
    ds_read_b128 a[72:75], v252 offset:26624
    v_max3_u32 v110, v110, v57, v58
    v_max3_u32 v110, v110, v59, v60
    v_mfma_f32_16x16x32_bf16 v[220:223], a[36:39], v[44:47], v[220:223]
    ds_read_b128 a[76:79], v252 offset:27648
    v_add_u32 v162, v160, v161
    v_max3_u32 v110, v110, v61, v62
    v_mfma_f32_16x16x32_bf16 v[224:227], a[40:43], v[44:47], v[224:227]
    s_waitcnt lgkmcnt(6)
    ds_read_b128 a[80:83], v252 offset:28672
    v_max3_u32 v110, v110, v63, v64
    v_max3_u32 v110, v110, v65, v66
    v_mfma_f32_16x16x32_bf16 v[208:211], a[44:47], v[48:51], v[208:211]
    ds_read_b128 a[84:87], v252 offset:47104
    v_lshl_add_u32 v153, v162, 4, s72
    v_max_u32 v110, v110, v67
    v_mfma_f32_16x16x32_bf16 v[212:215], a[48:51], v[48:51], v[212:215]
    ds_read_b128 a[88:91], v252 offset:48128
    v_cmp_eq_u32 vcc, -1, v110
    v_mfma_f32_16x16x32_bf16 v[216:219], a[52:55], v[48:51], v[216:219]
    s_waitcnt lgkmcnt(7)
    ds_read_b128 a[92:95], v252 offset:49152
    v_mul_u32_u24 v161, 1120, v161
    v_mfma_f32_16x16x32_bf16 v[220:223], a[56:59], v[48:51], v[220:223]
    ds_read_b128 a[96:99], v252 offset:50176
    buffer_store_dword v2, v163, s[60:63], 0 offen sc1
    v_mfma_f32_16x16x32_bf16 v[224:227], a[60:63], v[48:51], v[224:227]
    s_waitcnt lgkmcnt(6)
    ds_read_b128 a[100:103], v252 offset:51200
    s_cbranch_vccnz L_stub_p4
L_ok_p4:
    v_mfma_f32_16x16x32_bf16 v[208:211], a[64:67], v[52:55], v[208:211]
    ds_read_b128 a[104:107], v253 offset:12288
    v_lshl_add_u32 v157, v160, 4, v161
    v_mfma_f32_16x16x32_bf16 v[212:215], a[68:71], v[52:55], v[212:215]
    ds_read_b128 a[108:111], v253 offset:13312
    v_add_u32 v160, 128, v1
    v_mfma_f32_16x16x32_bf16 v[216:219], a[72:75], v[52:55], v[216:219]
    s_waitcnt lgkmcnt(7)
    ds_read_b128 a[112:115], v253 offset:14336
    v_min_u32 v160, 159, v160
    v_mfma_f32_16x16x32_bf16 v[220:223], a[76:79], v[52:55], v[220:223]
    ds_read_b128 a[116:119], v253 offset:15360
    v_mfma_f32_16x16x32_bf16 v[224:227], a[80:83], v[52:55], v[224:227]
    s_waitcnt lgkmcnt(6)
    ds_read_b128 a[120:123], v253 offset:16384
    v_mul_u32_u24 v161, 6554, v160
    v_mfma_f32_16x16x32_bf16 v[208:211], a[84:87], v[56:59], v[208:211]
    ds_read_b128 a[124:127], v253 offset:34816
    v_mfma_f32_16x16x32_bf16 v[212:215], a[88:91], v[56:59], v[212:215]
    ds_read_b128 a[128:131], v253 offset:35840
    v_lshrrev_b32 v161, 16, v161
    v_mfma_f32_16x16x32_bf16 v[216:219], a[92:95], v[56:59], v[216:219]
    s_waitcnt lgkmcnt(7)
    ds_read_b128 a[132:135], v253 offset:36864
    v_mfma_f32_16x16x32_bf16 v[220:223], a[96:99], v[56:59], v[220:223]
    ds_read_b128 a[136:139], v253 offset:37888
    v_add_u32 v162, v160, v161
    v_mfma_f32_16x16x32_bf16 v[224:227], a[100:103], v[56:59], v[224:227]
    s_waitcnt lgkmcnt(6)
    ds_read_b128 a[140:143], v253 offset:38912
    v_mfma_f32_16x16x32_bf16 v[208:211], a[104:107], v[60:63], v[208:211]
    s_waitcnt vmcnt(5)
    s_waitcnt vmcnt(1)
    s_barrier
    ds_read_b128 a[144:147], v251 offset:0
    v_max3_u32 v110, v84, v85, v86
    v_mfma_f32_16x16x32_bf16 v[212:215], a[108:111], v[60:63], v[212:215]
    ds_read_b128 a[164:167], v251 offset:18432
    v_lshl_add_u32 v154, v162, 4, s72
    v_max3_u32 v110, v110, v87, v88
    v_mfma_f32_16x16x32_bf16 v[216:219], a[112:115], v[60:63], v[216:219]
    s_waitcnt lgkmcnt(7)
    ds_read_b128 a[184:187], v251 offset:36864
    v_max3_u32 v110, v110, v89, v90
    v_max3_u32 v110, v110, v91, v92
    v_mfma_f32_16x16x32_bf16 v[220:223], a[116:119], v[60:63], v[220:223]
    ds_read_b128 a[204:207], v251 offset:55296
    v_mul_u32_u24 v161, 1120, v161
    v_max3_u32 v110, v110, v93, v94
    v_mfma_f32_16x16x32_bf16 v[224:227], a[120:123], v[60:63], v[224:227]
    s_waitcnt lgkmcnt(6)
    ds_read_b128 a[148:151], v251 offset:1024
    v_max3_u32 v110, v110, v95, v96
    v_max3_u32 v110, v110, v97, v98
    v_mfma_f32_16x16x32_bf16 v[208:211], a[124:127], v[64:67], v[208:211]
    ds_read_b128 a[168:171], v251 offset:19456
    v_lshl_add_u32 v158, v160, 4, v161
    v_max_u32 v110, v110, v99
    v_mfma_f32_16x16x32_bf16 v[212:215], a[128:131], v[64:67], v[212:215]
    ds_read_b128 a[188:191], v251 offset:37888
    v_cmp_eq_u32 vcc, -1, v110
    v_mfma_f32_16x16x32_bf16 v[216:219], a[132:135], v[64:67], v[216:219]
    s_waitcnt lgkmcnt(7)
    ds_read_b128 a[208:211], v251 offset:56320
    v_mfma_f32_16x16x32_bf16 v[220:223], a[136:139], v[64:67], v[220:223]
    ds_read_b128 a[152:155], v251 offset:2048
    v_mfma_f32_16x16x32_bf16 v[224:227], a[140:143], v[64:67], v[224:227]
    s_waitcnt lgkmcnt(6)
    ds_read_b128 a[172:175], v251 offset:20480
    s_cbranch_vccnz L_stub_p5
L_ok_p5:
    v_mfma_f32_16x16x32_bf16 v[208:211], a[144:147], v[84:87], v[208:211]
    ds_read_b128 a[192:195], v251 offset:38912
    v_mfma_f32_16x16x32_bf16 v[208:211], a[164:167], v[88:91], v[208:211]
    ds_read_b128 a[212:215], v252 offset:0
    v_mfma_f32_16x16x32_bf16 v[208:211], a[184:187], v[92:95], v[208:211]
    s_waitcnt lgkmcnt(7)
    ds_read_b128 a[156:159], v251 offset:3072
    v_mfma_f32_16x16x32_bf16 v[208:211], a[204:207], v[96:99], v[208:211]
    ds_read_b128 a[176:179], v251 offset:21504
    v_mfma_f32_16x16x32_bf16 v[212:215], a[148:151], v[84:87], v[212:215]
    s_waitcnt lgkmcnt(6)
    ds_read_b128 a[196:199], v251 offset:39936
    v_mfma_f32_16x16x32_bf16 v[212:215], a[168:171], v[88:91], v[212:215]
    ds_read_b128 a[216:219], v252 offset:1024
    v_mfma_f32_16x16x32_bf16 v[212:215], a[188:191], v[92:95], v[212:215]
    ds_read_b128 a[160:163], v251 offset:4096
    v_mfma_f32_16x16x32_bf16 v[212:215], a[208:211], v[96:99], v[212:215]
    s_waitcnt lgkmcnt(7)
    ds_read_b128 a[180:183], v251 offset:22528
    v_mfma_f32_16x16x32_bf16 v[216:219], a[152:155], v[84:87], v[216:219]
    ds_read_b128 a[200:203], v251 offset:40960
    v_mfma_f32_16x16x32_bf16 v[216:219], a[172:175], v[88:91], v[216:219]
    s_waitcnt lgkmcnt(6)
    ds_read_b128 a[220:223], v252 offset:2048
    v_mfma_f32_16x16x32_bf16 v[216:219], a[192:195], v[92:95], v[216:219]
    v_cvt_pk_bf16_f32 v128, v208, v209
    v_cvt_pk_bf16_f32 v129, v210, v211
    v_mfma_f32_16x16x32_bf16 v[216:219], a[212:215], v[96:99], v[216:219]
    ds_write_b64 v255, v[128:129] offset:0
    v_mfma_f32_16x16x32_bf16 v[220:223], a[156:159], v[84:87], v[220:223]
    s_waitcnt lgkmcnt(6)
    v_mfma_f32_16x16x32_bf16 v[220:223], a[176:179], v[88:91], v[220:223]
    v_mfma_f32_16x16x32_bf16 v[220:223], a[196:199], v[92:95], v[220:223]
    s_waitcnt lgkmcnt(3)
    v_cvt_pk_bf16_f32 v130, v212, v213
    v_cvt_pk_bf16_f32 v131, v214, v215
    v_mfma_f32_16x16x32_bf16 v[220:223], a[216:219], v[96:99], v[220:223]
    ds_write_b64 v255, v[130:131] offset:32
    v_mfma_f32_16x16x32_bf16 v[224:227], a[160:163], v[84:87], v[224:227]
    v_mfma_f32_16x16x32_bf16 v[224:227], a[180:183], v[88:91], v[224:227]
    s_waitcnt lgkmcnt(2)
    v_mfma_f32_16x16x32_bf16 v[224:227], a[200:203], v[92:95], v[224:227]
    v_cvt_pk_bf16_f32 v132, v216, v217
    v_cvt_pk_bf16_f32 v133, v218, v219
    v_mfma_f32_16x16x32_bf16 v[224:227], a[220:223], v[96:99], v[224:227]
    ds_write_b64 v255, v[132:133] offset:64
    v_cvt_pk_bf16_f32 v134, v220, v221
    v_cvt_pk_bf16_f32 v135, v222, v223
    ds_write_b64 v255, v[134:135] offset:96
    s_nop 3
    v_cvt_pk_bf16_f32 v136, v224, v225
    v_cvt_pk_bf16_f32 v137, v226, v227
    ds_write_b64 v255, v[136:137] offset:128
    ds_read_b128 v[140:143], v152
    ds_read_b128 v[144:147], v153
    ds_read_b128 v[148:151], v154
    s_waitcnt lgkmcnt(2)
    buffer_store_dwordx4 v[140:143], v156, s[56:59], s19 offen
    s_waitcnt lgkmcnt(1)
    buffer_store_dwordx4 v[144:147], v157, s[56:59], s19 offen
    s_mov_b32 exec_hi, 0
    s_waitcnt lgkmcnt(0)
    buffer_store_dwordx4 v[148:151], v158, s[56:59], s19 offen
    s_mov_b32 exec_hi, -1
L_end:
L_exit:
    s_endpgm
L_stub_st:
L_again_st:
    s_mov_b32 s91, 16384
    buffer_load_dwordx4 v[20:23], v109, s[60:63], s91 offen sc1
    s_mov_b32 s91, 20480
    buffer_load_dwordx4 v[24:27], v109, s[60:63], s91 offen sc1
    s_mov_b32 s91, 24576
    buffer_load_dwordx4 v[28:31], v109, s[60:63], s91 offen sc1
    s_mov_b32 s91, 28672
    buffer_load_dwordx4 v[32:35], v109, s[60:63], s91 offen sc1
    s_waitcnt vmcnt(0)
    v_xor_b32 v128, v21, v2
    v_bitop3_b32 v128, v23, v2, v128 bitop3:0xbe
    v_bitop3_b32 v128, v25, v2, v128 bitop3:0xbe
    v_bitop3_b32 v128, v27, v2, v128 bitop3:0xbe
    v_bitop3_b32 v128, v29, v2, v128 bitop3:0xbe
    v_bitop3_b32 v128, v31, v2, v128 bitop3:0xbe
    v_bitop3_b32 v128, v33, v2, v128 bitop3:0xbe
    v_bitop3_b32 v128, v35, v2, v128 bitop3:0xbe
    v_cmp_ne_u32 vcc, 0, v128
    s_cbranch_vccz L_ok_st
    s_sub_u32 s76, s76, 1
    s_cmp_lt_i32 s76, 0
    s_cbranch_scc1 L_ok_st
    s_sleep 4
    s_branch L_again_st
L_stub_flgc:
L_again_flgc:
    buffer_load_dword v110, v107, s[60:63], 0 offen sc1
    s_waitcnt vmcnt(0)
    v_xor_b32 v112, v110, v2
    v_cmp_ne_u32 vcc, 0, v112
    s_cbranch_vccz L_ok_flgc
    s_sub_u32 s76, s76, 1
    s_cmp_lt_i32 s76, 0
    s_cbranch_scc1 L_ok_flgc
    s_sleep 1
    s_branch L_again_flgc
L_stub_pre:
L_again_pre:
    buffer_load_dwordx2 v[4:5], v7, s[60:63], s3 offen sc1
    s_waitcnt vmcnt(0)
    v_max_u32 v6, v4, v5
    v_cmp_eq_u32 vcc, -1, v6
    s_cbranch_vccz L_ok_pre
    s_sub_u32 s76, s76, 1
    s_cmp_lt_i32 s76, 0
    s_cbranch_scc1 L_ok_pre
    s_sleep 2
    s_branch L_again_pre
L_stub_h0:
L_again_h0:
    s_add_u32 s91, s92, 0
    buffer_load_dwordx4 v[4:7], v90, s[60:63], s91 offen sc1
    s_add_u32 s91, s92, 131072
    buffer_load_dwordx4 v[8:11], v90, s[60:63], s91 offen sc1
    s_add_u32 s91, s92, 262144
    buffer_load_dwordx4 v[12:15], v90, s[60:63], s91 offen sc1
    s_add_u32 s91, s92, 393216
    buffer_load_dwordx4 v[16:19], v90, s[60:63], s91 offen sc1
    s_add_u32 s91, s92, 524288
    buffer_load_dwordx4 v[20:23], v90, s[60:63], s91 offen sc1
    s_add_u32 s91, s92, 655360
    buffer_load_dwordx4 v[24:27], v90, s[60:63], s91 offen sc1
    s_add_u32 s91, s92, 786432
    buffer_load_dwordx4 v[28:31], v90, s[60:63], s91 offen sc1
    s_add_u32 s91, s92, 917504
    buffer_load_dwordx4 v[32:35], v90, s[60:63], s91 offen sc1
    s_add_u32 s91, s92, 1048576
    buffer_load_dwordx4 v[36:39], v90, s[60:63], s91 offen sc1
    s_add_u32 s91, s92, 1179648
    buffer_load_dwordx4 v[40:43], v90, s[60:63], s91 offen sc1
    s_add_u32 s91, s92, 1310720
    buffer_load_dwordx4 v[44:47], v90, s[60:63], s91 offen sc1
    s_add_u32 s91, s92, 1441792
    buffer_load_dwordx4 v[48:51], v90, s[60:63], s91 offen sc1
    s_waitcnt vmcnt(0)
    s_nop 0
    v_max3_u32 v102, v4, v5, v6
    v_max3_u32 v102, v102, v7, v8
    v_max3_u32 v102, v102, v9, v10
    v_max3_u32 v102, v102, v11, v12
    v_max3_u32 v102, v102, v13, v14
    v_max3_u32 v102, v102, v15, v16
    v_max3_u32 v102, v102, v17, v18
    v_max_u32 v102, v102, v19
    v_cmp_eq_u32 vcc, -1, v102
    s_cbranch_vccz L_ok_h0
    s_sub_u32 s76, s76, 1
    s_cmp_lt_i32 s76, 0
    s_cbranch_scc1 L_ok_h0
    s_sleep 2
    s_branch L_again_h0
L_stub_h1:
L_again_h1:
    s_add_u32 s91, s92, 524288
    buffer_load_dwordx4 v[20:23], v90, s[60:63], s91 offen sc1
    s_add_u32 s91, s92, 655360
    buffer_load_dwordx4 v[24:27], v90, s[60:63], s91 offen sc1
    s_add_u32 s91, s92, 786432
    buffer_load_dwordx4 v[28:31], v90, s[60:63], s91 offen sc1
    s_add_u32 s91, s92, 917504
    buffer_load_dwordx4 v[32:35], v90, s[60:63], s91 offen sc1
    s_add_u32 s91, s92, 1048576
    buffer_load_dwordx4 v[36:39], v90, s[60:63], s91 offen sc1
    s_add_u32 s91, s92, 1179648
    buffer_load_dwordx4 v[40:43], v90, s[60:63], s91 offen sc1
    s_add_u32 s91, s92, 1310720
    buffer_load_dwordx4 v[44:47], v90, s[60:63], s91 offen sc1
    s_add_u32 s91, s92, 1441792
    buffer_load_dwordx4 v[48:51], v90, s[60:63], s91 offen sc1
    s_add_u32 s91, s92, 1572864
    buffer_load_dwordx4 v[52:55], v90, s[60:63], s91 offen sc1
    s_add_u32 s91, s92, 1703936
    buffer_load_dwordx4 v[56:59], v90, s[60:63], s91 offen sc1
    s_add_u32 s91, s92, 1835008
    buffer_load_dwordx4 v[60:63], v90, s[60:63], s91 offen sc1
    s_add_u32 s91, s92, 1966080
    buffer_load_dwordx4 v[64:67], v90, s[60:63], s91 offen sc1
    s_waitcnt vmcnt(0)
    s_nop 0
    v_max3_u32 v102, v20, v21, v22
    v_max3_u32 v102, v102, v23, v24
    v_max3_u32 v102, v102, v25, v26
    v_max3_u32 v102, v102, v27, v28
    v_max3_u32 v102, v102, v29, v30
    v_max3_u32 v102, v102, v31, v32
    v_max3_u32 v102, v102, v33, v34
    v_max_u32 v102, v102, v35
    v_cmp_eq_u32 vcc, -1, v102
    s_cbranch_vccz L_ok_h1
    s_sub_u32 s76, s76, 1
    s_cmp_lt_i32 s76, 0
    s_cbranch_scc1 L_ok_h1
    s_sleep 1
    s_branch L_again_h1
L_stub_h2:
L_again_h2:
    s_add_u32 s91, s92, 1048576
    buffer_load_dwordx4 v[36:39], v90, s[60:63], s91 offen sc1
    s_add_u32 s91, s92, 1179648
    buffer_load_dwordx4 v[40:43], v90, s[60:63], s91 offen sc1
    s_add_u32 s91, s92, 1310720
    buffer_load_dwordx4 v[44:47], v90, s[60:63], s91 offen sc1
    s_add_u32 s91, s92, 1441792
    buffer_load_dwordx4 v[48:51], v90, s[60:63], s91 offen sc1
    s_add_u32 s91, s92, 1572864
    buffer_load_dwordx4 v[52:55], v90, s[60:63], s91 offen sc1
    s_add_u32 s91, s92, 1703936
    buffer_load_dwordx4 v[56:59], v90, s[60:63], s91 offen sc1
    s_add_u32 s91, s92, 1835008
    buffer_load_dwordx4 v[60:63], v90, s[60:63], s91 offen sc1
    s_add_u32 s91, s92, 1966080
    buffer_load_dwordx4 v[64:67], v90, s[60:63], s91 offen sc1
    s_add_u32 s91, s92, 2097152
    buffer_load_dwordx4 v[68:71], v90, s[60:63], s91 offen sc1
    s_add_u32 s91, s92, 2228224
    buffer_load_dwordx4 v[72:75], v90, s[60:63], s91 offen sc1
    s_add_u32 s91, s92, 2359296
    buffer_load_dwordx4 v[76:79], v90, s[60:63], s91 offen sc1
    s_add_u32 s91, s92, 2490368
    buffer_load_dwordx4 v[80:83], v90, s[60:63], s91 offen sc1
    s_waitcnt vmcnt(0)
    s_nop 0
    v_max3_u32 v102, v36, v37, v38
    v_max3_u32 v102, v102, v39, v40
    v_max3_u32 v102, v102, v41, v42
    v_max3_u32 v102, v102, v43, v44
    v_max3_u32 v102, v102, v45, v46
    v_max3_u32 v102, v102, v47, v48
    v_max3_u32 v102, v102, v49, v50
    v_max_u32 v102, v102, v51
    v_cmp_eq_u32 vcc, -1, v102
    s_cbranch_vccz L_ok_h2
    s_sub_u32 s76, s76, 1
    s_cmp_lt_i32 s76, 0
    s_cbranch_scc1 L_ok_h2
    s_sleep 1
    s_branch L_again_h2
L_stub_h3:
L_again_h3:
    s_add_u32 s91, s92, 1572864
    buffer_load_dwordx4 v[52:55], v90, s[60:63], s91 offen sc1
    s_add_u32 s91, s92, 1703936
    buffer_load_dwordx4 v[56:59], v90, s[60:63], s91 offen sc1
    s_add_u32 s91, s92, 1835008
    buffer_load_dwordx4 v[60:63], v90, s[60:63], s91 offen sc1
    s_add_u32 s91, s92, 1966080
    buffer_load_dwordx4 v[64:67], v90, s[60:63], s91 offen sc1
    s_add_u32 s91, s92, 2097152
    buffer_load_dwordx4 v[68:71], v90, s[60:63], s91 offen sc1
    s_add_u32 s91, s92, 2228224
    buffer_load_dwordx4 v[72:75], v90, s[60:63], s91 offen sc1
    s_add_u32 s91, s92, 2359296
    buffer_load_dwordx4 v[76:79], v90, s[60:63], s91 offen sc1
    s_add_u32 s91, s92, 2490368
    buffer_load_dwordx4 v[80:83], v90, s[60:63], s91 offen sc1
    s_waitcnt vmcnt(0)
    s_nop 0
    v_max3_u32 v102, v52, v53, v54
    v_max3_u32 v102, v102, v55, v56
    v_max3_u32 v102, v102, v57, v58
    v_max3_u32 v102, v102, v59, v60
    v_max3_u32 v102, v102, v61, v62
    v_max3_u32 v102, v102, v63, v64
    v_max3_u32 v102, v102, v65, v66
    v_max_u32 v102, v102, v67
    v_cmp_eq_u32 vcc, -1, v102
    s_cbranch_vccz L_ok_h3
    s_sub_u32 s76, s76, 1
    s_cmp_lt_i32 s76, 0
    s_cbranch_scc1 L_ok_h3
    s_sleep 1
    s_branch L_again_h3
L_stub_h4:
L_again_h4:
    s_add_u32 s91, s92, 2097152
    buffer_load_dwordx4 v[68:71], v90, s[60:63], s91 offen sc1
    s_add_u32 s91, s92, 2228224
    buffer_load_dwordx4 v[72:75], v90, s[60:63], s91 offen sc1
    s_add_u32 s91, s92, 2359296
    buffer_load_dwordx4 v[76:79], v90, s[60:63], s91 offen sc1
    s_add_u32 s91, s92, 2490368
    buffer_load_dwordx4 v[80:83], v90, s[60:63], s91 offen sc1
    s_waitcnt vmcnt(0)
    s_nop 0
    v_max3_u32 v102, v68, v69, v70
    v_max3_u32 v102, v102, v71, v72
    v_max3_u32 v102, v102, v73, v74
    v_max3_u32 v102, v102, v75, v76
    v_max3_u32 v102, v102, v77, v78
    v_max3_u32 v102, v102, v79, v80
    v_max3_u32 v102, v102, v81, v82
    v_max_u32 v102, v102, v83
    v_cmp_eq_u32 vcc, -1, v102
    s_cbranch_vccz L_ok_h4
    s_sub_u32 s76, s76, 1
    s_cmp_lt_i32 s76, 0
    s_cbranch_scc1 L_ok_h4
    s_sleep 1
    s_branch L_again_h4
L_stub_zs:
L_again_zs:
    buffer_load_dwordx4 v[136:139], v91, s[60:63], s93 offen sc1
    s_waitcnt vmcnt(0)
    v_max3_u32 v104, v136, v137, v138
    v_max_u32 v104, v104, v139
    v_cmp_eq_u32 vcc, -1, v104
    s_cbranch_vccz L_ok_zs
    s_sub_u32 s76, s76, 1
    s_cmp_lt_i32 s76, 0
    s_cbranch_scc1 L_ok_zs
    s_sleep 1
    s_branch L_again_zs
L_stub_zc:
L_again_zc:
    buffer_load_dwordx2 v[108:109], v107, s[60:63], s23 offen sc1
    s_waitcnt vmcnt(0)
    v_max_u32 v104, v108, v109
    v_cmp_eq_u32 vcc, -1, v104
    s_cbranch_vccz L_ok_zc
    s_sub_u32 s76, s76, 1
    s_cmp_lt_i32 s76, 0
    s_cbranch_scc1 L_ok_zc
    s_sleep 1
    s_branch L_again_zc
L_stub_z0:
L_again_z0:
    s_add_u32 s91, s4, 0
    buffer_load_dwordx4 v[4:7], v106, s[60:63], s91 offen offset:0 sc1
    buffer_load_dwordx4 v[8:11], v106, s[60:63], s91 offen offset:1024 sc1
    buffer_load_dwordx4 v[12:15], v106, s[60:63], s91 offen offset:2048 sc1
    buffer_load_dwordx4 v[16:19], v106, s[60:63], s91 offen offset:3072 sc1
    s_add_u32 s91, s7, 0
    s_waitcnt vmcnt(0)
    s_nop 0
    v_max3_u32 v104, v4, v5, v6
    v_max3_u32 v104, v104, v7, v8
    v_max3_u32 v104, v104, v9, v10
    v_max3_u32 v104, v104, v11, v12
    v_max3_u32 v104, v104, v13, v14
    v_max3_u32 v104, v104, v15, v16
    v_max3_u32 v104, v104, v17, v18
    v_max_u32 v104, v104, v19
    v_cmp_eq_u32 vcc, -1, v104
    s_cbranch_vccz L_ok_z0
    s_sub_u32 s76, s76, 1
    s_cmp_lt_i32 s76, 0
    s_cbranch_scc1 L_ok_z0
    s_sleep 1
    s_branch L_again_z0
L_stub_z1:
L_again_z1:
    s_add_u32 s91, s5, 0
    buffer_load_dwordx4 v[20:23], v106, s[60:63], s91 offen offset:0 sc1
    buffer_load_dwordx4 v[24:27], v106, s[60:63], s91 offen offset:1024 sc1
    buffer_load_dwordx4 v[28:31], v106, s[60:63], s91 offen offset:2048 sc1
    buffer_load_dwordx4 v[32:35], v106, s[60:63], s91 offen offset:3072 sc1
    s_add_u32 s91, s8, 0
    s_waitcnt vmcnt(0)
    s_nop 0
    v_max3_u32 v104, v20, v21, v22
    v_max3_u32 v104, v104, v23, v24
    v_max3_u32 v104, v104, v25, v26
    v_max3_u32 v104, v104, v27, v28
    v_max3_u32 v104, v104, v29, v30
    v_max3_u32 v104, v104, v31, v32
    v_max3_u32 v104, v104, v33, v34
    v_max_u32 v104, v104, v35
    v_cmp_eq_u32 vcc, -1, v104
    s_cbranch_vccz L_ok_z1
    s_sub_u32 s76, s76, 1
    s_cmp_lt_i32 s76, 0
    s_cbranch_scc1 L_ok_z1
    s_sleep 1
    s_branch L_again_z1
L_stub_z2:
L_again_z2:
    s_add_u32 s91, s6, 0
    buffer_load_dwordx4 v[36:39], v106, s[60:63], s91 offen offset:0 sc1
    buffer_load_dwordx4 v[40:43], v106, s[60:63], s91 offen offset:1024 sc1
    buffer_load_dwordx4 v[44:47], v106, s[60:63], s91 offen offset:2048 sc1
    buffer_load_dwordx4 v[48:51], v106, s[60:63], s91 offen offset:3072 sc1
    s_add_u32 s91, s9, 0
    s_waitcnt vmcnt(0)
    s_nop 0
    v_max3_u32 v104, v36, v37, v38
    v_max3_u32 v104, v104, v39, v40
    v_max3_u32 v104, v104, v41, v42
    v_max3_u32 v104, v104, v43, v44
    v_max3_u32 v104, v104, v45, v46
    v_max3_u32 v104, v104, v47, v48
    v_max3_u32 v104, v104, v49, v50
    v_max_u32 v104, v104, v51
    v_cmp_eq_u32 vcc, -1, v104
    s_cbranch_vccz L_ok_z2
    s_sub_u32 s76, s76, 1
    s_cmp_lt_i32 s76, 0
    s_cbranch_scc1 L_ok_z2
    s_sleep 1
    s_branch L_again_z2
L_stub_z3:
L_again_z3:
    s_add_u32 s91, s7, 0
    buffer_load_dwordx4 v[52:55], v106, s[60:63], s91 offen offset:0 sc1
    buffer_load_dwordx4 v[56:59], v106, s[60:63], s91 offen offset:1024 sc1
    buffer_load_dwordx4 v[60:63], v106, s[60:63], s91 offen offset:2048 sc1
    buffer_load_dwordx4 v[64:67], v106, s[60:63], s91 offen offset:3072 sc1
    s_add_u32 s91, s10, 0
    s_waitcnt vmcnt(0)
    s_nop 0
    v_max3_u32 v104, v52, v53, v54
    v_max3_u32 v104, v104, v55, v56
    v_max3_u32 v104, v104, v57, v58
    v_max3_u32 v104, v104, v59, v60
    v_max3_u32 v104, v104, v61, v62
    v_max3_u32 v104, v104, v63, v64
    v_max3_u32 v104, v104, v65, v66
    v_max_u32 v104, v104, v67
    v_cmp_eq_u32 vcc, -1, v104
    s_cbranch_vccz L_ok_z3
    s_sub_u32 s76, s76, 1
    s_cmp_lt_i32 s76, 0
    s_cbranch_scc1 L_ok_z3
    s_sleep 1
    s_branch L_again_z3
L_stub_z4:
L_again_z4:
    s_add_u32 s91, s8, 0
    buffer_load_dwordx4 v[68:71], v106, s[60:63], s91 offen offset:0 sc1
    buffer_load_dwordx4 v[72:75], v106, s[60:63], s91 offen offset:1024 sc1
    buffer_load_dwordx4 v[76:79], v106, s[60:63], s91 offen offset:2048 sc1
    buffer_load_dwordx4 v[80:83], v106, s[60:63], s91 offen offset:3072 sc1
    s_add_u32 s91, s11, 0
    s_waitcnt vmcnt(0)
    s_nop 0
    v_max3_u32 v104, v68, v69, v70
    v_max3_u32 v104, v104, v71, v72
    v_max3_u32 v104, v104, v73, v74
    v_max3_u32 v104, v104, v75, v76
    v_max3_u32 v104, v104, v77, v78
    v_max3_u32 v104, v104, v79, v80
    v_max3_u32 v104, v104, v81, v82
    v_max_u32 v104, v104, v83
    v_cmp_eq_u32 vcc, -1, v104
    s_cbranch_vccz L_ok_z4
    s_sub_u32 s76, s76, 1
    s_cmp_lt_i32 s76, 0
    s_cbranch_scc1 L_ok_z4
    s_sleep 1
    s_branch L_again_z4
L_stub_z5:
L_again_z5:
    s_add_u32 s91, s9, 0
    s_nop 0
    buffer_load_dwordx4 v[4:7], v106, s[60:63], s91 offen offset:0 sc1
    buffer_load_dwordx4 v[8:11], v106, s[60:63], s91 offen offset:1024 sc1
    buffer_load_dwordx4 v[12:15], v106, s[60:63], s91 offen offset:2048 sc1
    buffer_load_dwordx4 v[16:19], v106, s[60:63], s91 offen offset:3072 sc1
    s_add_u32 s91, s4, 131072
    s_waitcnt vmcnt(0)
    s_nop 0
    v_max3_u32 v104, v4, v5, v6
    v_max3_u32 v104, v104, v7, v8
    v_max3_u32 v104, v104, v9, v10
    v_max3_u32 v104, v104, v11, v12
    v_max3_u32 v104, v104, v13, v14
    v_max3_u32 v104, v104, v15, v16
    v_max3_u32 v104, v104, v17, v18
    v_max_u32 v104, v104, v19
    v_cmp_eq_u32 vcc, -1, v104
    s_cbranch_vccz L_ok_z5
    s_sub_u32 s76, s76, 1
    s_cmp_lt_i32 s76, 0
    s_cbranch_scc1 L_ok_z5
    s_sleep 1
    s_branch L_again_z5
L_stub_z6:
L_again_z6:
    s_add_u32 s91, s10, 0
    s_nop 0
    buffer_load_dwordx4 v[20:23], v106, s[60:63], s91 offen offset:0 sc1
    buffer_load_dwordx4 v[24:27], v106, s[60:63], s91 offen offset:1024 sc1
    buffer_load_dwordx4 v[28:31], v106, s[60:63], s91 offen offset:2048 sc1
    buffer_load_dwordx4 v[32:35], v106, s[60:63], s91 offen offset:3072 sc1
    s_add_u32 s91, s5, 131072
    s_waitcnt vmcnt(0)
    s_nop 0
    v_max3_u32 v104, v20, v21, v22
    v_max3_u32 v104, v104, v23, v24
    v_max3_u32 v104, v104, v25, v26
    v_max3_u32 v104, v104, v27, v28
    v_max3_u32 v104, v104, v29, v30
    v_max3_u32 v104, v104, v31, v32
    v_max3_u32 v104, v104, v33, v34
    v_max_u32 v104, v104, v35
    v_cmp_eq_u32 vcc, -1, v104
    s_cbranch_vccz L_ok_z6
    s_sub_u32 s76, s76, 1
    s_cmp_lt_i32 s76, 0
    s_cbranch_scc1 L_ok_z6
    s_sleep 1
    s_branch L_again_z6
L_stub_z7:
L_again_z7:
    s_add_u32 s91, s11, 0
    s_nop 0
    buffer_load_dwordx4 v[36:39], v106, s[60:63], s91 offen offset:0 sc1
    buffer_load_dwordx4 v[40:43], v106, s[60:63], s91 offen offset:1024 sc1
    buffer_load_dwordx4 v[44:47], v106, s[60:63], s91 offen offset:2048 sc1
    buffer_load_dwordx4 v[48:51], v106, s[60:63], s91 offen offset:3072 sc1
    s_add_u32 s91, s6, 131072
    s_waitcnt vmcnt(0)
    s_nop 0
    v_max3_u32 v104, v36, v37, v38
    v_max3_u32 v104, v104, v39, v40
    v_max3_u32 v104, v104, v41, v42
    v_max3_u32 v104, v104, v43, v44
    v_max3_u32 v104, v104, v45, v46
    v_max3_u32 v104, v104, v47, v48
    v_max3_u32 v104, v104, v49, v50
    v_max_u32 v104, v104, v51
    v_cmp_eq_u32 vcc, -1, v104
    s_cbranch_vccz L_ok_z7
    s_sub_u32 s76, s76, 1
    s_cmp_lt_i32 s76, 0
    s_cbranch_scc1 L_ok_z7
    s_sleep 1
    s_branch L_again_z7
L_stub_z8:
L_again_z8:
    s_add_u32 s91, s4, 131072
    buffer_load_dwordx4 v[52:55], v106, s[60:63], s91 offen offset:0 sc1
    buffer_load_dwordx4 v[56:59], v106, s[60:63], s91 offen offset:1024 sc1
    buffer_load_dwordx4 v[60:63], v106, s[60:63], s91 offen offset:2048 sc1
    buffer_load_dwordx4 v[64:67], v106, s[60:63], s91 offen offset:3072 sc1
    s_add_u32 s91, s7, 131072
    s_waitcnt vmcnt(0)
    s_nop 0
    v_max3_u32 v104, v52, v53, v54
    v_max3_u32 v104, v104, v55, v56
    v_max3_u32 v104, v104, v57, v58
    v_max3_u32 v104, v104, v59, v60
    v_max3_u32 v104, v104, v61, v62
    v_max3_u32 v104, v104, v63, v64
    v_max3_u32 v104, v104, v65, v66
    v_max_u32 v104, v104, v67
    v_cmp_eq_u32 vcc, -1, v104
    s_cbranch_vccz L_ok_z8
    s_sub_u32 s76, s76, 1
    s_cmp_lt_i32 s76, 0
    s_cbranch_scc1 L_ok_z8
    s_sleep 1
    s_branch L_again_z8
L_stub_z9:
L_again_z9:
    s_add_u32 s91, s5, 131072
    buffer_load_dwordx4 v[68:71], v106, s[60:63], s91 offen offset:0 sc1
    buffer_load_dwordx4 v[72:75], v106, s[60:63], s91 offen offset:1024 sc1
    buffer_load_dwordx4 v[76:79], v106, s[60:63], s91 offen offset:2048 sc1
    buffer_load_dwordx4 v[80:83], v106, s[60:63], s91 offen offset:3072 sc1
    s_add_u32 s91, s8, 131072
    s_waitcnt vmcnt(0)
    s_nop 0
    v_max3_u32 v104, v68, v69, v70
    v_max3_u32 v104, v104, v71, v72
    v_max3_u32 v104, v104, v73, v74
    v_max3_u32 v104, v104, v75, v76
    v_max3_u32 v104, v104, v77, v78
    v_max3_u32 v104, v104, v79, v80
    v_max3_u32 v104, v104, v81, v82
    v_max_u32 v104, v104, v83
    v_cmp_eq_u32 vcc, -1, v104
    s_cbranch_vccz L_ok_z9
    s_sub_u32 s76, s76, 1
    s_cmp_lt_i32 s76, 0
    s_cbranch_scc1 L_ok_z9
    s_sleep 1
    s_branch L_again_z9
L_stub_z10:
L_again_z10:
    s_add_u32 s91, s6, 131072
    buffer_load_dwordx4 v[4:7], v106, s[60:63], s91 offen offset:0 sc1
    buffer_load_dwordx4 v[8:11], v106, s[60:63], s91 offen offset:1024 sc1
    buffer_load_dwordx4 v[12:15], v106, s[60:63], s91 offen offset:2048 sc1
    buffer_load_dwordx4 v[16:19], v106, s[60:63], s91 offen offset:3072 sc1
    s_add_u32 s91, s9, 131072
    s_waitcnt vmcnt(0)
    s_nop 0
    v_max3_u32 v104, v4, v5, v6
    v_max3_u32 v104, v104, v7, v8
    v_max3_u32 v104, v104, v9, v10
    v_max3_u32 v104, v104, v11, v12
    v_max3_u32 v104, v104, v13, v14
    v_max3_u32 v104, v104, v15, v16
    v_max3_u32 v104, v104, v17, v18
    v_max_u32 v104, v104, v19
    v_cmp_eq_u32 vcc, -1, v104
    s_cbranch_vccz L_ok_z10
    s_sub_u32 s76, s76, 1
    s_cmp_lt_i32 s76, 0
    s_cbranch_scc1 L_ok_z10
    s_sleep 1
    s_branch L_again_z10
L_stub_z11:
L_again_z11:
    s_add_u32 s91, s7, 131072
    buffer_load_dwordx4 v[20:23], v106, s[60:63], s91 offen offset:0 sc1
    buffer_load_dwordx4 v[24:27], v106, s[60:63], s91 offen offset:1024 sc1
    buffer_load_dwordx4 v[28:31], v106, s[60:63], s91 offen offset:2048 sc1
    buffer_load_dwordx4 v[32:35], v106, s[60:63], s91 offen offset:3072 sc1
    s_add_u32 s91, s10, 131072
    s_waitcnt vmcnt(0)
    s_nop 0
    v_max3_u32 v104, v20, v21, v22
    v_max3_u32 v104, v104, v23, v24
    v_max3_u32 v104, v104, v25, v26
    v_max3_u32 v104, v104, v27, v28
    v_max3_u32 v104, v104, v29, v30
    v_max3_u32 v104, v104, v31, v32
    v_max3_u32 v104, v104, v33, v34
    v_max_u32 v104, v104, v35
    v_cmp_eq_u32 vcc, -1, v104
    s_cbranch_vccz L_ok_z11
    s_sub_u32 s76, s76, 1
    s_cmp_lt_i32 s76, 0
    s_cbranch_scc1 L_ok_z11
    s_sleep 1
    s_branch L_again_z11
L_stub_z12:
L_again_z12:
    s_add_u32 s91, s8, 131072
    buffer_load_dwordx4 v[36:39], v106, s[60:63], s91 offen offset:0 sc1
    buffer_load_dwordx4 v[40:43], v106, s[60:63], s91 offen offset:1024 sc1
    buffer_load_dwordx4 v[44:47], v106, s[60:63], s91 offen offset:2048 sc1
    buffer_load_dwordx4 v[48:51], v106, s[60:63], s91 offen offset:3072 sc1
    s_add_u32 s91, s11, 131072
    s_waitcnt vmcnt(0)
    s_nop 0
    v_max3_u32 v104, v36, v37, v38
    v_max3_u32 v104, v104, v39, v40
    v_max3_u32 v104, v104, v41, v42
    v_max3_u32 v104, v104, v43, v44
    v_max3_u32 v104, v104, v45, v46
    v_max3_u32 v104, v104, v47, v48
    v_max3_u32 v104, v104, v49, v50
    v_max_u32 v104, v104, v51
    v_cmp_eq_u32 vcc, -1, v104
    s_cbranch_vccz L_ok_z12
    s_sub_u32 s76, s76, 1
    s_cmp_lt_i32 s76, 0
    s_cbranch_scc1 L_ok_z12
    s_sleep 1
    s_branch L_again_z12
L_stub_z13:
L_again_z13:
    s_add_u32 s91, s9, 131072
    buffer_load_dwordx4 v[52:55], v106, s[60:63], s91 offen offset:0 sc1
    buffer_load_dwordx4 v[56:59], v106, s[60:63], s91 offen offset:1024 sc1
    buffer_load_dwordx4 v[60:63], v106, s[60:63], s91 offen offset:2048 sc1
    buffer_load_dwordx4 v[64:67], v106, s[60:63], s91 offen offset:3072 sc1
    s_add_u32 s91, s4, 262144
    s_waitcnt vmcnt(0)
    s_nop 0
    v_max3_u32 v104, v52, v53, v54
    v_max3_u32 v104, v104, v55, v56
    v_max3_u32 v104, v104, v57, v58
    v_max3_u32 v104, v104, v59, v60
    v_max3_u32 v104, v104, v61, v62
    v_max3_u32 v104, v104, v63, v64
    v_max3_u32 v104, v104, v65, v66
    v_max_u32 v104, v104, v67
    v_cmp_eq_u32 vcc, -1, v104
    s_cbranch_vccz L_ok_z13
    s_sub_u32 s76, s76, 1
    s_cmp_lt_i32 s76, 0
    s_cbranch_scc1 L_ok_z13
    s_sleep 1
    s_branch L_again_z13
L_stub_z14:
L_again_z14:
    s_add_u32 s91, s10, 131072
    buffer_load_dwordx4 v[68:71], v106, s[60:63], s91 offen offset:0 sc1
    buffer_load_dwordx4 v[72:75], v106, s[60:63], s91 offen offset:1024 sc1
    buffer_load_dwordx4 v[76:79], v106, s[60:63], s91 offen offset:2048 sc1
    buffer_load_dwordx4 v[80:83], v106, s[60:63], s91 offen offset:3072 sc1
    s_add_u32 s91, s5, 262144
    s_waitcnt vmcnt(0)
    s_nop 0
    v_max3_u32 v104, v68, v69, v70
    v_max3_u32 v104, v104, v71, v72
    v_max3_u32 v104, v104, v73, v74
    v_max3_u32 v104, v104, v75, v76
    v_max3_u32 v104, v104, v77, v78
    v_max3_u32 v104, v104, v79, v80
    v_max3_u32 v104, v104, v81, v82
    v_max_u32 v104, v104, v83
    v_cmp_eq_u32 vcc, -1, v104
    s_cbranch_vccz L_ok_z14
    s_sub_u32 s76, s76, 1
    s_cmp_lt_i32 s76, 0
    s_cbranch_scc1 L_ok_z14
    s_sleep 1
    s_branch L_again_z14
L_stub_z15:
L_again_z15:
    s_add_u32 s91, s11, 131072
    buffer_load_dwordx4 v[4:7], v106, s[60:63], s91 offen offset:0 sc1
    buffer_load_dwordx4 v[8:11], v106, s[60:63], s91 offen offset:1024 sc1
    buffer_load_dwordx4 v[12:15], v106, s[60:63], s91 offen offset:2048 sc1
    buffer_load_dwordx4 v[16:19], v106, s[60:63], s91 offen offset:3072 sc1
    s_add_u32 s91, s6, 262144
    s_waitcnt vmcnt(0)
    s_nop 0
    v_max3_u32 v104, v4, v5, v6
    v_max3_u32 v104, v104, v7, v8
    v_max3_u32 v104, v104, v9, v10
    v_max3_u32 v104, v104, v11, v12
    v_max3_u32 v104, v104, v13, v14
    v_max3_u32 v104, v104, v15, v16
    v_max3_u32 v104, v104, v17, v18
    v_max_u32 v104, v104, v19
    v_cmp_eq_u32 vcc, -1, v104
    s_cbranch_vccz L_ok_z15
    s_sub_u32 s76, s76, 1
    s_cmp_lt_i32 s76, 0
    s_cbranch_scc1 L_ok_z15
    s_sleep 1
    s_branch L_again_z15
L_stub_z16:
L_again_z16:
    s_add_u32 s91, s4, 262144
    buffer_load_dwordx4 v[20:23], v106, s[60:63], s91 offen offset:0 sc1
    buffer_load_dwordx4 v[24:27], v106, s[60:63], s91 offen offset:1024 sc1
    buffer_load_dwordx4 v[28:31], v106, s[60:63], s91 offen offset:2048 sc1
    buffer_load_dwordx4 v[32:35], v106, s[60:63], s91 offen offset:3072 sc1
    s_add_u32 s91, s7, 262144
    s_waitcnt vmcnt(0)
    s_nop 0
    v_max3_u32 v104, v20, v21, v22
    v_max3_u32 v104, v104, v23, v24
    v_max3_u32 v104, v104, v25, v26
    v_max3_u32 v104, v104, v27, v28
    v_max3_u32 v104, v104, v29, v30
    v_max3_u32 v104, v104, v31, v32
    v_max3_u32 v104, v104, v33, v34
    v_max_u32 v104, v104, v35
    v_cmp_eq_u32 vcc, -1, v104
    s_cbranch_vccz L_ok_z16
    s_sub_u32 s76, s76, 1
    s_cmp_lt_i32 s76, 0
    s_cbranch_scc1 L_ok_z16
    s_sleep 1
    s_branch L_again_z16
L_stub_z17:
L_again_z17:
    s_add_u32 s91, s5, 262144
    buffer_load_dwordx4 v[36:39], v106, s[60:63], s91 offen offset:0 sc1
    buffer_load_dwordx4 v[40:43], v106, s[60:63], s91 offen offset:1024 sc1
    buffer_load_dwordx4 v[44:47], v106, s[60:63], s91 offen offset:2048 sc1
    buffer_load_dwordx4 v[48:51], v106, s[60:63], s91 offen offset:3072 sc1
    s_add_u32 s91, s8, 262144
    s_waitcnt vmcnt(0)
    s_nop 0
    v_max3_u32 v104, v36, v37, v38
    v_max3_u32 v104, v104, v39, v40
    v_max3_u32 v104, v104, v41, v42
    v_max3_u32 v104, v104, v43, v44
    v_max3_u32 v104, v104, v45, v46
    v_max3_u32 v104, v104, v47, v48
    v_max3_u32 v104, v104, v49, v50
    v_max_u32 v104, v104, v51
    v_cmp_eq_u32 vcc, -1, v104
    s_cbranch_vccz L_ok_z17
    s_sub_u32 s76, s76, 1
    s_cmp_lt_i32 s76, 0
    s_cbranch_scc1 L_ok_z17
    s_sleep 1
    s_branch L_again_z17
L_stub_z18:
L_again_z18:
    s_add_u32 s91, s6, 262144
    buffer_load_dwordx4 v[52:55], v106, s[60:63], s91 offen offset:0 sc1
    buffer_load_dwordx4 v[56:59], v106, s[60:63], s91 offen offset:1024 sc1
    buffer_load_dwordx4 v[60:63], v106, s[60:63], s91 offen offset:2048 sc1
    buffer_load_dwordx4 v[64:67], v106, s[60:63], s91 offen offset:3072 sc1
    s_add_u32 s91, s9, 262144
    s_waitcnt vmcnt(0)
    s_nop 0
    v_max3_u32 v104, v52, v53, v54
    v_max3_u32 v104, v104, v55, v56
    v_max3_u32 v104, v104, v57, v58
    v_max3_u32 v104, v104, v59, v60
    v_max3_u32 v104, v104, v61, v62
    v_max3_u32 v104, v104, v63, v64
    v_max3_u32 v104, v104, v65, v66
    v_max_u32 v104, v104, v67
    v_cmp_eq_u32 vcc, -1, v104
    s_cbranch_vccz L_ok_z18
    s_sub_u32 s76, s76, 1
    s_cmp_lt_i32 s76, 0
    s_cbranch_scc1 L_ok_z18
    s_sleep 1
    s_branch L_again_z18
L_stub_z19:
L_again_z19:
    s_add_u32 s91, s7, 262144
    buffer_load_dwordx4 v[68:71], v106, s[60:63], s91 offen offset:0 sc1
    buffer_load_dwordx4 v[72:75], v106, s[60:63], s91 offen offset:1024 sc1
    buffer_load_dwordx4 v[76:79], v106, s[60:63], s91 offen offset:2048 sc1
    buffer_load_dwordx4 v[80:83], v106, s[60:63], s91 offen offset:3072 sc1
    s_add_u32 s91, s10, 262144
    s_waitcnt vmcnt(0)
    s_nop 0
    v_max3_u32 v104, v68, v69, v70
    v_max3_u32 v104, v104, v71, v72
    v_max3_u32 v104, v104, v73, v74
    v_max3_u32 v104, v104, v75, v76
    v_max3_u32 v104, v104, v77, v78
    v_max3_u32 v104, v104, v79, v80
    v_max3_u32 v104, v104, v81, v82
    v_max_u32 v104, v104, v83
    v_cmp_eq_u32 vcc, -1, v104
    s_cbranch_vccz L_ok_z19
    s_sub_u32 s76, s76, 1
    s_cmp_lt_i32 s76, 0
    s_cbranch_scc1 L_ok_z19
    s_sleep 1
    s_branch L_again_z19
L_stub_z20:
L_again_z20:
    s_add_u32 s91, s8, 262144
    buffer_load_dwordx4 v[4:7], v106, s[60:63], s91 offen offset:0 sc1
    buffer_load_dwordx4 v[8:11], v106, s[60:63], s91 offen offset:1024 sc1
    buffer_load_dwordx4 v[12:15], v106, s[60:63], s91 offen offset:2048 sc1
    buffer_load_dwordx4 v[16:19], v106, s[60:63], s91 offen offset:3072 sc1
    s_add_u32 s91, s11, 262144
    s_waitcnt vmcnt(0)
    s_nop 0
    v_max3_u32 v104, v4, v5, v6
    v_max3_u32 v104, v104, v7, v8
    v_max3_u32 v104, v104, v9, v10
    v_max3_u32 v104, v104, v11, v12
    v_max3_u32 v104, v104, v13, v14
    v_max3_u32 v104, v104, v15, v16
    v_max3_u32 v104, v104, v17, v18
    v_max_u32 v104, v104, v19
    v_cmp_eq_u32 vcc, -1, v104
    s_cbranch_vccz L_ok_z20
    s_sub_u32 s76, s76, 1
    s_cmp_lt_i32 s76, 0
    s_cbranch_scc1 L_ok_z20
    s_sleep 1
    s_branch L_again_z20
L_stub_z21:
L_again_z21:
    s_add_u32 s91, s9, 262144
    buffer_load_dwordx4 v[20:23], v106, s[60:63], s91 offen offset:0 sc1
    buffer_load_dwordx4 v[24:27], v106, s[60:63], s91 offen offset:1024 sc1
    buffer_load_dwordx4 v[28:31], v106, s[60:63], s91 offen offset:2048 sc1
    buffer_load_dwordx4 v[32:35], v106, s[60:63], s91 offen offset:3072 sc1
    s_add_u32 s91, s11, 262144
    s_waitcnt vmcnt(0)
    s_nop 0
    v_max3_u32 v104, v20, v21, v22
    v_max3_u32 v104, v104, v23, v24
    v_max3_u32 v104, v104, v25, v26
    v_max3_u32 v104, v104, v27, v28
    v_max3_u32 v104, v104, v29, v30
    v_max3_u32 v104, v104, v31, v32
    v_max3_u32 v104, v104, v33, v34
    v_max_u32 v104, v104, v35
    v_cmp_eq_u32 vcc, -1, v104
    s_cbranch_vccz L_ok_z21
    s_sub_u32 s76, s76, 1
    s_cmp_lt_i32 s76, 0
    s_cbranch_scc1 L_ok_z21
    s_sleep 1
    s_branch L_again_z21
L_stub_z22:
L_again_z22:
    s_add_u32 s91, s10, 262144
    buffer_load_dwordx4 v[36:39], v106, s[60:63], s91 offen offset:0 sc1
    buffer_load_dwordx4 v[40:43], v106, s[60:63], s91 offen offset:1024 sc1
    buffer_load_dwordx4 v[44:47], v106, s[60:63], s91 offen offset:2048 sc1
    buffer_load_dwordx4 v[48:51], v106, s[60:63], s91 offen offset:3072 sc1
    s_add_u32 s91, s11, 262144
    s_waitcnt vmcnt(0)
    s_nop 0
    v_max3_u32 v104, v36, v37, v38
    v_max3_u32 v104, v104, v39, v40
    v_max3_u32 v104, v104, v41, v42
    v_max3_u32 v104, v104, v43, v44
    v_max3_u32 v104, v104, v45, v46
    v_max3_u32 v104, v104, v47, v48
    v_max3_u32 v104, v104, v49, v50
    v_max_u32 v104, v104, v51
    v_cmp_eq_u32 vcc, -1, v104
    s_cbranch_vccz L_ok_z22
    s_sub_u32 s76, s76, 1
    s_cmp_lt_i32 s76, 0
    s_cbranch_scc1 L_ok_z22
    s_sleep 1
    s_branch L_again_z22
L_stub_z23:
L_again_z23:
    s_add_u32 s91, s11, 262144
    buffer_load_dwordx4 v[52:55], v106, s[60:63], s91 offen offset:0 sc1
    buffer_load_dwordx4 v[56:59], v106, s[60:63], s91 offen offset:1024 sc1
    buffer_load_dwordx4 v[60:63], v106, s[60:63], s91 offen offset:2048 sc1
    buffer_load_dwordx4 v[64:67], v106, s[60:63], s91 offen offset:3072 sc1
    s_add_u32 s91, s11, 262144
    s_waitcnt vmcnt(0)
    s_nop 0
    v_max3_u32 v104, v52, v53, v54
    v_max3_u32 v104, v104, v55, v56
    v_max3_u32 v104, v104, v57, v58
    v_max3_u32 v104, v104, v59, v60
    v_max3_u32 v104, v104, v61, v62
    v_max3_u32 v104, v104, v63, v64
    v_max3_u32 v104, v104, v65, v66
    v_max_u32 v104, v104, v67
    v_cmp_eq_u32 vcc, -1, v104
    s_cbranch_vccz L_ok_z23
    s_sub_u32 s76, s76, 1
    s_cmp_lt_i32 s76, 0
    s_cbranch_scc1 L_ok_z23
    s_sleep 1
    s_branch L_again_z23
L_stub_pf:
L_again_pf:
    buffer_load_dword v108, v107, s[60:63], s23 offen sc1
    s_waitcnt vmcnt(0)
    v_xor_b32 v110, v108, v2
    v_cmp_ne_u32 vcc, 0, v110
    s_cbranch_vccz L_ok_pf
    s_sub_u32 s76, s76, 1
    s_cmp_lt_i32 s76, 0
    s_cbranch_scc1 L_ok_pf
    s_sleep 1
    s_branch L_again_pf
L_stub_p0:
L_again_p0:
    s_add_u32 s3, s17, 0
    buffer_load_dwordx4 v[68:71], v106, s[60:63], s3 offen offset:0 sc1
    buffer_load_dwordx4 v[72:75], v106, s[60:63], s3 offen offset:1024 sc1
    buffer_load_dwordx4 v[76:79], v106, s[60:63], s3 offen offset:2048 sc1
    buffer_load_dwordx4 v[80:83], v106, s[60:63], s3 offen offset:3072 sc1
    s_waitcnt vmcnt(0)
    s_nop 0
    v_max3_u32 v110, v68, v69, v70
    v_max3_u32 v110, v110, v71, v72
    v_max3_u32 v110, v110, v73, v74
    v_max3_u32 v110, v110, v75, v76
    v_max3_u32 v110, v110, v77, v78
    v_max3_u32 v110, v110, v79, v80
    v_max3_u32 v110, v110, v81, v82
    v_max_u32 v110, v110, v83
    v_cmp_eq_u32 vcc, -1, v110
    s_cbranch_vccz L_ok_p0
    s_sub_u32 s76, s76, 1
    s_cmp_lt_i32 s76, 0
    s_cbranch_scc1 L_ok_p0
    s_sleep 1
    s_branch L_again_p0
L_stub_p1:
L_again_p1:
    s_add_u32 s3, s17, 4096
    buffer_load_dwordx4 v[4:7], v106, s[60:63], s3 offen offset:0 sc1
    buffer_load_dwordx4 v[8:11], v106, s[60:63], s3 offen offset:1024 sc1
    buffer_load_dwordx4 v[12:15], v106, s[60:63], s3 offen offset:2048 sc1
    buffer_load_dwordx4 v[16:19], v106, s[60:63], s3 offen offset:3072 sc1
    s_waitcnt vmcnt(0)
    s_nop 0
    v_max3_u32 v110, v4, v5, v6
    v_max3_u32 v110, v110, v7, v8
    v_max3_u32 v110, v110, v9, v10
    v_max3_u32 v110, v110, v11, v12
    v_max3_u32 v110, v110, v13, v14
    v_max3_u32 v110, v110, v15, v16
    v_max3_u32 v110, v110, v17, v18
    v_max_u32 v110, v110, v19
    v_cmp_eq_u32 vcc, -1, v110
    s_cbranch_vccz L_ok_p1
    s_sub_u32 s76, s76, 1
    s_cmp_lt_i32 s76, 0
    s_cbranch_scc1 L_ok_p1
    s_sleep 1
    s_branch L_again_p1
L_stub_p2:
L_again_p2:
    s_add_u32 s3, s17, 8192
    buffer_load_dwordx4 v[20:23], v106, s[60:63], s3 offen offset:0 sc1
    buffer_load_dwordx4 v[24:27], v106, s[60:63], s3 offen offset:1024 sc1
    buffer_load_dwordx4 v[28:31], v106, s[60:63], s3 offen offset:2048 sc1
    buffer_load_dwordx4 v[32:35], v106, s[60:63], s3 offen offset:3072 sc1
    s_waitcnt vmcnt(0)
    s_nop 0
    v_max3_u32 v110, v20, v21, v22
    v_max3_u32 v110, v110, v23, v24
    v_max3_u32 v110, v110, v25, v26
    v_max3_u32 v110, v110, v27, v28
    v_max3_u32 v110, v110, v29, v30
    v_max3_u32 v110, v110, v31, v32
    v_max3_u32 v110, v110, v33, v34
    v_max_u32 v110, v110, v35
    v_cmp_eq_u32 vcc, -1, v110
    s_cbranch_vccz L_ok_p2
    s_sub_u32 s76, s76, 1
    s_cmp_lt_i32 s76, 0
    s_cbranch_scc1 L_ok_p2
    s_sleep 1
    s_branch L_again_p2
L_stub_p3:
L_again_p3:
    s_add_u32 s3, s17, 12288
    buffer_load_dwordx4 v[36:39], v106, s[60:63], s3 offen offset:0 sc1
    buffer_load_dwordx4 v[40:43], v106, s[60:63], s3 offen offset:1024 sc1
    buffer_load_dwordx4 v[44:47], v106, s[60:63], s3 offen offset:2048 sc1
    buffer_load_dwordx4 v[48:51], v106, s[60:63], s3 offen offset:3072 sc1
    s_waitcnt vmcnt(0)
    s_nop 0
    v_max3_u32 v110, v36, v37, v38
    v_max3_u32 v110, v110, v39, v40
    v_max3_u32 v110, v110, v41, v42
    v_max3_u32 v110, v110, v43, v44
    v_max3_u32 v110, v110, v45, v46
    v_max3_u32 v110, v110, v47, v48
    v_max3_u32 v110, v110, v49, v50
    v_max_u32 v110, v110, v51
    v_cmp_eq_u32 vcc, -1, v110
    s_cbranch_vccz L_ok_p3
    s_sub_u32 s76, s76, 1
    s_cmp_lt_i32 s76, 0
    s_cbranch_scc1 L_ok_p3
    s_sleep 1
    s_branch L_again_p3
L_stub_p4:
L_again_p4:
    s_add_u32 s3, s17, 16384
    buffer_load_dwordx4 v[52:55], v106, s[60:63], s3 offen offset:0 sc1
    buffer_load_dwordx4 v[56:59], v106, s[60:63], s3 offen offset:1024 sc1
    buffer_load_dwordx4 v[60:63], v106, s[60:63], s3 offen offset:2048 sc1
    buffer_load_dwordx4 v[64:67], v106, s[60:63], s3 offen offset:3072 sc1
    s_waitcnt vmcnt(0)
    s_nop 0
    v_max3_u32 v110, v52, v53, v54
    v_max3_u32 v110, v110, v55, v56
    v_max3_u32 v110, v110, v57, v58
    v_max3_u32 v110, v110, v59, v60
    v_max3_u32 v110, v110, v61, v62
    v_max3_u32 v110, v110, v63, v64
    v_max3_u32 v110, v110, v65, v66
    v_max_u32 v110, v110, v67
    v_cmp_eq_u32 vcc, -1, v110
    s_cbranch_vccz L_ok_p4
    s_sub_u32 s76, s76, 1
    s_cmp_lt_i32 s76, 0
    s_cbranch_scc1 L_ok_p4
    s_sleep 1
    s_branch L_again_p4
L_stub_p5:
L_again_p5:
    s_add_u32 s3, s17, 20480
    buffer_load_dwordx4 v[84:87], v106, s[60:63], s3 offen offset:0 sc1
    buffer_load_dwordx4 v[88:91], v106, s[60:63], s3 offen offset:1024 sc1
    buffer_load_dwordx4 v[92:95], v106, s[60:63], s3 offen offset:2048 sc1
    buffer_load_dwordx4 v[96:99], v106, s[60:63], s3 offen offset:3072 sc1
    s_waitcnt vmcnt(0)
    s_nop 0
    v_max3_u32 v110, v84, v85, v86
    v_max3_u32 v110, v110, v87, v88
    v_max3_u32 v110, v110, v89, v90
    v_max3_u32 v110, v110, v91, v92
    v_max3_u32 v110, v110, v93, v94
    v_max3_u32 v110, v110, v95, v96
    v_max3_u32 v110, v110, v97, v98
    v_max_u32 v110, v110, v99
    v_cmp_eq_u32 vcc, -1, v110
    s_cbranch_vccz L_ok_p5
    s_sub_u32 s76, s76, 1
    s_cmp_lt_i32 s76, 0
    s_cbranch_scc1 L_ok_p5
    s_sleep 1
    s_branch L_again_p5
L_stub_flgha:
L_again_flgha:
    buffer_load_dword v4, v107, s[60:63], 0 offen sc1
    s_waitcnt vmcnt(0)
    v_xor_b32 v126, v4, v2
    v_cmp_ne_u32 vcc, 0, v126
    s_cbranch_vccz L_ok_flgha
    s_sub_u32 s76, s76, 1
    s_cmp_lt_i32 s76, 0
    s_cbranch_scc1 L_ok_flgha
    s_sleep 8
    s_branch L_again_flgha
L_stub_flghb:
L_again_flghb:
    buffer_load_dword v4, v107, s[60:63], 0 offen sc1
    s_waitcnt vmcnt(0)
    v_xor_b32 v126, v4, v2
    v_cmp_ne_u32 vcc, 0, v126
    s_cbranch_vccz L_ok_flghb
    s_sub_u32 s76, s76, 1
    s_cmp_lt_i32 s76, 0
    s_cbranch_scc1 L_ok_flghb
    s_sleep 8
    s_branch L_again_flghb
L_helper:
    s_cmp_ge_u32 s66, 8
    s_cbranch_scc1 L_nostat
    s_lshl_b32 s72, s65, 3
    s_add_u32 s84, s72, s66
    s_lshl_b32 s72, s84, 2
    s_add_u32 s75, s72, s64
    s_mul_i32 s78, s75, 10240
    v_lshrrev_b32 v112, 3, v1
    v_mul_u32_u24 v113, 1280, v112
    v_and_b32 v114, 7, v1
    v_lshl_add_u32 v113, v114, 4, v113
    s_waitcnt lgkmcnt(0)
    s_mov_b64 s[40:41], s[4:5]
    s_mov_b32 s42, 2621440
    s_mov_b32 s43, 0x20000
    buffer_load_dwordx4 v[160:163], v113, s[40:43], s78 offen offset:0
    buffer_load_dwordx4 v[164:167], v113, s[40:43], s78 offen offset:128
    buffer_load_dwordx4 v[168:171], v113, s[40:43], s78 offen offset:256
    buffer_load_dwordx4 v[172:175], v113, s[40:43], s78 offen offset:384
    buffer_load_dwordx4 v[176:179], v113, s[40:43], s78 offen offset:512
    buffer_load_dwordx4 v[180:183], v113, s[40:43], s78 offen offset:640
    buffer_load_dwordx4 v[184:187], v113, s[40:43], s78 offen offset:768
    buffer_load_dwordx4 v[188:191], v113, s[40:43], s78 offen offset:896
    buffer_load_dwordx4 v[192:195], v113, s[40:43], s78 offen offset:1024
    buffer_load_dwordx4 v[196:199], v113, s[40:43], s78 offen offset:1152
    s_mov_b64 s[60:61], s[36:37]
    s_mov_b32 s62, 33554432
    s_mov_b32 s63, 0x20000
    v_mov_b32 v2, 0
    buffer_load_dword v2, v2, s[60:63], 0 offen sc1
    s_min_u32 s72, s84, 59
    s_mul_i32 s82, s72, 10923
    s_lshr_b32 s82, s82, 16
    s_mul_i32 s73, s82, 6
    s_sub_u32 s83, s72, s73
    s_lshl_b32 s75, s75, 6
    s_add_u32 s75, s75, 16384
    v_lshlrev_b32 v112, 3, v112
    v_lshrrev_b32 v116, 3, v1
    v_and_b32 v117, 6, v116
    v_and_b32 v118, 7, v1
    v_xor_b32 v117, v117, v118
    v_mul_u32_u24 v116, 1280, v116
    v_lshl_add_u32 v116, v117, 4, v116
    s_lshl_b32 s72, s83, 2
    s_add_u32 s72, s72, s64
    s_mul_i32 s85, s72, 40960
    s_lshl_b32 s72, s82, 7
    s_add_u32 s85, s85, s72
    s_mul_i32 s86, s64, 4096
    v_mov_b32 v3, 0
    s_lshr_b32 s72, s65, 1
    s_lshl_b32 s72, s72, 3
    s_and_b32 s73, s66, 7
    s_add_u32 s67, s72, s73
    s_and_b32 s72, s65, 1
    s_lshl_b32 s72, s72, 2
    s_lshr_b32 s73, s66, 3
    s_add_u32 s68, s72, s73
    s_lshl_b32 s72, s65, 2
    s_and_b32 s73, s66, 3
    s_add_u32 s69, s72, s73
    s_lshr_b32 s70, s66, 2
    s_mov_b32 s69, s67
    s_mov_b32 s70, s68
    s_nop 0
    s_mul_i32 s71, s64, 18432
    s_mul_i32 s95, s64, 22528
    s_add_u32 s95, s95, 73728
    s_mov_b32 s76, 65536
    s_mov_b32 s90, 0x3f803f80
    v_lshlrev_b32 v109, 4, v0
    s_sub_u32 s48, s26, 4096
    s_subb_u32 s49, s27, 0
    s_mov_b32 s50, 8392704
    s_mov_b32 s51, 0x20000
    s_mov_b64 s[56:57], s[32:33]
    s_mov_b32 s58, 2621440
    s_mov_b32 s59, 0x20000
    v_and_b32 v92, 7, v1
    v_bfe_u32 v91, v1, 3, 1
    v_lshl_add_u32 v92, v92, 1, v91
    s_lshl_b32 s72, s67, 2
    s_add_u32 s72, s72, s64
    s_lshl_b32 s72, s72, 5
    v_lshl_add_u32 v92, v92, 1, s72
    global_load_ushort v92, v92, s[28:29]
    v_lshrrev_b32 v120, 3, v1
    v_and_b32 v121, 7, v1
    v_lshrrev_b32 v122, 1, v120
    v_xor_b32 v121, v121, v122
    v_lshlrev_b32 v121, 4, v121
    v_lshl_add_u32 v122, v120, 12, v121
    v_xor_b32 v123, 64, v122
    s_mul_i32 s77, s67, 262144
    s_lshl_b32 s72, s64, 10
    s_add_u32 s77, s77, s72
    v_add_u32 v122, s77, v122
    s_add_u32 s77, s77, 31744
    v_add_u32 v123, s77, v123
    s_add_u32 s72, s64, 0
    s_and_b32 s72, s72, 3
    s_lshl_b32 s72, s72, 16
    s_add_u32 s72, s72, 4096
    v_add_u32 v100, s72, v122
    v_add_u32 v101, s72, v123
    s_add_u32 s72, s64, 1
    s_and_b32 s72, s72, 3
    s_lshl_b32 s72, s72, 16
    s_add_u32 s72, s72, 2048
    v_add_u32 v102, s72, v122
    v_add_u32 v103, s72, v123
    s_add_u32 s72, s64, 2
    s_and_b32 s72, s72, 3
    s_lshl_b32 s72, s72, 16
    s_add_u32 s72, s72, 4096
    v_add_u32 v70, s72, v122
    v_add_u32 v71, s72, v123
    s_add_u32 s72, s64, 3
    s_and_b32 s72, s72, 3
    s_lshl_b32 s72, s72, 16
    s_add_u32 s72, s72, 2048
    v_add_u32 v72, s72, v122
    v_add_u32 v73, s72, v123
    v_and_b32 v120, 7, v1
    v_lshrrev_b32 v121, 4, v1
    v_xor_b32 v121, v121, v120
    v_lshlrev_b32 v121, 4, v121
    v_lshl_add_u32 v121, v120, 8, v121
    v_and_b32 v120, 8, v1
    v_lshl_add_u32 v121, v120, 4, v121
    v_xor_b32 v122, 64, v121
    v_add_u32 v104, s95, v121
    v_add_u32 v105, s95, v122
    s_lshl_b32 s99, s67, 3
    s_and_b32 s72, s68, 4
    s_add_u32 s99, s99, s72
    s_and_b32 s99, s99, 7
    s_lshl_b32 s98, s99, 7
    v_lshlrev_b32 v106, 4, v1
    s_mul_i32 s72, s68, 3
    s_lshr_b32 s72, s72, 1
    v_and_b32 v107, 2, v1
    v_mad_u32_u24 v107, v107, 5, s72
    s_mul_i32 s72, s64, 24
    s_sub_u32 s72, s72, 4
    v_mov_b32 v108, s72
    s_mov_b64 vcc, 15
    v_cndmask_b32 v107, v108, v107, vcc
    v_min_u32 v108, 27, v1
    v_add_lshl_u32 v107, v107, v108, 7
    v_add_u32 v107, 4096, v107
    s_add_u32 m0, s95, 0
    s_nop 0
    buffer_load_dwordx4 v100, s[48:51], s98 offen offset:0 lds
    buffer_load_dwordx4 v101, s[48:51], s98 offen offset:1024 lds
    buffer_load_dwordx4 v102, s[48:51], s98 offen offset:2048 lds
    buffer_load_dwordx4 v103, s[48:51], s98 offen offset:3072 lds
    s_add_u32 m0, s95, 4096
    s_nop 0
    s_nop 0
    buffer_load_dwordx4 v70, s[48:51], s98 offen offset:0 lds
    buffer_load_dwordx4 v71, s[48:51], s98 offen offset:1024 lds
    buffer_load_dwordx4 v72, s[48:51], s98 offen offset:2048 lds
    buffer_load_dwordx4 v73, s[48:51], s98 offen offset:3072 lds
    s_add_u32 s98, s98, 128
    s_and_b32 s98, s98, 1023
    s_waitcnt vmcnt(18)
    s_nop 0
    v_dot2_f32_bf16 v8, v160, s90, 0
    v_dot2_f32_bf16 v10, v160, v160, 0
    v_dot2_f32_bf16 v9, v161, s90, 0
    v_dot2_f32_bf16 v11, v161, v161, 0
    v_dot2_f32_bf16 v8, v162, s90, v8
    v_dot2_f32_bf16 v10, v162, v162, v10
    v_dot2_f32_bf16 v9, v163, s90, v9
    v_dot2_f32_bf16 v11, v163, v163, v11
    v_dot2_f32_bf16 v8, v164, s90, v8
    v_dot2_f32_bf16 v10, v164, v164, v10
    v_dot2_f32_bf16 v9, v165, s90, v9
    v_dot2_f32_bf16 v11, v165, v165, v11
    v_dot2_f32_bf16 v8, v166, s90, v8
    v_dot2_f32_bf16 v10, v166, v166, v10
    v_dot2_f32_bf16 v9, v167, s90, v9
    v_dot2_f32_bf16 v11, v167, v167, v11
    s_waitcnt vmcnt(16)
    s_nop 0
    v_dot2_f32_bf16 v8, v168, s90, v8
    v_dot2_f32_bf16 v10, v168, v168, v10
    v_dot2_f32_bf16 v9, v169, s90, v9
    v_dot2_f32_bf16 v11, v169, v169, v11
    v_dot2_f32_bf16 v8, v170, s90, v8
    v_dot2_f32_bf16 v10, v170, v170, v10
    v_dot2_f32_bf16 v9, v171, s90, v9
    v_dot2_f32_bf16 v11, v171, v171, v11
    v_dot2_f32_bf16 v8, v172, s90, v8
    v_dot2_f32_bf16 v10, v172, v172, v10
    v_dot2_f32_bf16 v9, v173, s90, v9
    v_dot2_f32_bf16 v11, v173, v173, v11
    v_dot2_f32_bf16 v8, v174, s90, v8
    v_dot2_f32_bf16 v10, v174, v174, v10
    v_dot2_f32_bf16 v9, v175, s90, v9
    v_dot2_f32_bf16 v11, v175, v175, v11
    s_waitcnt vmcnt(14)
    s_nop 0
    v_dot2_f32_bf16 v8, v176, s90, v8
    v_dot2_f32_bf16 v10, v176, v176, v10
    v_dot2_f32_bf16 v9, v177, s90, v9
    v_dot2_f32_bf16 v11, v177, v177, v11
    v_dot2_f32_bf16 v8, v178, s90, v8
    v_dot2_f32_bf16 v10, v178, v178, v10
    v_dot2_f32_bf16 v9, v179, s90, v9
    v_dot2_f32_bf16 v11, v179, v179, v11
    v_dot2_f32_bf16 v8, v180, s90, v8
    v_dot2_f32_bf16 v10, v180, v180, v10
    v_dot2_f32_bf16 v9, v181, s90, v9
    v_dot2_f32_bf16 v11, v181, v181, v11
    v_dot2_f32_bf16 v8, v182, s90, v8
    v_dot2_f32_bf16 v10, v182, v182, v10
    v_dot2_f32_bf16 v9, v183, s90, v9
    v_dot2_f32_bf16 v11, v183, v183, v11
    s_waitcnt vmcnt(12)
    s_nop 0
    v_dot2_f32_bf16 v8, v184, s90, v8
    v_dot2_f32_bf16 v10, v184, v184, v10
    v_dot2_f32_bf16 v9, v185, s90, v9
    v_dot2_f32_bf16 v11, v185, v185, v11
    v_dot2_f32_bf16 v8, v186, s90, v8
    v_dot2_f32_bf16 v10, v186, v186, v10
    v_dot2_f32_bf16 v9, v187, s90, v9
    v_dot2_f32_bf16 v11, v187, v187, v11
    v_dot2_f32_bf16 v8, v188, s90, v8
    v_dot2_f32_bf16 v10, v188, v188, v10
    v_dot2_f32_bf16 v9, v189, s90, v9
    v_dot2_f32_bf16 v11, v189, v189, v11
    v_dot2_f32_bf16 v8, v190, s90, v8
    v_dot2_f32_bf16 v10, v190, v190, v10
    v_dot2_f32_bf16 v9, v191, s90, v9
    v_dot2_f32_bf16 v11, v191, v191, v11
    s_waitcnt vmcnt(10)
    s_nop 0
    v_dot2_f32_bf16 v8, v192, s90, v8
    v_dot2_f32_bf16 v10, v192, v192, v10
    v_dot2_f32_bf16 v9, v193, s90, v9
    v_dot2_f32_bf16 v11, v193, v193, v11
    v_dot2_f32_bf16 v8, v194, s90, v8
    v_dot2_f32_bf16 v10, v194, v194, v10
    v_dot2_f32_bf16 v9, v195, s90, v9
    v_dot2_f32_bf16 v11, v195, v195, v11
    v_dot2_f32_bf16 v8, v196, s90, v8
    v_dot2_f32_bf16 v10, v196, v196, v10
    v_dot2_f32_bf16 v9, v197, s90, v9
    v_dot2_f32_bf16 v11, v197, v197, v11
    v_dot2_f32_bf16 v8, v198, s90, v8
    v_dot2_f32_bf16 v10, v198, v198, v10
    v_dot2_f32_bf16 v9, v199, s90, v9
    v_dot2_f32_bf16 v11, v199, v199, v11
    s_waitcnt vmcnt(9)
    v_add_u32 v2, 2654435761, v2
    v_add_f32 v8, v8, v9
    v_add_f32 v9, v10, v11
    s_nop 0
    v_add_f32_dpp v8, v8, v8 quad_perm:[1,0,3,2] row_mask:0xf bank_mask:0xf
    v_add_f32_dpp v9, v9, v9 quad_perm:[1,0,3,2] row_mask:0xf bank_mask:0xf
    s_nop 0
    v_add_f32_dpp v8, v8, v8 quad_perm:[2,3,0,1] row_mask:0xf bank_mask:0xf
    v_add_f32_dpp v9, v9, v9 quad_perm:[2,3,0,1] row_mask:0xf bank_mask:0xf
    s_nop 0
    v_add_f32_dpp v8, v8, v8 row_half_mirror row_mask:0xf bank_mask:0xf
    v_add_f32_dpp v9, v9, v9 row_half_mirror row_mask:0xf bank_mask:0xf
    v_mul_f32 v8, 0x3acccccd, v8
    v_mul_f32 v9, 0x3acccccd, v9
    v_fma_f32 v9, -v8, v8, v9
    v_max_f32 v9, 0, v9
    v_cvt_pk_bf16_f32 v9, 0, v9
    v_add_f32 v9, 0x3727c5ac, v9
    v_cvt_pk_bf16_f32 v9, 0, v9
    v_sqrt_f32 v9, v9
    v_mov_b32 v11, v2
    v_cvt_pk_bf16_f32 v10, v8, v9
    s_mov_b32 exec_lo, 0x01010101
    s_mov_b32 exec_hi, 0x01010101
    buffer_store_dwordx2 v[10:11], v112, s[60:63], s75 offen sc1
    s_mov_b64 exec, -1
    s_add_u32 m0, s95, 8192
    s_nop 0
    s_nop 0
    buffer_load_dwordx4 v100, s[48:51], s98 offen offset:0 lds
    buffer_load_dwordx4 v101, s[48:51], s98 offen offset:1024 lds
    buffer_load_dwordx4 v102, s[48:51], s98 offen offset:2048 lds
    buffer_load_dwordx4 v103, s[48:51], s98 offen offset:3072 lds
    s_add_u32 m0, s95, 12288
    s_nop 0
    s_nop 0
    buffer_load_dwordx4 v70, s[48:51], s98 offen offset:0 lds
    buffer_load_dwordx4 v71, s[48:51], s98 offen offset:1024 lds
    buffer_load_dwordx4 v72, s[48:51], s98 offen offset:2048 lds
    buffer_load_dwordx4 v73, s[48:51], s98 offen offset:3072 lds
    s_add_u32 s98, s98, 128
    s_and_b32 s98, s98, 1023
    s_mov_b64 s[52:53], s[30:31]
    s_mov_b32 s54, 983040
    s_mov_b32 s55, 0x20000
    s_add_u32 m0, s86, 0
    s_nop 0
    s_nop 0
    buffer_load_dwordx4 v116, s[52:55], s85 offen lds
    s_add_u32 m0, s86, 1024
    s_add_u32 s85, s85, 10240
    buffer_load_dwordx4 v116, s[52:55], s85 offen lds
    s_add_u32 m0, s86, 2048
    s_add_u32 s85, s85, 10240
    buffer_load_dwordx4 v116, s[52:55], s85 offen lds
    s_add_u32 m0, s86, 3072
    s_add_u32 s85, s85, 10240
    buffer_load_dwordx4 v116, s[52:55], s85 offen lds
    s_waitcnt vmcnt(19)
    ds_read_b128 a[0:3], v104 offset:0
    ds_read_b128 a[4:7], v105 offset:0
    s_waitcnt vmcnt(17)
    ds_read_b128 a[64:67], v104 offset:2048
    ds_read_b128 a[68:71], v105 offset:2048
    s_add_u32 m0, s95, 0
    s_waitcnt lgkmcnt(2)
    buffer_load_dwordx4 v100, s[48:51], s98 offen offset:0 lds
    s_waitcnt vmcnt(16)
    ds_read_b128 a[128:131], v104 offset:4096
    buffer_load_dwordx4 v101, s[48:51], s98 offen offset:1024 lds
    ds_read_b128 a[132:135], v105 offset:4096
    s_waitcnt lgkmcnt(2)
    buffer_load_dwordx4 v102, s[48:51], s98 offen offset:2048 lds
    s_waitcnt vmcnt(16)
    ds_read_b128 a[192:195], v104 offset:6144
    buffer_load_dwordx4 v103, s[48:51], s98 offen offset:3072 lds
    ds_read_b128 a[196:199], v105 offset:6144
    s_add_u32 m0, s95, 4096
    s_waitcnt lgkmcnt(2)
    buffer_load_dwordx4 v70, s[48:51], s98 offen offset:0 lds
    s_waitcnt vmcnt(15)
    ds_read_b128 a[8:11], v104 offset:8192
    buffer_load_dwordx4 v71, s[48:51], s98 offen offset:1024 lds
    ds_read_b128 a[12:15], v105 offset:8192
    s_waitcnt lgkmcnt(2)
    buffer_load_dwordx4 v72, s[48:51], s98 offen offset:2048 lds
    s_waitcnt vmcnt(15)
    s_nop 0
    ds_read_b128 a[72:75], v104 offset:10240
    buffer_load_dwordx4 v73, s[48:51], s98 offen offset:3072 lds
    s_add_u32 s98, s98, 128
    s_and_b32 s98, s98, 1023
    ds_read_b128 a[76:79], v105 offset:10240
    s_add_u32 m0, s95, 8192
    s_waitcnt lgkmcnt(2)
    buffer_load_dwordx4 v100, s[48:51], s98 offen offset:0 lds
    s_waitcnt vmcnt(15)
    ds_read_b128 a[136:139], v104 offset:12288
    buffer_load_dwordx4 v101, s[48:51], s98 offen offset:1024 lds
    ds_read_b128 a[140:143], v105 offset:12288
    s_waitcnt lgkmcnt(2)
    buffer_load_dwordx4 v102, s[48:51], s98 offen offset:2048 lds
    s_waitcnt vmcnt(15)
    ds_read_b128 a[200:203], v104 offset:14336
    buffer_load_dwordx4 v103, s[48:51], s98 offen offset:3072 lds
    ds_read_b128 a[204:207], v105 offset:14336
    s_add_u32 m0, s95, 12288
    s_waitcnt lgkmcnt(2)
    buffer_load_dwordx4 v70, s[48:51], s98 offen offset:0 lds
    v_lshrrev_b32 v117, 2, v1
    v_lshlrev_b32 v118, 7, v117
    v_and_b32 v119, 3, v1
    v_lshl_add_u32 v118, v119, 3, v118
    v_bfe_u32 v117, v117, 1, 2
    v_xor_b32 v117, s64, v117
    v_lshl_add_u32 v48, v117, 5, v118
    v_add_u32 v49, 40960, v48
    s_lshl_b32 s72, s82, 2
    s_add_u32 s74, s72, s64
    s_mul_i32 s78, s74, 13108
    s_lshr_b32 s78, s78, 16
    s_mul_i32 s78, s78, 117760
    s_lshl_b32 s72, s74, 10
    s_add_u32 s78, s78, s72
    s_mul_i32 s72, s83, 20480
    s_add_u32 s78, s78, s72
    s_add_u32 s78, s78, 12189696
    s_waitcnt vmcnt(13)
    s_barrier
    s_nop 0
    ds_read_b64_tr_b16 v[128:129], v48 offset:0
    ds_read_b64_tr_b16 v[130:131], v48 offset:2048
    ds_read_b64_tr_b16 v[132:133], v48 offset:4096
    ds_read_b64_tr_b16 v[134:135], v48 offset:6144
    ds_read_b64_tr_b16 v[136:137], v48 offset:8192
    ds_read_b64_tr_b16 v[138:139], v48 offset:10240
    ds_read_b64_tr_b16 v[140:141], v48 offset:12288
    ds_read_b64_tr_b16 v[142:143], v48 offset:14336
    s_waitcnt lgkmcnt(6)
    buffer_store_dwordx4 v[128:131], v106, s[60:63], s78 offen sc1
    s_add_u32 s78, s78, 5120
    s_waitcnt lgkmcnt(4)
    buffer_store_dwordx4 v[132:135], v106, s[60:63], s78 offen sc1
    s_add_u32 s78, s78, 5120
    s_waitcnt lgkmcnt(2)
    buffer_store_dwordx4 v[136:139], v106, s[60:63], s78 offen sc1
    s_add_u32 s78, s78, 5120
    s_waitcnt lgkmcnt(0)
    buffer_store_dwordx4 v[140:143], v106, s[60:63], s78 offen sc1
    s_mul_i32 s87, s84, 20480
    s_add_u32 s87, s87, 1048576
    v_mov_b32 v52, -1
    v_mov_b32 v53, -1
    v_mov_b32 v54, -1
    v_mov_b32 v55, -1
    buffer_store_dwordx4 v[52:55], v109, s[60:63], s87 offen sc1
    s_add_u32 s87, s87, 4096
    buffer_store_dwordx4 v[52:55], v109, s[60:63], s87 offen sc1
    s_add_u32 s87, s87, 4096
    buffer_store_dwordx4 v[52:55], v109, s[60:63], s87 offen sc1
    s_add_u32 s87, s87, 4096
    buffer_store_dwordx4 v[52:55], v109, s[60:63], s87 offen sc1
    s_add_u32 s87, s87, 4096
    buffer_store_dwordx4 v[52:55], v109, s[60:63], s87 offen sc1
    s_add_u32 s84, s84, 32
    s_waitcnt vmcnt(20)
    ds_read_b128 a[16:19], v104 offset:0
    buffer_load_dwordx4 v71, s[48:51], s98 offen offset:1024 lds
    ds_read_b128 a[20:23], v105 offset:0
    buffer_load_dwordx4 v72, s[48:51], s98 offen offset:2048 lds
    s_waitcnt vmcnt(20)
    s_nop 0
    ds_read_b128 a[80:83], v104 offset:2048
    buffer_load_dwordx4 v73, s[48:51], s98 offen offset:3072 lds
    s_add_u32 s98, s98, 128
    s_and_b32 s98, s98, 1023
    ds_read_b128 a[84:87], v105 offset:2048
    s_add_u32 m0, s95, 0
    s_waitcnt lgkmcnt(2)
    buffer_load_dwordx4 v100, s[48:51], s98 offen offset:0 lds
    s_waitcnt vmcnt(20)
    ds_read_b128 a[144:147], v104 offset:4096
    buffer_load_dwordx4 v101, s[48:51], s98 offen offset:1024 lds
    ds_read_b128 a[148:151], v105 offset:4096
    s_waitcnt lgkmcnt(2)
    buffer_load_dwordx4 v102, s[48:51], s98 offen offset:2048 lds
    s_waitcnt vmcnt(20)
    ds_read_b128 a[208:211], v104 offset:6144
    buffer_load_dwordx4 v103, s[48:51], s98 offen offset:3072 lds
    ds_read_b128 a[212:215], v105 offset:6144
    s_add_u32 m0, s95, 4096
    s_waitcnt lgkmcnt(2)
    buffer_load_dwordx4 v70, s[48:51], s98 offen offset:0 lds
    s_waitcnt vmcnt(20)
    ds_read_b128 a[24:27], v104 offset:8192
    buffer_load_dwordx4 v71, s[48:51], s98 offen offset:1024 lds
    ds_read_b128 a[28:31], v105 offset:8192
    s_waitcnt lgkmcnt(2)
    buffer_load_dwordx4 v72, s[48:51], s98 offen offset:2048 lds
    s_waitcnt vmcnt(10)
    s_barrier
    s_cmp_lg_u32 s64, 0
    s_cbranch_scc1 L_nofla
    s_lshl_b32 s72, s84, 7
    s_add_u32 s72, s72, 4096
    v_and_b32 v112, 31, v1
    v_lshlrev_b32_e64 v112, 2, v112
    buffer_store_dword v2, v112, s[60:63], s72 offen sc1
L_nofla:
    ds_read_b128 a[88:91], v104 offset:10240
    buffer_load_dwordx4 v73, s[48:51], s98 offen offset:3072 lds
    s_add_u32 s98, s98, 128
    s_and_b32 s98, s98, 1023
    ds_read_b128 a[92:95], v105 offset:10240
    s_add_u32 m0, s95, 8192
    s_waitcnt lgkmcnt(2)
    buffer_load_dwordx4 v100, s[48:51], s98 offen offset:0 lds
    s_waitcnt vmcnt(11)
    ds_read_b128 a[152:155], v104 offset:12288
    buffer_load_dwordx4 v101, s[48:51], s98 offen offset:1024 lds
    ds_read_b128 a[156:159], v105 offset:12288
    s_waitcnt lgkmcnt(2)
    buffer_load_dwordx4 v102, s[48:51], s98 offen offset:2048 lds
    s_waitcnt vmcnt(11)
    ds_read_b128 a[216:219], v104 offset:14336
    buffer_load_dwordx4 v103, s[48:51], s98 offen offset:3072 lds
    ds_read_b128 a[220:223], v105 offset:14336
    s_add_u32 m0, s95, 12288
    s_waitcnt lgkmcnt(2)
    buffer_load_dwordx4 v70, s[48:51], s98 offen offset:0 lds
    s_waitcnt vmcnt(11)
    ds_read_b128 a[32:35], v104 offset:0
    buffer_load_dwordx4 v71, s[48:51], s98 offen offset:1024 lds
    ds_read_b128 a[36:39], v105 offset:0
    s_waitcnt lgkmcnt(2)
    buffer_load_dwordx4 v72, s[48:51], s98 offen offset:2048 lds
    s_waitcnt vmcnt(11)
    ds_read_b128 a[96:99], v104 offset:2048
    buffer_load_dwordx4 v73, s[48:51], s98 offen offset:3072 lds
    s_add_u32 s98, s98, 128
    s_and_b32 s98, s98, 1023
    ds_read_b128 a[100:103], v105 offset:2048
    s_add_u32 m0, s95, 0
    s_waitcnt lgkmcnt(2)
    buffer_load_dwordx4 v100, s[48:51], s98 offen offset:0 lds
    s_waitcnt vmcnt(11)
    ds_read_b128 a[160:163], v104 offset:4096
    buffer_load_dwordx4 v101, s[48:51], s98 offen offset:1024 lds
    ds_read_b128 a[164:167], v105 offset:4096
    s_waitcnt lgkmcnt(2)
    buffer_load_dwordx4 v102, s[48:51], s98 offen offset:2048 lds
    s_waitcnt vmcnt(11)
    ds_read_b128 a[224:227], v104 offset:6144
    buffer_load_dwordx4 v103, s[48:51], s98 offen offset:3072 lds
    ds_read_b128 a[228:231], v105 offset:6144
    s_add_u32 m0, s95, 4096
    s_waitcnt lgkmcnt(2)
    buffer_load_dwordx4 v70, s[48:51], s98 offen offset:0 lds
    s_waitcnt vmcnt(11)
    ds_read_b128 a[40:43], v104 offset:8192
    buffer_load_dwordx4 v71, s[48:51], s98 offen offset:1024 lds
    ds_read_b128 a[44:47], v105 offset:8192
    s_waitcnt lgkmcnt(2)
    buffer_load_dwordx4 v72, s[48:51], s98 offen offset:2048 lds
    s_waitcnt vmcnt(11)
    s_nop 0
    ds_read_b128 a[104:107], v104 offset:10240
    buffer_load_dwordx4 v73, s[48:51], s98 offen offset:3072 lds
    s_add_u32 s98, s98, 128
    s_and_b32 s98, s98, 1023
    ds_read_b128 a[108:111], v105 offset:10240
    s_add_u32 m0, s95, 8192
    s_waitcnt lgkmcnt(2)
    buffer_load_dwordx4 v100, s[48:51], s98 offen offset:0 lds
    s_waitcnt vmcnt(11)
    ds_read_b128 a[168:171], v104 offset:12288
    buffer_load_dwordx4 v101, s[48:51], s98 offen offset:1024 lds
    ds_read_b128 a[172:175], v105 offset:12288
    s_waitcnt lgkmcnt(2)
    buffer_load_dwordx4 v102, s[48:51], s98 offen offset:2048 lds
    s_waitcnt vmcnt(11)
    ds_read_b128 a[232:235], v104 offset:14336
    buffer_load_dwordx4 v103, s[48:51], s98 offen offset:3072 lds
    ds_read_b128 a[236:239], v105 offset:14336
    s_add_u32 m0, s95, 12288
    s_waitcnt lgkmcnt(2)
    buffer_load_dwordx4 v70, s[48:51], s98 offen offset:0 lds
    s_waitcnt vmcnt(11)
    ds_read_b128 a[48:51], v104 offset:0
    buffer_load_dwordx4 v71, s[48:51], s98 offen offset:1024 lds
    ds_read_b128 a[52:55], v105 offset:0
    s_waitcnt lgkmcnt(2)
    buffer_load_dwordx4 v72, s[48:51], s98 offen offset:2048 lds
    s_waitcnt vmcnt(11)
    ds_read_b128 a[112:115], v104 offset:2048
    buffer_load_dwordx4 v73, s[48:51], s98 offen offset:3072 lds
    buffer_load_dword v4, v107, s[60:63], 0 offen sc1
    ds_read_b128 a[116:119], v105 offset:2048
    s_waitcnt vmcnt(11)
    ds_read_b128 a[176:179], v104 offset:4096
    ds_read_b128 a[180:183], v105 offset:4096
    s_waitcnt vmcnt(9)
    ds_read_b128 a[240:243], v104 offset:6144
    ds_read_b128 a[244:247], v105 offset:6144
    s_waitcnt vmcnt(7)
    ds_read_b128 a[56:59], v104 offset:8192
    ds_read_b128 a[60:63], v105 offset:8192
    s_waitcnt vmcnt(5)
    ds_read_b128 a[120:123], v104 offset:10240
    ds_read_b128 a[124:127], v105 offset:10240
    s_waitcnt vmcnt(3)
    ds_read_b128 a[184:187], v104 offset:12288
    ds_read_b128 a[188:191], v105 offset:12288
    s_waitcnt vmcnt(1)
    ds_read_b128 a[248:251], v104 offset:14336
    ds_read_b128 a[252:255], v105 offset:14336
    s_waitcnt lgkmcnt(0)
    s_waitcnt vmcnt(0)
    v_xor_b32 v126, v4, v2
    v_cmp_ne_u32 vcc, 0, v126
    s_cbranch_vccnz L_stub_flgha
L_ok_flgha:
    s_barrier
    s_mul_i32 s75, s68, 122880
    s_mul_i32 s72, s64, 6144
    s_add_u32 s75, s75, s72
    s_add_u32 s75, s75, 10223616
    v_min_u32 v114, 47, v1
    v_lshlrev_b32 v114, 4, v114
    v_cmp_gt_u32 vcc, 24, v1
    v_add_u32 v115, 2688, v114
    s_nop 0
    v_cndmask_b32 v114, v115, v114, vcc
    s_add_u32 m0, s71, 12288
    s_add_u32 s78, s75, 983040
    buffer_load_dwordx4 v106, s[60:63], s78 offen offset:0 sc1 lds
    buffer_load_dwordx4 v106, s[60:63], s78 offen offset:1024 sc1 lds
    buffer_load_dwordx4 v106, s[60:63], s78 offen offset:2048 sc1 lds
    buffer_load_dwordx4 v106, s[60:63], s78 offen offset:3072 sc1 lds
    s_add_u32 m0, s71, 16384
    s_add_u32 s78, s75, 987136
    buffer_load_dwordx4 v106, s[60:63], s78 offen offset:0 sc1 lds
    buffer_load_dwordx4 v106, s[60:63], s78 offen offset:1024 sc1 lds
    s_add_u32 m0, s95, 0
    s_nop 0
    s_add_u32 s78, s75, 1007616
    buffer_load_dwordx4 v106, s[60:63], s78 offen offset:0 sc1 lds
    buffer_load_dwordx4 v106, s[60:63], s78 offen offset:1024 sc1 lds
    buffer_load_dwordx4 v106, s[60:63], s78 offen offset:2048 sc1 lds
    buffer_load_dwordx4 v106, s[60:63], s78 offen offset:3072 sc1 lds
    s_add_u32 m0, s95, 4096
    s_add_u32 s78, s75, 1011712
    buffer_load_dwordx4 v106, s[60:63], s78 offen offset:0 sc1 lds
    buffer_load_dwordx4 v106, s[60:63], s78 offen offset:1024 sc1 lds
    v_and_b32 v102, 7, v1
    v_bfe_u32 v91, v1, 3, 1
    v_lshrrev_b32 v103, 4, v1
    v_lshl_add_u32 v111, v102, 1, v91
    v_lshlrev_b32 v90, 4, v102
    v_lshl_add_u32 v90, v103, 14, v90
    v_lshl_add_u32 v90, v91, 16, v90
    v_and_b32 v102, 15, v1
    s_lshl_b32 s72, s67, 2
    s_add_u32 s74, s72, s64
    s_lshl_b32 s92, s74, 7
    s_add_u32 s92, s92, 1048576
    v_mov_b32 v94, v106
    v_add_u32 v95, 57344, v106
    v_add_u32 v96, 114688, v106
    s_add_u32 s72, s95, 6144
    v_lshl_add_u32 v100, v102, 2, s72
    v_lshl_add_u32 v101, v103, 4, s72
    v_mov_b32 v144, s90
    v_mov_b32 v145, s90
    v_mov_b32 v146, s90
    v_mov_b32 v147, s90
    s_branch L_join
L_nostat:
    s_cmp_eq_u32 s66, 11
    s_cbranch_scc1 L_clr
    s_mul_i32 s82, s65, 3
    s_add_u32 s82, s82, s66
    s_sub_u32 s82, s82, 8
    s_mov_b32 s84, s82
    s_mov_b32 s83, 0
    v_lshrrev_b32 v116, 3, v1
    v_and_b32 v117, 6, v116
    v_and_b32 v118, 7, v1
    v_xor_b32 v117, v117, v118
    v_mul_u32_u24 v116, 3072, v116
    v_lshl_add_u32 v116, v117, 4, v116
    s_lshl_b32 s72, s83, 2
    s_add_u32 s72, s72, s64
    s_mul_i32 s85, s72, 491520
    s_lshl_b32 s72, s82, 7
    s_add_u32 s85, s85, s72
    s_mul_i32 s86, s64, 20480
    s_waitcnt lgkmcnt(0)
    s_mov_b64 s[44:45], s[24:25]
    s_mov_b32 s46, 1966080
    s_mov_b32 s47, 0x20000
    s_add_u32 m0, s86, 0
    s_nop 0
    buffer_load_dwordx4 v116, s[44:47], s85 offen lds
    s_add_u32 m0, s86, 1024
    s_add_u32 s85, s85, 24576
    buffer_load_dwordx4 v116, s[44:47], s85 offen lds
    s_add_u32 m0, s86, 2048
    s_add_u32 s85, s85, 24576
    buffer_load_dwordx4 v116, s[44:47], s85 offen lds
    s_add_u32 m0, s86, 3072
    s_add_u32 s85, s85, 24576
    buffer_load_dwordx4 v116, s[44:47], s85 offen lds
    s_add_u32 m0, s86, 4096
    s_add_u32 s85, s85, 24576
    buffer_load_dwordx4 v116, s[44:47], s85 offen lds
    s_add_u32 m0, s86, 5120
    s_add_u32 s85, s85, 24576
    buffer_load_dwordx4 v116, s[44:47], s85 offen lds
    s_add_u32 m0, s86, 6144
    s_add_u32 s85, s85, 24576
    buffer_load_dwordx4 v116, s[44:47], s85 offen lds
    s_add_u32 m0, s86, 7168
    s_add_u32 s85, s85, 24576
    buffer_load_dwordx4 v116, s[44:47], s85 offen lds
    s_add_u32 m0, s86, 8192
    s_add_u32 s85, s85, 24576
    buffer_load_dwordx4 v116, s[44:47], s85 offen lds
    s_add_u32 m0, s86, 9216
    s_add_u32 s85, s85, 24576
    buffer_load_dwordx4 v116, s[44:47], s85 offen lds
    s_add_u32 m0, s86, 10240
    s_add_u32 s85, s85, 24576
    buffer_load_dwordx4 v116, s[44:47], s85 offen lds
    s_add_u32 m0, s86, 11264
    s_add_u32 s85, s85, 24576
    buffer_load_dwordx4 v116, s[44:47], s85 offen lds
    s_add_u32 m0, s86, 12288
    s_add_u32 s85, s85, 24576
    buffer_load_dwordx4 v116, s[44:47], s85 offen lds
    s_add_u32 m0, s86, 13312
    s_add_u32 s85, s85, 24576
    buffer_load_dwordx4 v116, s[44:47], s85 offen lds
    s_add_u32 m0, s86, 14336
    s_add_u32 s85, s85, 24576
    buffer_load_dwordx4 v116, s[44:47], s85 offen lds
    s_add_u32 m0, s86, 15360
    s_add_u32 s85, s85, 24576
    buffer_load_dwordx4 v116, s[44:47], s85 offen lds
    s_add_u32 m0, s86, 16384
    s_add_u32 s85, s85, 24576
    buffer_load_dwordx4 v116, s[44:47], s85 offen lds
    s_add_u32 m0, s86, 17408
    s_add_u32 s85, s85, 24576
    buffer_load_dwordx4 v116, s[44:47], s85 offen lds
    s_add_u32 m0, s86, 18432
    s_add_u32 s85, s85, 24576
    buffer_load_dwordx4 v116, s[44:47], s85 offen lds
    s_add_u32 m0, s86, 19456
    s_add_u32 s85, s85, 24576
    buffer_load_dwordx4 v116, s[44:47], s85 offen lds
    s_mov_b64 s[60:61], s[36:37]
    s_mov_b32 s62, 33554432
    s_mov_b32 s63, 0x20000
    v_mov_b32 v2, 0
    buffer_load_dword v2, v2, s[60:63], 0 offen sc1
    v_mov_b32 v3, 0
    s_lshr_b32 s72, s65, 1
    s_lshl_b32 s72, s72, 3
    s_and_b32 s73, s66, 7
    s_add_u32 s67, s72, s73
    s_and_b32 s72, s65, 1
    s_lshl_b32 s72, s72, 2
    s_lshr_b32 s73, s66, 3
    s_add_u32 s68, s72, s73
    s_lshl_b32 s72, s65, 2
    s_and_b32 s73, s66, 3
    s_add_u32 s69, s72, s73
    s_lshr_b32 s70, s66, 2
    s_mov_b32 s69, s67
    s_mov_b32 s70, s68
    s_nop 0
    s_mul_i32 s71, s64, 18432
    s_mul_i32 s95, s64, 22528
    s_add_u32 s95, s95, 73728
    s_mov_b32 s76, 65536
    s_mov_b32 s90, 0x3f803f80
    v_lshlrev_b32 v109, 4, v0
    s_sub_u32 s48, s26, 4096
    s_subb_u32 s49, s27, 0
    s_mov_b32 s50, 8392704
    s_mov_b32 s51, 0x20000
    s_mov_b64 s[56:57], s[32:33]
    s_mov_b32 s58, 2621440
    s_mov_b32 s59, 0x20000
    v_and_b32 v92, 7, v1
    v_bfe_u32 v91, v1, 3, 1
    v_lshl_add_u32 v92, v92, 1, v91
    s_lshl_b32 s72, s67, 2
    s_add_u32 s72, s72, s64
    s_lshl_b32 s72, s72, 5
    v_lshl_add_u32 v92, v92, 1, s72
    global_load_ushort v92, v92, s[28:29]
    v_lshrrev_b32 v120, 3, v1
    v_and_b32 v121, 7, v1
    v_lshrrev_b32 v122, 1, v120
    v_xor_b32 v121, v121, v122
    v_lshlrev_b32 v121, 4, v121
    v_lshl_add_u32 v122, v120, 12, v121
    v_xor_b32 v123, 64, v122
    s_mul_i32 s77, s67, 262144
    s_lshl_b32 s72, s64, 10
    s_add_u32 s77, s77, s72
    v_add_u32 v122, s77, v122
    s_add_u32 s77, s77, 31744
    v_add_u32 v123, s77, v123
    s_add_u32 s72, s64, 0
    s_and_b32 s72, s72, 3
    s_lshl_b32 s72, s72, 16
    s_add_u32 s72, s72, 4096
    v_add_u32 v100, s72, v122
    v_add_u32 v101, s72, v123
    s_add_u32 s72, s64, 1
    s_and_b32 s72, s72, 3
    s_lshl_b32 s72, s72, 16
    s_add_u32 s72, s72, 2048
    v_add_u32 v102, s72, v122
    v_add_u32 v103, s72, v123
    s_add_u32 s72, s64, 2
    s_and_b32 s72, s72, 3
    s_lshl_b32 s72, s72, 16
    s_add_u32 s72, s72, 4096
    v_add_u32 v70, s72, v122
    v_add_u32 v71, s72, v123
    s_add_u32 s72, s64, 3
    s_and_b32 s72, s72, 3
    s_lshl_b32 s72, s72, 16
    s_add_u32 s72, s72, 2048
    v_add_u32 v72, s72, v122
    v_add_u32 v73, s72, v123
    v_and_b32 v120, 7, v1
    v_lshrrev_b32 v121, 4, v1
    v_xor_b32 v121, v121, v120
    v_lshlrev_b32 v121, 4, v121
    v_lshl_add_u32 v121, v120, 8, v121
    v_and_b32 v120, 8, v1
    v_lshl_add_u32 v121, v120, 4, v121
    v_xor_b32 v122, 64, v121
    v_add_u32 v104, s95, v121
    v_add_u32 v105, s95, v122
    s_lshl_b32 s99, s67, 3
    s_and_b32 s72, s68, 4
    s_add_u32 s99, s99, s72
    s_and_b32 s99, s99, 7
    s_lshl_b32 s98, s99, 7
    v_lshlrev_b32 v106, 4, v1
    s_mul_i32 s72, s68, 3
    s_lshr_b32 s72, s72, 1
    v_and_b32 v107, 2, v1
    v_mad_u32_u24 v107, v107, 5, s72
    s_mul_i32 s72, s64, 24
    s_sub_u32 s72, s72, 4
    v_mov_b32 v108, s72
    s_mov_b64 vcc, 15
    v_cndmask_b32 v107, v108, v107, vcc
    v_min_u32 v108, 27, v1
    v_add_lshl_u32 v107, v107, v108, 7
    v_add_u32 v107, 4096, v107
    v_lshrrev_b32 v117, 2, v1
    v_lshlrev_b32 v118, 7, v117
    v_and_b32 v119, 3, v1
    v_lshl_add_u32 v118, v119, 3, v118
    v_bfe_u32 v117, v117, 1, 2
    v_xor_b32 v117, s64, v117
    v_lshl_add_u32 v48, v117, 5, v118
    v_add_u32 v49, 40960, v48
    s_lshl_b32 s72, s82, 2
    s_add_u32 s74, s72, s64
    s_mul_i32 s78, s74, 10923
    s_lshr_b32 s78, s78, 16
    s_mul_i32 s78, s78, 116736
    s_lshl_b32 s72, s74, 10
    s_add_u32 s78, s78, s72
    s_mul_i32 s72, s83, 122880
    s_add_u32 s78, s78, s72
    s_add_u32 s78, s78, 10223616
    v_mov_b32 v44, s90
    v_mov_b32 v45, s90
    v_mov_b32 v46, s90
    v_mov_b32 v47, s90
    s_waitcnt vmcnt(2)
    s_barrier
    ds_read_b64_tr_b16 v[128:129], v48 offset:0
    ds_read_b64_tr_b16 v[130:131], v48 offset:2048
    ds_read_b64_tr_b16 v[132:133], v48 offset:4096
    ds_read_b64_tr_b16 v[134:135], v48 offset:6144
    ds_read_b64_tr_b16 v[136:137], v48 offset:8192
    ds_read_b64_tr_b16 v[138:139], v48 offset:10240
    ds_read_b64_tr_b16 v[140:141], v48 offset:12288
    ds_read_b64_tr_b16 v[142:143], v48 offset:14336
    ds_read_b64_tr_b16 v[144:145], v48 offset:16384
    ds_read_b64_tr_b16 v[146:147], v48 offset:18432
    ds_read_b64_tr_b16 v[148:149], v48 offset:20480
    ds_read_b64_tr_b16 v[150:151], v48 offset:22528
    ds_read_b64_tr_b16 v[152:153], v48 offset:24576
    ds_read_b64_tr_b16 v[154:155], v48 offset:26624
    ds_read_b64_tr_b16 v[156:157], v48 offset:28672
    ds_read_b64_tr_b16 v[158:159], v48 offset:30720
    ds_read_b64_tr_b16 v[160:161], v48 offset:32768
    ds_read_b64_tr_b16 v[162:163], v48 offset:34816
    ds_read_b64_tr_b16 v[164:165], v48 offset:36864
    ds_read_b64_tr_b16 v[166:167], v48 offset:38912
    ds_read_b64_tr_b16 v[168:169], v49 offset:0
    ds_read_b64_tr_b16 v[170:171], v49 offset:2048
    ds_read_b64_tr_b16 v[172:173], v49 offset:4096
    ds_read_b64_tr_b16 v[174:175], v49 offset:6144
    ds_read_b64_tr_b16 v[176:177], v49 offset:8192
    ds_read_b64_tr_b16 v[178:179], v49 offset:10240
    ds_read_b64_tr_b16 v[180:181], v49 offset:12288
    ds_read_b64_tr_b16 v[182:183], v49 offset:14336
    ds_read_b64_tr_b16 v[184:185], v49 offset:16384
    ds_read_b64_tr_b16 v[186:187], v49 offset:18432
    ds_read_b64_tr_b16 v[188:189], v49 offset:20480
    ds_read_b64_tr_b16 v[190:191], v49 offset:22528
    ds_read_b64_tr_b16 v[192:193], v49 offset:24576
    ds_read_b64_tr_b16 v[194:195], v49 offset:26624
    ds_read_b64_tr_b16 v[196:197], v49 offset:28672
    ds_read_b64_tr_b16 v[198:199], v49 offset:30720
    ds_read_b64_tr_b16 v[200:201], v49 offset:32768
    ds_read_b64_tr_b16 v[202:203], v49 offset:34816
    ds_read_b64_tr_b16 v[204:205], v49 offset:36864
    ds_read_b64_tr_b16 v[206:207], v49 offset:38912
    s_waitcnt lgkmcnt(15)
    buffer_store_dwordx4 v[128:131], v106, s[60:63], s78 offen sc1
    v_mfma_f32_16x16x32_bf16 v[40:43], v[44:47], v[128:131], 0
    s_add_u32 s78, s78, 6144
    buffer_store_dwordx4 v[132:135], v106, s[60:63], s78 offen sc1
    v_mfma_f32_16x16x32_bf16 v[40:43], v[44:47], v[132:135], v[40:43]
    s_add_u32 s78, s78, 6144
    buffer_store_dwordx4 v[136:139], v106, s[60:63], s78 offen sc1
    v_mfma_f32_16x16x32_bf16 v[40:43], v[44:47], v[136:139], v[40:43]
    s_add_u32 s78, s78, 6144
    buffer_store_dwordx4 v[140:143], v106, s[60:63], s78 offen sc1
    v_mfma_f32_16x16x32_bf16 v[40:43], v[44:47], v[140:143], v[40:43]
    s_add_u32 s78, s78, 6144
    buffer_store_dwordx4 v[144:147], v106, s[60:63], s78 offen sc1
    v_mfma_f32_16x16x32_bf16 v[40:43], v[44:47], v[144:147], v[40:43]
    s_add_u32 s78, s78, 6144
    buffer_store_dwordx4 v[148:151], v106, s[60:63], s78 offen sc1
    v_mfma_f32_16x16x32_bf16 v[40:43], v[44:47], v[148:151], v[40:43]
    s_add_u32 s78, s78, 6144
    buffer_store_dwordx4 v[152:155], v106, s[60:63], s78 offen sc1
    v_mfma_f32_16x16x32_bf16 v[40:43], v[44:47], v[152:155], v[40:43]
    s_add_u32 s78, s78, 6144
    buffer_store_dwordx4 v[156:159], v106, s[60:63], s78 offen sc1
    v_mfma_f32_16x16x32_bf16 v[40:43], v[44:47], v[156:159], v[40:43]
    s_add_u32 s78, s78, 6144
    buffer_store_dwordx4 v[160:163], v106, s[60:63], s78 offen sc1
    v_mfma_f32_16x16x32_bf16 v[40:43], v[44:47], v[160:163], v[40:43]
    s_add_u32 s78, s78, 6144
    buffer_store_dwordx4 v[164:167], v106, s[60:63], s78 offen sc1
    v_mfma_f32_16x16x32_bf16 v[40:43], v[44:47], v[164:167], v[40:43]
    s_add_u32 s78, s78, 6144
    buffer_store_dwordx4 v[168:171], v106, s[60:63], s78 offen sc1
    v_mfma_f32_16x16x32_bf16 v[40:43], v[44:47], v[168:171], v[40:43]
    s_add_u32 s78, s78, 6144
    buffer_store_dwordx4 v[172:175], v106, s[60:63], s78 offen sc1
    v_mfma_f32_16x16x32_bf16 v[40:43], v[44:47], v[172:175], v[40:43]
    s_add_u32 s78, s78, 6144
    s_waitcnt lgkmcnt(14)
    buffer_store_dwordx4 v[176:179], v106, s[60:63], s78 offen sc1
    v_mfma_f32_16x16x32_bf16 v[40:43], v[44:47], v[176:179], v[40:43]
    s_add_u32 s78, s78, 6144
    s_waitcnt lgkmcnt(12)
    buffer_store_dwordx4 v[180:183], v106, s[60:63], s78 offen sc1
    v_mfma_f32_16x16x32_bf16 v[40:43], v[44:47], v[180:183], v[40:43]
    s_add_u32 s78, s78, 6144
    s_waitcnt lgkmcnt(10)
    buffer_store_dwordx4 v[184:187], v106, s[60:63], s78 offen sc1
    v_mfma_f32_16x16x32_bf16 v[40:43], v[44:47], v[184:187], v[40:43]
    s_add_u32 s78, s78, 6144
    s_waitcnt lgkmcnt(8)
    buffer_store_dwordx4 v[188:191], v106, s[60:63], s78 offen sc1
    v_mfma_f32_16x16x32_bf16 v[40:43], v[44:47], v[188:191], v[40:43]
    s_add_u32 s78, s78, 6144
    s_waitcnt lgkmcnt(6)
    buffer_store_dwordx4 v[192:195], v106, s[60:63], s78 offen sc1
    v_mfma_f32_16x16x32_bf16 v[40:43], v[44:47], v[192:195], v[40:43]
    s_add_u32 s78, s78, 6144
    s_waitcnt lgkmcnt(4)
    buffer_store_dwordx4 v[196:199], v106, s[60:63], s78 offen sc1
    v_mfma_f32_16x16x32_bf16 v[40:43], v[44:47], v[196:199], v[40:43]
    s_add_u32 s78, s78, 6144
    s_waitcnt lgkmcnt(2)
    buffer_store_dwordx4 v[200:203], v106, s[60:63], s78 offen sc1
    v_mfma_f32_16x16x32_bf16 v[40:43], v[44:47], v[200:203], v[40:43]
    s_add_u32 s78, s78, 6144
    s_waitcnt lgkmcnt(0)
    buffer_store_dwordx4 v[204:207], v106, s[60:63], s78 offen sc1
    v_mfma_f32_16x16x32_bf16 v[40:43], v[44:47], v[204:207], v[40:43]
    v_and_b32 v112, 15, v1
    v_lshlrev_b32 v112, 2, v112
    s_lshl_b32 s72, s74, 6
    s_add_u32 s72, s72, 40960
    s_nop 3
    buffer_store_dword v40, v112, s[60:63], s72 offen sc1
    s_waitcnt vmcnt(22)
    v_add_u32 v2, 2654435761, v2
    s_branch L_wd
L_clr:
    s_add_u32 s84, s65, 24
    s_waitcnt lgkmcnt(0)
    s_mov_b64 s[60:61], s[36:37]
    s_mov_b32 s62, 33554432
    s_mov_b32 s63, 0x20000
    v_mov_b32 v2, 0
    buffer_load_dword v2, v2, s[60:63], 0 offen sc1
    v_mov_b32 v3, 0
    s_lshr_b32 s72, s65, 1
    s_lshl_b32 s72, s72, 3
    s_and_b32 s73, s66, 7
    s_add_u32 s67, s72, s73
    s_and_b32 s72, s65, 1
    s_lshl_b32 s72, s72, 2
    s_lshr_b32 s73, s66, 3
    s_add_u32 s68, s72, s73
    s_lshl_b32 s72, s65, 2
    s_and_b32 s73, s66, 3
    s_add_u32 s69, s72, s73
    s_lshr_b32 s70, s66, 2
    s_mov_b32 s69, s67
    s_mov_b32 s70, s68
    s_mul_i32 s71, s64, 18432
    s_mul_i32 s95, s64, 22528
    s_add_u32 s95, s95, 73728
    s_mov_b32 s76, 65536
    s_mov_b32 s90, 0x3f803f80
    v_lshlrev_b32 v109, 4, v0
    s_sub_u32 s48, s26, 4096
    s_subb_u32 s49, s27, 0
    s_mov_b32 s50, 8392704
    s_mov_b32 s51, 0x20000
    s_mov_b64 s[56:57], s[32:33]
    s_mov_b32 s58, 2621440
    s_mov_b32 s59, 0x20000
    v_and_b32 v92, 7, v1
    v_bfe_u32 v91, v1, 3, 1
    v_lshl_add_u32 v92, v92, 1, v91
    s_lshl_b32 s72, s67, 2
    s_add_u32 s72, s72, s64
    s_lshl_b32 s72, s72, 5
    v_lshl_add_u32 v92, v92, 1, s72
    global_load_ushort v92, v92, s[28:29]
    v_lshrrev_b32 v120, 3, v1
    v_and_b32 v121, 7, v1
    v_lshrrev_b32 v122, 1, v120
    v_xor_b32 v121, v121, v122
    v_lshlrev_b32 v121, 4, v121
    v_lshl_add_u32 v122, v120, 12, v121
    v_xor_b32 v123, 64, v122
    s_mul_i32 s77, s67, 262144
    s_lshl_b32 s72, s64, 10
    s_add_u32 s77, s77, s72
    v_add_u32 v122, s77, v122
    s_add_u32 s77, s77, 31744
    v_add_u32 v123, s77, v123
    s_add_u32 s72, s64, 0
    s_and_b32 s72, s72, 3
    s_lshl_b32 s72, s72, 16
    s_add_u32 s72, s72, 4096
    v_add_u32 v100, s72, v122
    v_add_u32 v101, s72, v123
    s_add_u32 s72, s64, 1
    s_and_b32 s72, s72, 3
    s_lshl_b32 s72, s72, 16
    s_add_u32 s72, s72, 2048
    v_add_u32 v102, s72, v122
    v_add_u32 v103, s72, v123
    s_add_u32 s72, s64, 2
    s_and_b32 s72, s72, 3
    s_lshl_b32 s72, s72, 16
    s_add_u32 s72, s72, 4096
    v_add_u32 v70, s72, v122
    v_add_u32 v71, s72, v123
    s_add_u32 s72, s64, 3
    s_and_b32 s72, s72, 3
    s_lshl_b32 s72, s72, 16
    s_add_u32 s72, s72, 2048
    v_add_u32 v72, s72, v122
    v_add_u32 v73, s72, v123
    v_and_b32 v120, 7, v1
    v_lshrrev_b32 v121, 4, v1
    v_xor_b32 v121, v121, v120
    v_lshlrev_b32 v121, 4, v121
    v_lshl_add_u32 v121, v120, 8, v121
    v_and_b32 v120, 8, v1
    v_lshl_add_u32 v121, v120, 4, v121
    v_xor_b32 v122, 64, v121
    v_add_u32 v104, s95, v121
    v_add_u32 v105, s95, v122
    s_lshl_b32 s99, s67, 3
    s_and_b32 s72, s68, 4
    s_add_u32 s99, s99, s72
    s_and_b32 s99, s99, 7
    s_lshl_b32 s98, s99, 7
    v_lshlrev_b32 v106, 4, v1
    s_mul_i32 s72, s68, 3
    s_lshr_b32 s72, s72, 1
    v_and_b32 v107, 2, v1
    v_mad_u32_u24 v107, v107, 5, s72
    s_mul_i32 s72, s64, 24
    s_sub_u32 s72, s72, 4
    v_mov_b32 v108, s72
    s_mov_b64 vcc, 15
    v_cndmask_b32 v107, v108, v107, vcc
    v_min_u32 v108, 27, v1
    v_add_lshl_u32 v107, v107, v108, 7
    v_add_u32 v107, 4096, v107
    s_waitcnt vmcnt(1)
    v_add_u32 v2, 2654435761, v2
    s_mul_i32 s87, s65, 180224
    s_add_u32 s87, s87, 2359296
    v_mov_b32 v52, -1
    v_mov_b32 v53, -1
    v_mov_b32 v54, -1
    v_mov_b32_e64 v55, -1
    buffer_store_dwordx4 v[52:55], v109, s[60:63], s87 offen sc1
    s_add_u32 s87, s87, 4096
    buffer_store_dwordx4 v[52:55], v109, s[60:63], s87 offen sc1
    s_add_u32 s87, s87, 4096
    buffer_store_dwordx4 v[52:55], v109, s[60:63], s87 offen sc1
    s_add_u32 s87, s87, 4096
    buffer_store_dwordx4 v[52:55], v109, s[60:63], s87 offen sc1
    s_add_u32 s87, s87, 4096
    buffer_store_dwordx4 v[52:55], v109, s[60:63], s87 offen sc1
    s_add_u32 s87, s87, 4096
    buffer_store_dwordx4 v[52:55], v109, s[60:63], s87 offen sc1
    s_add_u32 s87, s87, 4096
    buffer_store_dwordx4 v[52:55], v109, s[60:63], s87 offen sc1
    s_add_u32 s87, s87, 4096
    buffer_store_dwordx4 v[52:55], v109, s[60:63], s87 offen sc1
    s_add_u32 s87, s87, 4096
    buffer_store_dwordx4 v[52:55], v109, s[60:63], s87 offen sc1
    s_add_u32 s87, s87, 4096
    buffer_store_dwordx4 v[52:55], v109, s[60:63], s87 offen sc1
    s_add_u32 s87, s87, 4096
    buffer_store_dwordx4 v[52:55], v109, s[60:63], s87 offen sc1
    s_add_u32 s87, s87, 4096
    buffer_store_dwordx4 v[52:55], v109, s[60:63], s87 offen sc1
    s_add_u32 s87, s87, 4096
    buffer_store_dwordx4 v[52:55], v109, s[60:63], s87 offen sc1
    s_add_u32 s87, s87, 4096
    buffer_store_dwordx4 v[52:55], v109, s[60:63], s87 offen sc1
    s_add_u32 s87, s87, 4096
    buffer_store_dwordx4 v[52:55], v109, s[60:63], s87 offen sc1
    s_add_u32 s87, s87, 4096
    buffer_store_dwordx4 v[52:55], v109, s[60:63], s87 offen sc1
    s_add_u32 s87, s87, 4096
    buffer_store_dwordx4 v[52:55], v109, s[60:63], s87 offen sc1
    s_add_u32 s87, s87, 4096
    buffer_store_dwordx4 v[52:55], v109, s[60:63], s87 offen sc1
    s_add_u32 s87, s87, 4096
    buffer_store_dwordx4 v[52:55], v109, s[60:63], s87 offen sc1
    s_add_u32 s87, s87, 4096
    buffer_store_dwordx4 v[52:55], v109, s[60:63], s87 offen sc1
    s_add_u32 s87, s87, 4096
    buffer_store_dwordx4 v[52:55], v109, s[60:63], s87 offen sc1
    s_add_u32 s87, s87, 4096
    buffer_store_dwordx4 v[52:55], v109, s[60:63], s87 offen sc1
    s_add_u32 s87, s87, 4096
    buffer_store_dwordx4 v[52:55], v109, s[60:63], s87 offen sc1
    s_add_u32 s87, s87, 4096
    buffer_store_dwordx4 v[52:55], v109, s[60:63], s87 offen sc1
    s_add_u32 s87, s87, 4096
    buffer_store_dwordx4 v[52:55], v109, s[60:63], s87 offen sc1
    s_add_u32 s87, s87, 4096
    buffer_store_dwordx4 v[52:55], v109, s[60:63], s87 offen sc1
    s_add_u32 s87, s87, 4096
    buffer_store_dwordx4 v[52:55], v109, s[60:63], s87 offen sc1
    s_add_u32 s87, s87, 4096
    buffer_store_dwordx4 v[52:55], v109, s[60:63], s87 offen sc1
    s_add_u32 s87, s87, 4096
    buffer_store_dwordx4 v[52:55], v109, s[60:63], s87 offen sc1
    s_add_u32 s87, s87, 4096
    buffer_store_dwordx4 v[52:55], v109, s[60:63], s87 offen sc1
    s_add_u32 s87, s87, 4096
    buffer_store_dwordx4 v[52:55], v109, s[60:63], s87 offen sc1
    s_add_u32 s87, s87, 4096
    buffer_store_dwordx4 v[52:55], v109, s[60:63], s87 offen sc1
    s_add_u32 s87, s87, 4096
    buffer_store_dwordx4 v[52:55], v109, s[60:63], s87 offen sc1
    s_add_u32 s87, s87, 4096
    buffer_store_dwordx4 v[52:55], v109, s[60:63], s87 offen sc1
    s_add_u32 s87, s87, 4096
    buffer_store_dwordx4 v[52:55], v109, s[60:63], s87 offen sc1
    s_add_u32 s87, s87, 4096
    buffer_store_dwordx4 v[52:55], v109, s[60:63], s87 offen sc1
    s_add_u32 s87, s87, 4096
    buffer_store_dwordx4 v[52:55], v109, s[60:63], s87 offen sc1
    s_add_u32 s87, s87, 4096
    buffer_store_dwordx4 v[52:55], v109, s[60:63], s87 offen sc1
    s_add_u32 s87, s87, 4096
    buffer_store_dwordx4 v[52:55], v109, s[60:63], s87 offen sc1
    s_add_u32 s87, s87, 4096
    buffer_store_dwordx4 v[52:55], v109, s[60:63], s87 offen sc1
    s_add_u32 s87, s87, 4096
    s_waitcnt vmcnt(20)
    s_nop 0
    buffer_store_dwordx4 v[52:55], v109, s[60:63], s87 offen sc1
    s_add_u32 s87, s87, 4096
    buffer_store_dwordx4 v[52:55], v109, s[60:63], s87 offen sc1
    s_add_u32 s87, s87, 4096
    buffer_store_dwordx4 v[52:55], v109, s[60:63], s87 offen sc1
    s_add_u32 s87, s87, 4096
    buffer_store_dwordx4 v[52:55], v109, s[60:63], s87 offen sc1
L_wd:
    s_barrier
    s_add_u32 m0, s95, 0
    s_nop 0
    s_nop 0
    buffer_load_dwordx4 v100, s[48:51], s98 offen offset:0 lds
    buffer_load_dwordx4 v101, s[48:51], s98 offen offset:1024 lds
    buffer_load_dwordx4 v102, s[48:51], s98 offen offset:2048 lds
    buffer_load_dwordx4 v103, s[48:51], s98 offen offset:3072 lds
    s_add_u32 m0, s95, 4096
    s_nop 0
    s_nop 0
    buffer_load_dwordx4 v70, s[48:51], s98 offen offset:0 lds
    buffer_load_dwordx4 v71, s[48:51], s98 offen offset:1024 lds
    buffer_load_dwordx4 v72, s[48:51], s98 offen offset:2048 lds
    buffer_load_dwordx4 v73, s[48:51], s98 offen offset:3072 lds
    s_add_u32 s98, s98, 128
    s_and_b32 s98, s98, 1023
    s_waitcnt vmcnt(8)
    s_barrier
    s_cmp_lg_u32 s64, 0
    s_cbranch_scc1 L_noflb
    s_lshl_b32 s72, s84, 7
    s_add_u32 s72, s72, 4096
    v_and_b32 v112, 31, v1
    v_lshlrev_b32 v112, 2, v112
    buffer_store_dword v2, v112, s[60:63], s72 offen sc1
L_noflb:
    s_add_u32 m0, s95, 8192
    s_nop 0
    buffer_load_dwordx4 v100, s[48:51], s98 offen offset:0 lds
    buffer_load_dwordx4 v101, s[48:51], s98 offen offset:1024 lds
    buffer_load_dwordx4 v102, s[48:51], s98 offen offset:2048 lds
    buffer_load_dwordx4 v103, s[48:51], s98 offen offset:3072 lds
    s_add_u32 m0, s95, 12288
    s_nop 0
    s_nop 0
    buffer_load_dwordx4 v70, s[48:51], s98 offen offset:0 lds
    buffer_load_dwordx4 v71, s[48:51], s98 offen offset:1024 lds
    buffer_load_dwordx4 v72, s[48:51], s98 offen offset:2048 lds
    buffer_load_dwordx4 v73, s[48:51], s98 offen offset:3072 lds
    s_add_u32 s98, s98, 128
    s_and_b32 s98, s98, 1023
    s_waitcnt vmcnt(14)
    ds_read_b128 a[0:3], v104 offset:0
    ds_read_b128 a[4:7], v105 offset:0
    s_waitcnt vmcnt(12)
    ds_read_b128 a[64:67], v104 offset:2048
    ds_read_b128 a[68:71], v105 offset:2048
    s_add_u32 m0, s95, 0
    s_waitcnt lgkmcnt(2)
    buffer_load_dwordx4 v100, s[48:51], s98 offen offset:0 lds
    s_waitcnt vmcnt(11)
    ds_read_b128 a[128:131], v104 offset:4096
    buffer_load_dwordx4 v101, s[48:51], s98 offen offset:1024 lds
    ds_read_b128 a[132:135], v105 offset:4096
    s_waitcnt lgkmcnt(2)
    buffer_load_dwordx4 v102, s[48:51], s98 offen offset:2048 lds
    s_waitcnt vmcnt(11)
    ds_read_b128 a[192:195], v104 offset:6144
    buffer_load_dwordx4 v103, s[48:51], s98 offen offset:3072 lds
    ds_read_b128 a[196:199], v105 offset:6144
    s_add_u32 m0, s95, 4096
    s_waitcnt lgkmcnt(2)
    buffer_load_dwordx4 v70, s[48:51], s98 offen offset:0 lds
    s_waitcnt vmcnt(11)
    ds_read_b128 a[8:11], v104 offset:8192
    buffer_load_dwordx4 v71, s[48:51], s98 offen offset:1024 lds
    ds_read_b128 a[12:15], v105 offset:8192
    s_waitcnt lgkmcnt(2)
    buffer_load_dwordx4 v72, s[48:51], s98 offen offset:2048 lds
    s_waitcnt vmcnt(11)
    s_nop 0
    ds_read_b128 a[72:75], v104 offset:10240
    buffer_load_dwordx4 v73, s[48:51], s98 offen offset:3072 lds
    s_add_u32 s98, s98, 128
    s_and_b32 s98, s98, 1023
    ds_read_b128 a[76:79], v105 offset:10240
    s_add_u32 m0, s95, 8192
    s_waitcnt lgkmcnt(2)
    buffer_load_dwordx4 v100, s[48:51], s98 offen offset:0 lds
    s_waitcnt vmcnt(11)
    ds_read_b128 a[136:139], v104 offset:12288
    buffer_load_dwordx4 v101, s[48:51], s98 offen offset:1024 lds
    ds_read_b128 a[140:143], v105 offset:12288
    s_waitcnt lgkmcnt(2)
    buffer_load_dwordx4 v102, s[48:51], s98 offen offset:2048 lds
    s_waitcnt vmcnt(11)
    ds_read_b128 a[200:203], v104 offset:14336
    buffer_load_dwordx4 v103, s[48:51], s98 offen offset:3072 lds
    ds_read_b128 a[204:207], v105 offset:14336
    s_add_u32 m0, s95, 12288
    s_waitcnt lgkmcnt(2)
    buffer_load_dwordx4 v70, s[48:51], s98 offen offset:0 lds
    s_waitcnt vmcnt(11)
    ds_read_b128 a[16:19], v104 offset:0
    buffer_load_dwordx4 v71, s[48:51], s98 offen offset:1024 lds
    ds_read_b128 a[20:23], v105 offset:0
    s_waitcnt lgkmcnt(2)
    buffer_load_dwordx4 v72, s[48:51], s98 offen offset:2048 lds
    s_waitcnt vmcnt(11)
    ds_read_b128 a[80:83], v104 offset:2048
    buffer_load_dwordx4 v73, s[48:51], s98 offen offset:3072 lds
    s_add_u32 s98, s98, 128
    s_and_b32 s98, s98, 1023
    ds_read_b128 a[84:87], v105 offset:2048
    s_add_u32 m0, s95, 0
    s_waitcnt lgkmcnt(2)
    buffer_load_dwordx4 v100, s[48:51], s98 offen offset:0 lds
    s_waitcnt vmcnt(11)
    ds_read_b128 a[144:147], v104 offset:4096
    buffer_load_dwordx4 v101, s[48:51], s98 offen offset:1024 lds
    ds_read_b128 a[148:151], v105 offset:4096
    s_waitcnt lgkmcnt(2)
    buffer_load_dwordx4 v102, s[48:51], s98 offen offset:2048 lds
    s_waitcnt vmcnt(11)
    ds_read_b128 a[208:211], v104 offset:6144
    buffer_load_dwordx4 v103, s[48:51], s98 offen offset:3072 lds
    ds_read_b128 a[212:215], v105 offset:6144
    s_add_u32 m0, s95, 4096
    s_waitcnt lgkmcnt(2)
    buffer_load_dwordx4 v70, s[48:51], s98 offen offset:0 lds
    s_waitcnt vmcnt(11)
    ds_read_b128 a[24:27], v104 offset:8192
    buffer_load_dwordx4 v71, s[48:51], s98 offen offset:1024 lds
    ds_read_b128 a[28:31], v105 offset:8192
    s_waitcnt lgkmcnt(2)
    buffer_load_dwordx4 v72, s[48:51], s98 offen offset:2048 lds
    s_waitcnt vmcnt(11)
    s_nop 0
    ds_read_b128 a[88:91], v104 offset:10240
    buffer_load_dwordx4 v73, s[48:51], s98 offen offset:3072 lds
    s_add_u32 s98, s98, 128
    s_and_b32 s98, s98, 1023
    ds_read_b128 a[92:95], v105 offset:10240
    s_add_u32 m0, s95, 8192
    s_waitcnt lgkmcnt(2)
    buffer_load_dwordx4 v100, s[48:51], s98 offen offset:0 lds
    s_waitcnt vmcnt(11)
    ds_read_b128 a[152:155], v104 offset:12288
    buffer_load_dwordx4 v101, s[48:51], s98 offen offset:1024 lds
    ds_read_b128 a[156:159], v105 offset:12288
    s_waitcnt lgkmcnt(2)
    buffer_load_dwordx4 v102, s[48:51], s98 offen offset:2048 lds
    s_waitcnt vmcnt(11)
    ds_read_b128 a[216:219], v104 offset:14336
    buffer_load_dwordx4 v103, s[48:51], s98 offen offset:3072 lds
    ds_read_b128 a[220:223], v105 offset:14336
    s_add_u32 m0, s95, 12288
    s_waitcnt lgkmcnt(2)
    buffer_load_dwordx4 v70, s[48:51], s98 offen offset:0 lds
    s_waitcnt vmcnt(11)
    ds_read_b128 a[32:35], v104 offset:0
    buffer_load_dwordx4 v71, s[48:51], s98 offen offset:1024 lds
    ds_read_b128 a[36:39], v105 offset:0
    s_waitcnt lgkmcnt(2)
    buffer_load_dwordx4 v72, s[48:51], s98 offen offset:2048 lds
    s_waitcnt vmcnt(11)
    ds_read_b128 a[96:99], v104 offset:2048
    buffer_load_dwordx4 v73, s[48:51], s98 offen offset:3072 lds
    s_add_u32 s98, s98, 128
    s_and_b32 s98, s98, 1023
    ds_read_b128 a[100:103], v105 offset:2048
    s_add_u32 m0, s95, 0
    s_waitcnt lgkmcnt(2)
    buffer_load_dwordx4 v100, s[48:51], s98 offen offset:0 lds
    s_waitcnt vmcnt(11)
    ds_read_b128 a[160:163], v104 offset:4096
    buffer_load_dwordx4 v101, s[48:51], s98 offen offset:1024 lds
    ds_read_b128 a[164:167], v105 offset:4096
    s_waitcnt lgkmcnt(2)
    buffer_load_dwordx4 v102, s[48:51], s98 offen offset:2048 lds
    s_waitcnt vmcnt(11)
    ds_read_b128 a[224:227], v104 offset:6144
    buffer_load_dwordx4 v103, s[48:51], s98 offen offset:3072 lds
    ds_read_b128 a[228:231], v105 offset:6144
    s_add_u32 m0, s95, 4096
    s_waitcnt lgkmcnt(2)
    buffer_load_dwordx4 v70, s[48:51], s98 offen offset:0 lds
    s_waitcnt vmcnt(11)
    ds_read_b128 a[40:43], v104 offset:8192
    buffer_load_dwordx4 v71, s[48:51], s98 offen offset:1024 lds
    ds_read_b128 a[44:47], v105 offset:8192
    s_waitcnt lgkmcnt(2)
    buffer_load_dwordx4 v72, s[48:51], s98 offen offset:2048 lds
    s_waitcnt vmcnt(11)
    s_nop 0
    ds_read_b128 a[104:107], v104 offset:10240
    buffer_load_dwordx4 v73, s[48:51], s98 offen offset:3072 lds
    s_add_u32 s98, s98, 128
    s_and_b32 s98, s98, 1023
    ds_read_b128 a[108:111], v105 offset:10240
    s_add_u32 m0, s95, 8192
    s_waitcnt lgkmcnt(2)
    buffer_load_dwordx4 v100, s[48:51], s98 offen offset:0 lds
    s_waitcnt vmcnt(11)
    ds_read_b128 a[168:171], v104 offset:12288
    buffer_load_dwordx4 v101, s[48:51], s98 offen offset:1024 lds
    ds_read_b128 a[172:175], v105 offset:12288
    s_waitcnt lgkmcnt(2)
    buffer_load_dwordx4 v102, s[48:51], s98 offen offset:2048 lds
    s_waitcnt vmcnt(11)
    ds_read_b128 a[232:235], v104 offset:14336
    buffer_load_dwordx4 v103, s[48:51], s98 offen offset:3072 lds
    ds_read_b128 a[236:239], v105 offset:14336
    s_add_u32 m0, s95, 12288
    s_waitcnt lgkmcnt(2)
    buffer_load_dwordx4 v70, s[48:51], s98 offen offset:0 lds
    s_waitcnt vmcnt(11)
    ds_read_b128 a[48:51], v104 offset:0
    buffer_load_dwordx4 v71, s[48:51], s98 offen offset:1024 lds
    ds_read_b128 a[52:55], v105 offset:0
    s_waitcnt lgkmcnt(2)
    buffer_load_dwordx4 v72, s[48:51], s98 offen offset:2048 lds
    s_waitcnt vmcnt(11)
    ds_read_b128 a[112:115], v104 offset:2048
    buffer_load_dwordx4 v73, s[48:51], s98 offen offset:3072 lds
    buffer_load_dword v4, v107, s[60:63], 0 offen sc1
    ds_read_b128 a[116:119], v105 offset:2048
    s_waitcnt vmcnt(11)
    ds_read_b128 a[176:179], v104 offset:4096
    ds_read_b128 a[180:183], v105 offset:4096
    s_waitcnt vmcnt(9)
    ds_read_b128 a[240:243], v104 offset:6144
    ds_read_b128 a[244:247], v105 offset:6144
    s_waitcnt vmcnt(7)
    ds_read_b128 a[56:59], v104 offset:8192
    ds_read_b128 a[60:63], v105 offset:8192
    s_waitcnt vmcnt(5)
    ds_read_b128 a[120:123], v104 offset:10240
    ds_read_b128 a[124:127], v105 offset:10240
    s_waitcnt vmcnt(3)
    ds_read_b128 a[184:187], v104 offset:12288
    ds_read_b128 a[188:191], v105 offset:12288
    s_waitcnt vmcnt(1)
    ds_read_b128 a[248:251], v104 offset:14336
    ds_read_b128 a[252:255], v105 offset:14336
    s_waitcnt lgkmcnt(0)
    s_waitcnt vmcnt(0)
    v_xor_b32 v126, v4, v2
    v_cmp_ne_u32 vcc, 0, v126
    s_cbranch_vccnz L_stub_flghb
L_ok_flghb:
    s_barrier
    s_mul_i32 s75, s68, 122880
    s_mul_i32 s72, s64, 6144
    s_add_u32 s75, s75, s72
    s_add_u32 s75, s75, 10223616
    v_min_u32 v114, 47, v1
    v_lshlrev_b32 v114, 4, v114
    v_cmp_gt_u32 vcc, 24, v1
    v_add_u32 v115, 2688, v114
    s_nop 0
    v_cndmask_b32 v114, v115, v114, vcc
    s_add_u32 m0, s71, 12288
    s_add_u32 s78, s75, 983040
    buffer_load_dwordx4 v106, s[60:63], s78 offen offset:0 sc1 lds
    buffer_load_dwordx4 v106, s[60:63], s78 offen offset:1024 sc1 lds
    buffer_load_dwordx4 v106, s[60:63], s78 offen offset:2048 sc1 lds
    buffer_load_dwordx4 v106, s[60:63], s78 offen offset:3072 sc1 lds
    s_add_u32 m0, s71, 16384
    s_add_u32 s78, s75, 987136
    buffer_load_dwordx4 v106, s[60:63], s78 offen offset:0 sc1 lds
    buffer_load_dwordx4 v106, s[60:63], s78 offen offset:1024 sc1 lds
    s_add_u32 m0, s95, 0
    s_nop 0
    s_add_u32 s78, s75, 1007616
    buffer_load_dwordx4 v106, s[60:63], s78 offen offset:0 sc1 lds
    buffer_load_dwordx4 v106, s[60:63], s78 offen offset:1024 sc1 lds
    buffer_load_dwordx4 v106, s[60:63], s78 offen offset:2048 sc1 lds
    buffer_load_dwordx4 v106, s[60:63], s78 offen offset:3072 sc1 lds
    s_add_u32 m0, s95, 4096
    s_add_u32 s78, s75, 1011712
    buffer_load_dwordx4 v106, s[60:63], s78 offen offset:0 sc1 lds
    buffer_load_dwordx4 v106, s[60:63], s78 offen offset:1024 sc1 lds
    v_and_b32 v102, 7, v1
    v_bfe_u32 v91, v1, 3, 1
    v_lshrrev_b32 v103, 4, v1
    v_lshl_add_u32 v111, v102, 1, v91
    v_lshlrev_b32 v90, 4, v102
    v_lshl_add_u32 v90, v103, 14, v90
    v_lshl_add_u32 v90, v91, 16, v90
    v_and_b32 v102, 15, v1
    s_lshl_b32 s72, s67, 2
    s_add_u32 s74, s72, s64
    s_lshl_b32 s92, s74, 7
    s_add_u32 s92, s92, 1048576
    v_mov_b32 v94, v106
    v_add_u32 v95, 57344, v106
    v_add_u32 v96, 114688, v106
    s_add_u32 s72, s95, 6144
    v_lshl_add_u32 v100, v102, 2, s72
    v_lshl_add_u32 v101, v103, 4, s72
    v_mov_b32 v144, s90
    v_mov_b32 v145, s90
    v_mov_b32 v146, s90
    v_mov_b32 v147, s90
    s_branch L_join
.section .rodata,"a"
.p2align 6
.amdhsa_kernel sequential_preLN__ssm_conv_s4__mixer_gmlp__prompt_kernel
  .amdhsa_next_free_vgpr 512
  .amdhsa_next_free_sgpr 102
  .amdhsa_accum_offset 256
  .amdhsa_group_segment_fixed_size 0
  .amdhsa_kernarg_size 136
  .amdhsa_user_sgpr_count 2
  .amdhsa_user_sgpr_kernarg_segment_ptr 1
  .amdhsa_system_sgpr_workgroup_id_x 1
.end_amdhsa_kernel
```
